```python
import torch

def _softmax(x, axis=-1):
    return torch.softmax(x, dim=axis)
def _gelu(x):
    return torch.nn.functional.gelu(x, approximate="tanh")
def _silu(x):
    return torch.nn.functional.silu(x)
def _sigmoid(x):
    return torch.sigmoid(x)
def _layernorm(x, axis=-1, eps=1e-5):
    m = x.mean(dim=axis, keepdim=True)
    v = x.var(dim=axis, keepdim=True, unbiased=False)
    return (x - m) / torch.sqrt(v + eps)
def _scatter_add(tgt, idx, src, axis=0):
    return tgt.clone().index_add_(axis, idx, src)
def _segment_sum(src, seg, n):
    out = torch.zeros((n,) + src.shape[1:], dtype=src.dtype)
    return out.index_add_(0, seg, src)
def _pad(x, pw):
    flat = tuple(v for pair in reversed(pw) for v in pair)
    return torch.nn.functional.pad(x, flat)

kernel_name = 'sequential_preLN__grouped_kv_mqa__dense_activation_gelu__prompt'

def setup_inputs():

    _w = (lambda a: (lambda t: t.to(torch.bfloat16) if t.is_floating_point() else t)(torch.as_tensor(a)))
    def _A_setup():
        B, S, D, H = 1, 2048, 512, 32
        Dh = D // H
        return {
            "x": _w((lambda *s: torch.randn(*s, dtype=torch.bfloat16) * 0.05)(B, S, D)),
            "wq": _w((lambda *s: torch.randn(*s, dtype=torch.bfloat16) * 0.05)(D, H * Dh)),
            "wk": _w((lambda *s: torch.randn(*s, dtype=torch.bfloat16) * 0.05)(D, Dh)),
            "wv": _w((lambda *s: torch.randn(*s, dtype=torch.bfloat16) * 0.05)(D, Dh)),
            "wo": _w((lambda *s: torch.randn(*s, dtype=torch.bfloat16) * 0.05)(H * Dh, D)),
        }
    _A_in = _A_setup()

    def _B_setup():
        B, S, D, F = 1, 2048, 512, 1376
        return {
            "x": _w((lambda *s: torch.randn(*s, dtype=torch.bfloat16) * 0.05)(B, S, D)),
            "w1": _w((lambda *s: torch.randn(*s, dtype=torch.bfloat16) * 0.8)(D, F) * (D ** -0.5)),
            "b1": _w((lambda *s: torch.randn(*s, dtype=torch.bfloat16) * 0.8)(F) * 0.01),
            "w2": _w((lambda *s: torch.randn(*s, dtype=torch.bfloat16) * 0.2)(F, D) * (F ** -0.5)),
            "b2": _w((lambda *s: torch.randn(*s, dtype=torch.bfloat16) * 0.2)(D) * 0.01),
        }
    _B_in = _B_setup()

    return {
        "A_x": _A_in["x"],
        "A_wq": _A_in["wq"],
        "A_wk": _A_in["wk"],
        "A_wv": _A_in["wv"],
        "A_wo": _A_in["wo"],
        "B_x": _B_in["x"],
        "B_w1": _B_in["w1"],
        "B_b1": _B_in["b1"],
        "B_w2": _B_in["w2"],
        "B_b2": _B_in["b2"],
    }

def reference(A_x, A_wq, A_wk, A_wv, A_wo, B_x, B_w1, B_b1, B_w2, B_b2):
    def _A_ref(x, wq, wk, wv, wo):
        B, S, D = x.shape
        H = 32
        Dh = D // H
        q = (lambda x, *d: x.permute(*d))((x @ wq).reshape(B, S, H, Dh), 0, 2, 1, 3)
        k = x @ wk
        v = x @ wv
        scores = torch.einsum("bhqd,bkd->bhqk", q, k) * (Dh ** -0.5)
        p = _softmax(scores, axis=-1)
        o = torch.einsum("bhqk,bkd->bhqd", p, v)
        return (lambda x, *d: x.permute(*d))(o, 0, 2, 1, 3).reshape(B, S, H * Dh) @ wo

    def _B_ref(x, w1, b1, w2, b2):
        h = torch.einsum("bsd,df->bsf", x, w1) + b1
        h = _gelu(h)
        return torch.einsum("bsf,fd->bsd", h, w2) + b2

    x = A_x
    h = x + _A_ref(_layernorm(x, axis=-1), A_wq, A_wk, A_wv, A_wo)
    h2 = h + _B_ref(_layernorm(h, axis=-1), B_w1, B_b1, B_w2, B_b2)
    return h2
```

```asm
; @launch grid=(256,1,1) block=(512,1,1) lds=163840
.amdgcn_target "amdgcn-amd-amdhsa--gfx950"
.text
.globl sequential_preLN__grouped_kv_mqa__dense_activation_gelu__prompt_kernel
.p2align 8
.type sequential_preLN__grouped_kv_mqa__dense_activation_gelu__prompt_kernel,@function
sequential_preLN__grouped_kv_mqa__dense_activation_gelu__prompt_kernel:
    s_load_dwordx16 s[4:19], s[0:1], 0
    s_load_dwordx8 s[20:27], s[0:1], 64
    s_load_dwordx2 s[28:29], s[0:1], 96
    s_cmp_ge_u32 s2, 256
    s_cbranch_scc1 L_end
    s_cmp_lt_u32 s2, 224
    s_cbranch_scc1 L_nocpf
    s_getpc_b64 s[92:93]
    v_subrev_u32 v2, 256, v0
    v_cmp_gt_u32 vcc, 256, v2
    v_lshlrev_b32 v2, 7, v2
    v_min_u32 v2, L_fb_code - sequential_preLN__grouped_kv_mqa__dense_activation_gelu__prompt_kernel - 64, v2
    s_and_saveexec_b64 s[94:95], vcc
    s_cbranch_execz L_nocpf
    v_mov_b32 v3, s93
    v_add_co_u32 v2, vcc, s92, v2
    s_nop 1
    v_addc_co_u32 v3, vcc, 0, v3, vcc
    global_load_dword v122, v[2:3], off
L_nocpf:
    s_mov_b64 exec, -1
    v_lshrrev_b32 v2, 6, v0
    v_and_b32 v1, 63, v0
    v_readfirstlane_b32 s50, v2
    s_and_b32 s64, s2, 7
    s_lshr_b32 s65, s2, 3
    s_lshr_b32 s52, s65, 2
    s_and_b32 s65, s65, 3
    s_lshl_b32 s64, s64, 2
    s_add_u32 s51, s64, s65
    s_and_b32 s53, s50, 1
    s_lshr_b32 s54, s50, 2
    s_bfe_u32 s55, s50, 0x10001
    v_lshlrev_b32 v4, 4, v1
    v_lshrrev_b32 v5, 5, v1
    s_and_b32 s79, s50, 3
    s_cmp_eq_u32 s52, 1
    s_cselect_b32 s64, 1, 0
    s_xor_b32 s88, s54, s64
    v_lshrrev_b32 v2, 4, v1
    v_and_b32 v3, 15, v1
    v_xor_b32 v3, v3, v2
    v_lshlrev_b32 v3, 4, v3
    v_lshl_add_u32 v16, v2, 10, v3
    v_xor_b32 v17, 0x1040, v16
    v_xor_b32 v18, 0x2080, v16
    v_xor_b32 v19, 0x30c0, v16
    v_lshrrev_b32 v2, 3, v1
    v_and_b32 v3, 7, v1
    v_lshrrev_b32 v13, 2, v1
    v_and_b32 v13, 4, v13
    v_xor_b32 v3, v3, v13
    v_lshlrev_b32 v3, 4, v3
    v_lshl_add_u32 v6, v2, 10, v3
    s_lshl_b32 s68, s51, 16
    s_lshl_b32 s65, s88, 15
    s_add_u32 s68, s68, s65
    s_lshl_b32 s65, s79, 8
    s_add_u32 s68, s68, s65
    s_lshl_b32 s69, s79, 14
    s_lshl_b32 s65, s88, 13
    s_add_u32 s69, s69, s65
    s_lshl_b32 s70, s79, 12
    s_lshl_b32 s67, s52, 7
    s_cmp_ge_u32 s52, 2
    s_cbranch_scc1 L_sequential_preLN__grouped_kv_mqa__dense_activation_gelu__prompt_kernel_nb_2
    v_mov_b32 v20, 98304
    v_mov_b32 v21, 0
    ds_write_b32 v20, v21
    s_waitcnt lgkmcnt(0)
    s_barrier
L_sequential_preLN__grouped_kv_mqa__dense_activation_gelu__prompt_kernel_nb_2:
    s_waitcnt lgkmcnt(0)
    s_mov_b32 s40, s4
    s_and_b32 s41, s5, 0xffff
    s_mov_b32 s42, 0x200000
    s_mov_b32 s43, 0x20000
    s_mov_b32 s84, s6
    s_and_b32 s85, s7, 0xffff
    s_mov_b32 s86, 0x80000
    s_mov_b32 s87, 0x20000
    s_sub_u32 s64, s52, 2
    s_cmp_ge_u32 s64, 4
    s_cbranch_scc1 L_sequential_preLN__grouped_kv_mqa__dense_activation_gelu__prompt_kernel_nw_8
    s_cmp_ge_u32 s50, 2
    s_cbranch_scc1 L_sequential_preLN__grouped_kv_mqa__dense_activation_gelu__prompt_kernel_nw_8
    s_cmp_eq_u32 s64, 0
    s_cselect_b64 s[94:95], s[8:9], s[10:11]
    v_lshlrev_b32 v20, 7, v0
    s_cmp_lt_u32 s64, 2
    s_cbranch_scc1 L_sequential_preLN__grouped_kv_mqa__dense_activation_gelu__prompt_kernel_nw_8_l
    s_cmp_eq_u32 s64, 2
    s_cselect_b64 s[94:95], s[28:29], s[26:27]
    s_cselect_b32 s65, 0x20740, 0
    s_add_u32 s65, s65, 192
    v_mov_b32 v20, s65
L_sequential_preLN__grouped_kv_mqa__dense_activation_gelu__prompt_kernel_nw_8_l:
    global_load_dword v123, v20, s[94:95] sc1
L_sequential_preLN__grouped_kv_mqa__dense_activation_gelu__prompt_kernel_nw_8:
    s_add_u32 m0, s69, 0
    s_add_u32 s71, s68, 0
    buffer_load_dwordx4 v16, s[40:43], s71 offen  lds
    s_add_u32 m0, s69, 1024
    s_add_u32 s71, s68, 0
    buffer_load_dwordx4 v17, s[40:43], s71 offen  lds
    s_add_u32 m0, s69, 2048
    s_add_u32 s71, s68, 0
    buffer_load_dwordx4 v18, s[40:43], s71 offen  lds
    s_add_u32 m0, s69, 3072
    s_add_u32 s71, s68, 0
    buffer_load_dwordx4 v19, s[40:43], s71 offen  lds
    s_add_u32 m0, s69, 4096
    s_add_u32 s71, s68, 16384
    buffer_load_dwordx4 v16, s[40:43], s71 offen  lds
    s_add_u32 m0, s69, 5120
    s_add_u32 s71, s68, 16384
    buffer_load_dwordx4 v17, s[40:43], s71 offen  lds
    s_add_u32 m0, s69, 6144
    s_add_u32 s71, s68, 16384
    buffer_load_dwordx4 v18, s[40:43], s71 offen  lds
    s_add_u32 m0, s69, 7168
    s_add_u32 s71, s68, 16384
    buffer_load_dwordx4 v19, s[40:43], s71 offen  lds
    s_cmp_ge_u32 s52, 2
    s_cbranch_scc1 L_sequential_preLN__grouped_kv_mqa__dense_activation_gelu__prompt_kernel_nprod_4
    s_cmp_ge_u32 s50, 4
    s_cbranch_scc1 L_sequential_preLN__grouped_kv_mqa__dense_activation_gelu__prompt_kernel_p47_5
    s_mov_b32 s44, s8
    s_and_b32 s45, s9, 0xffff
    s_mov_b32 s46, 0x4000
    s_mov_b32 s47, 0x20000
    s_mov_b32 s80, s10
    s_and_b32 s81, s11, 0xffff
    s_mov_b32 s82, 0x4000
    s_mov_b32 s83, 0x20000
    s_add_u32 m0, s70, 131072
    s_add_u32 s71, s70, 0
    buffer_load_dwordx4 v4, s[44:47], s71 offen  lds
    s_add_u32 m0, s70, 132096
    s_add_u32 s71, s70, 1024
    buffer_load_dwordx4 v4, s[44:47], s71 offen  lds
    s_add_u32 m0, s70, 133120
    s_add_u32 s71, s70, 2048
    buffer_load_dwordx4 v4, s[44:47], s71 offen  lds
    s_add_u32 m0, s70, 134144
    s_add_u32 s71, s70, 3072
    buffer_load_dwordx4 v4, s[44:47], s71 offen  lds
    s_add_u32 m0, s70, 147456
    s_add_u32 s71, s70, 0
    buffer_load_dwordx4 v4, s[80:83], s71 offen  lds
    s_add_u32 m0, s70, 148480
    s_add_u32 s71, s70, 1024
    buffer_load_dwordx4 v4, s[80:83], s71 offen  lds
    s_add_u32 m0, s70, 149504
    s_add_u32 s71, s70, 2048
    buffer_load_dwordx4 v4, s[80:83], s71 offen  lds
    s_add_u32 m0, s70, 150528
    s_add_u32 s71, s70, 3072
    buffer_load_dwordx4 v4, s[80:83], s71 offen  lds
L_sequential_preLN__grouped_kv_mqa__dense_activation_gelu__prompt_kernel_crit_7:
    s_setprio 3
    v_and_b32 v3, 15, v1
    v_xor_b32 v2, v5, v3
    v_lshlrev_b32 v2, 4, v2
    v_and_b32 v3, 31, v1
    v_lshl_add_u32 v94, v3, 8, v2
    v_add_u32 v80, s69, v94
    v_xor_b32 v81, 32, v80
    v_xor_b32 v82, 64, v80
    v_xor_b32 v83, 96, v80
    v_xor_b32 v84, 128, v80
    v_xor_b32 v85, 160, v80
    v_xor_b32 v86, 192, v80
    v_xor_b32 v87, 224, v80
    v_lshlrev_b32 v2, 4, v5
    v_lshl_add_u32 v7, v3, 10, v2
    s_mov_b32 s57, 0x3f803f80
    v_mov_b32 v92, 0
    v_mov_b32 v93, 0
    v_mov_b32 v120, s57
    v_mov_b32 v121, s57
    v_bfe_u32 v2, v1, 2, 2
    v_lshl_add_u32 v2, v5, 3, v2
    v_lshlrev_b32 v2, 5, v2
    v_bfe_u32 v3, v1, 4, 1
    v_lshl_add_u32 v2, v3, 14, v2
    v_and_b32 v3, 3, v1
    v_lshl_add_u32 v2, v3, 3, v2
    s_add_u32 s70, s70, 131072
    v_add_u32 v14, s70, v2
    s_mov_b32 s32, s28
    s_and_b32 s33, s29, 0xffff
    s_mov_b32 s34, 0x21000
    s_mov_b32 s35, 0x20000
    s_lshl_b32 s78, s50, 11
    v_mov_b32 v13, 98304
    v_mov_b32 v15, 1
    v_and_b32 v2, 31, v1
    v_lshlrev_b32 v2, 5, v2
    v_lshl_add_u32 v2, v5, 3, v2
    v_add_u32 v8, 148480, v2
    v_lshrrev_b32 v2, 4, v1
    v_lshlrev_b32 v2, 8, v2
    v_and_b32 v3, 15, v1
    v_lshl_add_u32 v2, v3, 3, v2
    v_add_u32 v9, 148480, v2
    v_lshrrev_b32 v10, 2, v1
    s_lshl_b32 s68, s51, 1
    s_add_u32 s68, s68, s52
    v_add_u32 v90, s78, v4
    v_add_u32 v90, 131072, v90
    s_lshl_b32 s64, s50, 6
    s_add_u32 s64, s64, 147968
    v_lshl_add_u32 v91, v5, 4, s64
    s_waitcnt vmcnt(8)
    ds_read_b128 v[48:51], v80
    ds_read_b128 v[52:55], v81
    ds_read_b128 v[56:59], v82
    ds_read_b128 v[60:63], v83
    ds_read_b128 v[64:67], v84
    ds_read_b128 v[68:71], v85
    ds_read_b128 v[72:75], v86
    ds_read_b128 v[76:79], v87
    s_waitcnt lgkmcnt(4)
    v_dot2c_f32_bf16 v92, s57, v48
    v_dot2c_f32_bf16 v93, v48, v48
    v_dot2c_f32_bf16 v92, s57, v49
    v_dot2c_f32_bf16 v93, v49, v49
    v_dot2c_f32_bf16 v92, s57, v50
    v_dot2c_f32_bf16 v93, v50, v50
    v_dot2c_f32_bf16 v92, s57, v51
    v_dot2c_f32_bf16 v93, v51, v51
    v_dot2c_f32_bf16 v92, s57, v52
    v_dot2c_f32_bf16 v93, v52, v52
    v_dot2c_f32_bf16 v92, s57, v53
    v_dot2c_f32_bf16 v93, v53, v53
    v_dot2c_f32_bf16 v92, s57, v54
    v_dot2c_f32_bf16 v93, v54, v54
    v_dot2c_f32_bf16 v92, s57, v55
    v_dot2c_f32_bf16 v93, v55, v55
    v_dot2c_f32_bf16 v92, s57, v56
    v_dot2c_f32_bf16 v93, v56, v56
    v_dot2c_f32_bf16 v92, s57, v57
    v_dot2c_f32_bf16 v93, v57, v57
    v_dot2c_f32_bf16 v92, s57, v58
    v_dot2c_f32_bf16 v93, v58, v58
    v_dot2c_f32_bf16 v92, s57, v59
    v_dot2c_f32_bf16 v93, v59, v59
    v_dot2c_f32_bf16 v92, s57, v60
    v_dot2c_f32_bf16 v93, v60, v60
    v_dot2c_f32_bf16 v92, s57, v61
    v_dot2c_f32_bf16 v93, v61, v61
    v_dot2c_f32_bf16 v92, s57, v62
    v_dot2c_f32_bf16 v93, v62, v62
    v_dot2c_f32_bf16 v92, s57, v63
    v_dot2c_f32_bf16 v93, v63, v63
    s_waitcnt vmcnt(0) lgkmcnt(0)
    ds_read_b64_tr_b16 a[0:1], v14 offset:0
    ds_read_b64_tr_b16 a[2:3], v14 offset:128
    ds_read_b64_tr_b16 a[4:5], v14 offset:512
    ds_read_b64_tr_b16 a[6:7], v14 offset:640
    ds_read_b64_tr_b16 a[8:9], v14 offset:1024
    ds_read_b64_tr_b16 a[10:11], v14 offset:1152
    ds_read_b64_tr_b16 a[12:13], v14 offset:1536
    ds_read_b64_tr_b16 a[14:15], v14 offset:1664
    ds_read_b64_tr_b16 a[16:17], v14 offset:2048
    ds_read_b64_tr_b16 a[18:19], v14 offset:2176
    ds_read_b64_tr_b16 a[20:21], v14 offset:2560
    ds_read_b64_tr_b16 a[22:23], v14 offset:2688
    ds_read_b64_tr_b16 a[24:25], v14 offset:3072
    ds_read_b64_tr_b16 a[26:27], v14 offset:3200
    s_waitcnt lgkmcnt(8)
    ds_read_b64_tr_b16 a[28:29], v14 offset:3584
    ds_read_b64_tr_b16 a[30:31], v14 offset:3712
    v_dot2c_f32_bf16 v92, s57, v64
    v_dot2c_f32_bf16 v93, v64, v64
    v_dot2c_f32_bf16 v92, s57, v65
    v_dot2c_f32_bf16 v93, v65, v65
    v_dot2c_f32_bf16 v92, s57, v66
    v_dot2c_f32_bf16 v93, v66, v66
    v_dot2c_f32_bf16 v92, s57, v67
    v_dot2c_f32_bf16 v93, v67, v67
    v_dot2c_f32_bf16 v92, s57, v68
    v_dot2c_f32_bf16 v93, v68, v68
    v_dot2c_f32_bf16 v92, s57, v69
    v_dot2c_f32_bf16 v93, v69, v69
    v_dot2c_f32_bf16 v92, s57, v70
    v_dot2c_f32_bf16 v93, v70, v70
    v_dot2c_f32_bf16 v92, s57, v71
    v_dot2c_f32_bf16 v93, v71, v71
    v_dot2c_f32_bf16 v92, s57, v72
    v_dot2c_f32_bf16 v93, v72, v72
    v_dot2c_f32_bf16 v92, s57, v73
    v_dot2c_f32_bf16 v93, v73, v73
    v_dot2c_f32_bf16 v92, s57, v74
    v_dot2c_f32_bf16 v93, v74, v74
    v_dot2c_f32_bf16 v92, s57, v75
    v_dot2c_f32_bf16 v93, v75, v75
    v_dot2c_f32_bf16 v92, s57, v76
    v_dot2c_f32_bf16 v93, v76, v76
    v_dot2c_f32_bf16 v92, s57, v77
    v_dot2c_f32_bf16 v93, v77, v77
    v_dot2c_f32_bf16 v92, s57, v78
    v_dot2c_f32_bf16 v93, v78, v78
    v_dot2c_f32_bf16 v92, s57, v79
    v_dot2c_f32_bf16 v93, v79, v79
    s_waitcnt lgkmcnt(0)
    v_mfma_f32_4x4x4_16b_bf16 v[32:35], v[120:121], a[0:1], 0
    v_mfma_f32_4x4x4_16b_bf16 v[36:39], v[120:121], a[2:3], 0
    v_mfma_f32_4x4x4_16b_bf16 v[40:43], v[120:121], a[4:5], 0
    v_mfma_f32_4x4x4_16b_bf16 v[44:47], v[120:121], a[6:7], 0
    v_mfma_f32_4x4x4_16b_bf16 v[32:35], v[120:121], a[8:9], v[32:35]
    v_mfma_f32_4x4x4_16b_bf16 v[36:39], v[120:121], a[10:11], v[36:39]
    v_mfma_f32_4x4x4_16b_bf16 v[40:43], v[120:121], a[12:13], v[40:43]
    v_mfma_f32_4x4x4_16b_bf16 v[44:47], v[120:121], a[14:15], v[44:47]
    v_mfma_f32_4x4x4_16b_bf16 v[32:35], v[120:121], a[16:17], v[32:35]
    v_mfma_f32_4x4x4_16b_bf16 v[36:39], v[120:121], a[18:19], v[36:39]
    v_mfma_f32_4x4x4_16b_bf16 v[40:43], v[120:121], a[20:21], v[40:43]
    v_mfma_f32_4x4x4_16b_bf16 v[44:47], v[120:121], a[22:23], v[44:47]
    v_mfma_f32_4x4x4_16b_bf16 v[32:35], v[120:121], a[24:25], v[32:35]
    v_mfma_f32_4x4x4_16b_bf16 v[36:39], v[120:121], a[26:27], v[36:39]
    v_mfma_f32_4x4x4_16b_bf16 v[40:43], v[120:121], a[28:29], v[40:43]
    v_mfma_f32_4x4x4_16b_bf16 v[44:47], v[120:121], a[30:31], v[44:47]
    v_mfma_f32_32x32x16_bf16 v[16:31], a[0:3], v[48:51], 0
    v_mfma_f32_32x32x16_bf16 v[16:31], a[4:7], v[52:55], v[16:31]
    v_mfma_f32_32x32x16_bf16 v[16:31], a[8:11], v[56:59], v[16:31]
    v_mfma_f32_32x32x16_bf16 v[16:31], a[12:15], v[60:63], v[16:31]
    v_mfma_f32_32x32x16_bf16 v[16:31], a[16:19], v[64:67], v[16:31]
    v_mfma_f32_32x32x16_bf16 v[16:31], a[20:23], v[68:71], v[16:31]
    v_mfma_f32_32x32x16_bf16 v[16:31], a[24:27], v[72:75], v[16:31]
    v_mfma_f32_32x32x16_bf16 v[16:31], a[28:31], v[76:79], v[16:31]
    s_lshl_b32 s64, s88, 8
    s_add_u32 s64, s64, s70
    s_add_u32 s64, s64, 16384
    v_permlane32_swap_b32 v92, v93
    v_lshl_add_u32 v95, v1, 2, s64
    v_add_f32 v92, v92, v93
    ds_write_b32 v95, v92
    v_add_f32 v32, v32, v36
    v_add_f32 v40, v40, v44
    v_add_f32 v32, v32, v40
    v_mov_b32 v33, v32
    s_add_u32 s64, s70, 16896
    v_lshl_add_u32 v3, v1, 2, s64
    v_permlane32_swap_b32 v32, v33
    v_add_u32 v2, s70, v4
    v_add_f32 v32, v32, v33
    ds_write_b32 v3, v32
    ds_write_b128 v2, v[16:19] offset:0
    ds_write_b128 v2, v[20:23] offset:1024
    ds_write_b128 v2, v[24:27] offset:2048
    ds_write_b128 v2, v[28:31] offset:3072
    v_mov_b32 v2, 148224
    v_mov_b32 v3, 0
    s_mov_b64 exec, 1
    s_cmp_lg_u32 s50, 0
    s_cbranch_scc1 L_sequential_preLN__grouped_kv_mqa__dense_activation_gelu__prompt_kernel_nz_13
    ds_write_b32 v2, v3
L_sequential_preLN__grouped_kv_mqa__dense_activation_gelu__prompt_kernel_nz_13:
    ds_add_u32 v13, v15
    s_mov_b64 exec, -1
    s_cmp_lt_u32 s50, 2
    s_cbranch_scc1 L_sequential_preLN__grouped_kv_mqa__dense_activation_gelu__prompt_kernel_fin_14
    s_setprio 0
    s_lshl_b32 s64, s55, 5
    v_xor_b32 v2, s64, v94
    s_lshl_b32 s64, s54, 13
    v_add_u32 v8, s64, v2
    v_xor_b32 v9, 64, v8
    v_xor_b32 v10, 0x80, v8
    v_xor_b32 v11, 0xc0, v8
    s_lshl_b32 s64, s55, 11
    s_add_u32 s64, s64, 65536
    v_bfe_u32 v2, v1, 2, 2
    v_lshl_add_u32 v3, v5, 3, v2
    v_lshrrev_b32 v2, 1, v2
    v_xor_b32 v2, s53, v2
    v_lshlrev_b32 v2, 6, v2
    v_lshl_add_u32 v2, v3, 7, v2
    v_bfe_u32 v3, v1, 4, 1
    v_lshl_add_u32 v2, v3, 5, v2
    v_and_b32 v3, 3, v1
    v_lshl_add_u32 v2, v3, 3, v2
    v_add_u32 v12, s64, v2
    s_mul_i32 s64, s51, 0x40000
    s_add_u32 s64, s64, 0x40000
    s_add_u32 s36, s28, s64
    s_addc_u32 s37, s29, 0
    s_and_b32 s37, s37, 0xffff
    s_mov_b32 s38, 0x40000
    s_mov_b32 s39, 0x20000
    s_mov_b32 s44, s16
    s_and_b32 s45, s17, 0xffff
    s_mov_b32 s46, 0x158000
    s_mov_b32 s47, 0x20000
    s_mov_b32 s80, s20
    s_and_b32 s81, s21, 0xffff
    s_mov_b32 s82, 0x158000
    s_mov_b32 s83, 0x20000
    s_mov_b32 s62, 1048576
    s_lshl_b32 s63, s50, 10
    s_lshl_b32 s89, s2, 13
    s_add_u32 s89, s89, s63
    s_lshl_b32 s77, s50, 14
    s_add_u32 s77, s77, s67
    s_lshl_b32 s61, s52, 5
    s_lshl_b32 s65, s50, 2
    s_add_u32 s61, s61, s65
    s_add_u32 s61, s61, 0x24000
    s_lshl_b32 s65, s52, 2
    s_lshl_b32 s66, s53, 1
    s_add_u32 s65, s65, s66
    s_add_u32 s65, s65, s55
    s_lshl_b32 s59, s54, 5
    s_add_u32 s59, s59, s65
    s_lshl_b32 s59, s59, 10
    s_lshl_b32 s64, s51, 1
    s_add_u32 s64, s64, s54
    s_lshl_b32 s60, s64, 15
    s_lshl_b32 s65, s65, 5
    s_add_u32 s60, s60, s65
    v_lshlrev_b32 v119, 7, v1
    v_mov_b32 v96, 0
    s_mov_b32 exec_lo, 0x11
    s_mov_b32 exec_hi, 0x11
    v_mov_b32 v96, s57
    s_mov_b64 exec, -1
    v_mov_b32 v97, v96
    v_mov_b32 v98, v96
    v_mov_b32 v99, v96
    v_mov_b32 v100, v96
    v_mov_b32 v101, v96
    v_mov_b32 v102, v96
    v_mov_b32 v103, v96
    v_mov_b32 v104, v96
    v_mov_b32 v105, v96
    v_mov_b32 v106, v96
    v_mov_b32 v107, v96
    v_mov_b32 v108, v96
    v_mov_b32 v109, v96
    v_mov_b32 v110, v96
    v_mov_b32 v111, v96
    v_mov_b32 v112, 0xdddddddd
    s_lshl_b32 s64, s55, 10
    v_add_u32 v113, s64, v4
    v_and_b32 v2, 15, v1
    v_lshl_add_u32 v2, v5, 4, v2
    s_add_u32 s64, s64, 65536
    v_lshl_add_u32 v114, v2, 4, s64
    s_mov_b32 s72, 0xffff0000
    s_mov_b32 s73, 0xffff0000
    s_mul_i32 s58, s52, 5
    s_min_u32 s64, s52, 3
    s_add_u32 s58, s58, s64
    s_add_u32 s64, s53, 4
    s_cmp_lt_u32 s50, 4
    s_cselect_b32 s64, s50, s64
    s_add_u32 s58, s58, s64
    v_lshrrev_b32 v2, 2, v1
    v_and_b32 v3, 3, v1
    v_lshlrev_b32 v3, 4, v3
    s_movk_i32 s64, 2752
    v_mad_u32_u24 v115, v2, s64, v3
    v_bfe_u32 v2, v1, 2, 2
    v_lshl_add_u32 v2, v5, 2, v2
    v_lshlrev_b32 v2, 6, v2
    v_lshrrev_b32 v3, 1, v3
    v_add_u32 v2, v2, v3
    v_bfe_u32 v3, v1, 4, 1
    v_lshl_add_u32 v2, v3, 5, v2
    s_lshl_b32 s75, s50, 12
    s_add_u32 s75, s75, 131072
    v_add_u32 v116, s75, v2
    s_lshl_b32 s74, s58, 6
    s_waitcnt lgkmcnt(0)
    s_barrier
    s_branch L_sequential_preLN__grouped_kv_mqa__dense_activation_gelu__prompt_kernel_qproj_9
L_sequential_preLN__grouped_kv_mqa__dense_activation_gelu__prompt_kernel_fin_14:
    ds_read_b32 v3, v13
    s_waitcnt lgkmcnt(0)
    v_readfirstlane_b32 s64, v3
    s_nop 3
    s_cmp_lt_u32 s64, 4
    s_cbranch_scc1 L_sequential_preLN__grouped_kv_mqa__dense_activation_gelu__prompt_kernel_fin_14
    v_and_b32 v2, 31, v1
    s_lshl_b32 s64, s52, 8
    s_add_u32 s64, s64, 147456
    v_lshl_add_u32 v2, v2, 2, s64
    ds_read_b32 v80, v2 offset:0
    ds_read_b32 v81, v2 offset:128
    ds_read_b32 v82, v2 offset:4096
    ds_read_b32 v83, v2 offset:4224
    ds_read_b32 v84, v2 offset:8192
    ds_read_b32 v85, v2 offset:8320
    ds_read_b32 v86, v2 offset:12288
    ds_read_b32 v87, v2 offset:12416
    ds_read_b128 v[16:19], v90 offset:0
    ds_read_b128 v[20:23], v90 offset:1024
    ds_read_b128 v[24:27], v90 offset:4096
    ds_read_b128 v[28:31], v90 offset:5120
    ds_read_b128 v[32:35], v90 offset:8192
    ds_read_b128 v[36:39], v90 offset:9216
    s_waitcnt lgkmcnt(5)
    ds_read_b128 v[40:43], v90 offset:12288
    ds_read_b128 v[44:47], v90 offset:13312
    ds_read_b128 v[48:51], v91 offset:0
    ds_read_b128 v[52:55], v91 offset:32
    ds_read_b128 v[56:59], v91 offset:4096
    ds_read_b128 v[60:63], v91 offset:4128
    ds_read_b128 v[64:67], v91 offset:8192
    ds_read_b128 v[68:71], v91 offset:8224
    ds_read_b128 v[72:75], v91 offset:12288
    ds_read_b128 v[76:79], v91 offset:12320
    v_add_f32 v80, v80, v82
    v_add_f32 v84, v84, v86
    v_add_f32 v81, v81, v83
    v_add_f32 v85, v85, v87
    v_add_f32 v80, v80, v84
    v_add_f32 v81, v81, v85
    v_mul_f32 v80, 0x3b000000, v80
    v_mul_f32 v81, 0x3b000000, v81
    v_fma_f32 v81, -v80, v80, v81
    v_max_f32 v81, 0, v81
    v_add_f32 v81, 0x3727c5ac, v81
    v_rsq_f32 v81, v81
    s_nop 0
    s_waitcnt lgkmcnt(8)
    v_pk_add_f32 v[16:17], v[16:17], v[32:33]
    v_pk_add_f32 v[18:19], v[18:19], v[34:35]
    v_pk_add_f32 v[20:21], v[20:21], v[36:37]
    v_pk_add_f32 v[22:23], v[22:23], v[38:39]
    v_pk_add_f32 v[24:25], v[24:25], v[40:41]
    v_pk_add_f32 v[26:27], v[26:27], v[42:43]
    v_pk_add_f32 v[28:29], v[28:29], v[44:45]
    v_pk_add_f32 v[30:31], v[30:31], v[46:47]
    v_pk_add_f32 v[16:17], v[16:17], v[24:25]
    v_pk_add_f32 v[18:19], v[18:19], v[26:27]
    v_pk_add_f32 v[20:21], v[20:21], v[28:29]
    v_pk_add_f32 v[22:23], v[22:23], v[30:31]
    s_waitcnt lgkmcnt(6)
    v_pk_fma_f32 v[16:17], v[80:81], v[48:49], v[16:17] op_sel:[0,0,0] op_sel_hi:[0,1,1] neg_lo:[1,0,0] neg_hi:[1,0,0]
    v_pk_fma_f32 v[18:19], v[80:81], v[50:51], v[18:19] op_sel:[0,0,0] op_sel_hi:[0,1,1] neg_lo:[1,0,0] neg_hi:[1,0,0]
    v_pk_fma_f32 v[20:21], v[80:81], v[52:53], v[20:21] op_sel:[0,0,0] op_sel_hi:[0,1,1] neg_lo:[1,0,0] neg_hi:[1,0,0]
    v_pk_fma_f32 v[22:23], v[80:81], v[54:55], v[22:23] op_sel:[0,0,0] op_sel_hi:[0,1,1] neg_lo:[1,0,0] neg_hi:[1,0,0]
    s_waitcnt lgkmcnt(4)
    v_pk_fma_f32 v[16:17], v[80:81], v[56:57], v[16:17] op_sel:[0,0,0] op_sel_hi:[0,1,1] neg_lo:[1,0,0] neg_hi:[1,0,0]
    v_pk_fma_f32 v[18:19], v[80:81], v[58:59], v[18:19] op_sel:[0,0,0] op_sel_hi:[0,1,1] neg_lo:[1,0,0] neg_hi:[1,0,0]
    v_pk_fma_f32 v[20:21], v[80:81], v[60:61], v[20:21] op_sel:[0,0,0] op_sel_hi:[0,1,1] neg_lo:[1,0,0] neg_hi:[1,0,0]
    v_pk_fma_f32 v[22:23], v[80:81], v[62:63], v[22:23] op_sel:[0,0,0] op_sel_hi:[0,1,1] neg_lo:[1,0,0] neg_hi:[1,0,0]
    s_waitcnt lgkmcnt(2)
    v_pk_fma_f32 v[16:17], v[80:81], v[64:65], v[16:17] op_sel:[0,0,0] op_sel_hi:[0,1,1] neg_lo:[1,0,0] neg_hi:[1,0,0]
    v_pk_fma_f32 v[18:19], v[80:81], v[66:67], v[18:19] op_sel:[0,0,0] op_sel_hi:[0,1,1] neg_lo:[1,0,0] neg_hi:[1,0,0]
    v_pk_fma_f32 v[20:21], v[80:81], v[68:69], v[20:21] op_sel:[0,0,0] op_sel_hi:[0,1,1] neg_lo:[1,0,0] neg_hi:[1,0,0]
    v_pk_fma_f32 v[22:23], v[80:81], v[70:71], v[22:23] op_sel:[0,0,0] op_sel_hi:[0,1,1] neg_lo:[1,0,0] neg_hi:[1,0,0]
    s_waitcnt lgkmcnt(0)
    v_pk_fma_f32 v[16:17], v[80:81], v[72:73], v[16:17] op_sel:[0,0,0] op_sel_hi:[0,1,1] neg_lo:[1,0,0] neg_hi:[1,0,0]
    v_pk_fma_f32 v[18:19], v[80:81], v[74:75], v[18:19] op_sel:[0,0,0] op_sel_hi:[0,1,1] neg_lo:[1,0,0] neg_hi:[1,0,0]
    v_pk_fma_f32 v[20:21], v[80:81], v[76:77], v[20:21] op_sel:[0,0,0] op_sel_hi:[0,1,1] neg_lo:[1,0,0] neg_hi:[1,0,0]
    v_pk_fma_f32 v[22:23], v[80:81], v[78:79], v[22:23] op_sel:[0,0,0] op_sel_hi:[0,1,1] neg_lo:[1,0,0] neg_hi:[1,0,0]
    v_pk_mul_f32 v[16:17], v[80:81], v[16:17] op_sel:[1,0] op_sel_hi:[1,1]
    v_pk_mul_f32 v[18:19], v[80:81], v[18:19] op_sel:[1,0] op_sel_hi:[1,1]
    v_pk_mul_f32 v[20:21], v[80:81], v[20:21] op_sel:[1,0] op_sel_hi:[1,1]
    v_pk_mul_f32 v[22:23], v[80:81], v[22:23] op_sel:[1,0] op_sel_hi:[1,1]
    v_cvt_pk_bf16_f32 v84, v16, v17
    v_cvt_pk_bf16_f32 v85, v18, v19
    v_cvt_pk_bf16_f32 v86, v20, v21
    v_cvt_pk_bf16_f32 v87, v22, v23
    s_lshl_b32 s66, s68, 10
    s_cmp_eq_u32 s50, 0
    s_cbranch_scc1 L_sequential_preLN__grouped_kv_mqa__dense_activation_gelu__prompt_kernel_FV_12
    ds_write_b64 v8, v[84:85]
    ds_write_b64 v8, v[86:87] offset:16
    ds_read_b64_tr_b16 a[0:1], v9
    ds_read_b64_tr_b16 a[2:3], v9 offset:128
    v_mul_f32 v88, v16, v16
    v_mul_f32 v89, v17, v17
    v_fmac_f32 v88, v18, v18
    v_fmac_f32 v89, v19, v19
    v_fmac_f32 v88, v20, v20
    v_fmac_f32 v89, v21, v21
    v_fmac_f32 v88, v22, v22
    v_fmac_f32 v89, v23, v23
    v_add_f32 v88, v88, v89
    s_lshl_b32 s64, s68, 4
    v_mov_b32 v89, v88
    s_lshl_b32 s65, s50, 3
    s_add_u32 s64, s64, s65
    v_permlane32_swap_b32 v88, v89
    s_add_u32 s64, s64, 0x20000
    v_add_f32 v88, v88, v89
    v_and_b32 v88, 0x7fffffff, v88
    s_add_u32 s66, s66, 0x10000
    s_waitcnt lgkmcnt(0)
    buffer_store_dwordx4 a[0:3], v4, s[32:35], s66 offen sc1
L_sequential_preLN__grouped_kv_mqa__dense_activation_gelu__prompt_kernel_fj_15:
    s_nop 1
    v_max_u32_dpp v88, v88, v88 row_ror:8 row_mask:0xf bank_mask:0xf
    s_nop 1
    v_max_u32_dpp v88, v88, v88 row_ror:4 row_mask:0xf bank_mask:0xf
    s_nop 1
    v_max_u32_dpp v88, v88, v88 row_ror:2 row_mask:0xf bank_mask:0xf
    s_nop 1
    v_max_u32_dpp v88, v88, v88 row_ror:1 row_mask:0xf bank_mask:0xf
    s_mov_b64 exec, 0x10001
    buffer_store_dword v88, v10, s[32:35], s64 offen sc1
    s_mov_b64 exec, -1
    s_lshl_b32 s64, s55, 5
    v_xor_b32 v2, s64, v94
    s_lshl_b32 s64, s54, 13
    v_add_u32 v8, s64, v2
    v_xor_b32 v9, 64, v8
    v_xor_b32 v10, 0x80, v8
    v_xor_b32 v11, 0xc0, v8
    s_lshl_b32 s64, s55, 11
    s_add_u32 s64, s64, 65536
    v_bfe_u32 v2, v1, 2, 2
    v_lshl_add_u32 v3, v5, 3, v2
    v_lshrrev_b32 v2, 1, v2
    v_xor_b32 v2, s53, v2
    v_lshlrev_b32 v2, 6, v2
    v_lshl_add_u32 v2, v3, 7, v2
    v_bfe_u32 v3, v1, 4, 1
    v_lshl_add_u32 v2, v3, 5, v2
    v_and_b32 v3, 3, v1
    v_lshl_add_u32 v2, v3, 3, v2
    v_add_u32 v12, s64, v2
    s_mul_i32 s64, s51, 0x40000
    s_add_u32 s64, s64, 0x40000
    s_add_u32 s36, s28, s64
    s_addc_u32 s37, s29, 0
    s_and_b32 s37, s37, 0xffff
    s_mov_b32 s38, 0x40000
    s_mov_b32 s39, 0x20000
    s_mov_b32 s44, s16
    s_and_b32 s45, s17, 0xffff
    s_mov_b32 s46, 0x158000
    s_mov_b32 s47, 0x20000
    s_mov_b32 s80, s20
    s_and_b32 s81, s21, 0xffff
    s_mov_b32 s82, 0x158000
    s_mov_b32 s83, 0x20000
    s_mov_b32 s62, 1048576
    s_lshl_b32 s63, s50, 10
    s_lshl_b32 s89, s2, 13
    s_add_u32 s89, s89, s63
    s_lshl_b32 s77, s50, 14
    s_add_u32 s77, s77, s67
    s_lshl_b32 s61, s52, 5
    s_lshl_b32 s65, s50, 2
    s_add_u32 s61, s61, s65
    s_add_u32 s61, s61, 0x24000
    s_lshl_b32 s65, s52, 2
    s_lshl_b32 s66, s53, 1
    s_add_u32 s65, s65, s66
    s_add_u32 s65, s65, s55
    s_lshl_b32 s59, s54, 5
    s_add_u32 s59, s59, s65
    s_lshl_b32 s59, s59, 10
    s_lshl_b32 s64, s51, 1
    s_add_u32 s64, s64, s54
    s_lshl_b32 s60, s64, 15
    s_lshl_b32 s65, s65, 5
    s_add_u32 s60, s60, s65
    v_lshlrev_b32 v119, 7, v1
    v_mov_b32 v96, 0
    s_mov_b32 exec_lo, 0x11
    s_mov_b32 exec_hi, 0x11
    v_mov_b32 v96, s57
    s_mov_b64 exec, -1
    v_mov_b32 v97, v96
    v_mov_b32 v98, v96
    v_mov_b32 v99, v96
    v_mov_b32 v100, v96
    v_mov_b32 v101, v96
    v_mov_b32 v102, v96
    v_mov_b32 v103, v96
    v_mov_b32 v104, v96
    v_mov_b32 v105, v96
    v_mov_b32 v106, v96
    v_mov_b32 v107, v96
    v_mov_b32 v108, v96
    v_mov_b32 v109, v96
    v_mov_b32 v110, v96
    v_mov_b32 v111, v96
    v_mov_b32 v112, 0xdddddddd
    s_lshl_b32 s64, s55, 10
    v_add_u32 v113, s64, v4
    v_and_b32 v2, 15, v1
    v_lshl_add_u32 v2, v5, 4, v2
    s_add_u32 s64, s64, 65536
    v_lshl_add_u32 v114, v2, 4, s64
    s_mov_b32 s72, 0xffff0000
    s_mov_b32 s73, 0xffff0000
    s_mul_i32 s58, s52, 5
    s_min_u32 s64, s52, 3
    s_add_u32 s58, s58, s64
    s_add_u32 s64, s53, 4
    s_cmp_lt_u32 s50, 4
    s_cselect_b32 s64, s50, s64
    s_add_u32 s58, s58, s64
    v_lshrrev_b32 v2, 2, v1
    v_and_b32 v3, 3, v1
    v_lshlrev_b32 v3, 4, v3
    s_movk_i32 s64, 2752
    v_mad_u32_u24 v115, v2, s64, v3
    v_bfe_u32 v2, v1, 2, 2
    v_lshl_add_u32 v2, v5, 2, v2
    v_lshlrev_b32 v2, 6, v2
    v_lshrrev_b32 v3, 1, v3
    v_add_u32 v2, v2, v3
    v_bfe_u32 v3, v1, 4, 1
    v_lshl_add_u32 v2, v3, 5, v2
    s_lshl_b32 s75, s50, 12
    s_add_u32 s75, s75, 131072
    v_add_u32 v116, s75, v2
    s_lshl_b32 s74, s58, 6
    v_mov_b32 v13, 148224
    v_mov_b32 v14, 0
    v_mov_b32 v95, 0
    s_waitcnt vmcnt(0)
    s_mov_b64 exec, 1
    ds_add_rtn_u32 v3, v13, v15
    s_waitcnt lgkmcnt(0)
    v_readfirstlane_b32 s64, v3
    s_nop 3
    s_cmp_lg_u32 s64, 1
    s_cbranch_scc1 L_sequential_preLN__grouped_kv_mqa__dense_activation_gelu__prompt_kernel_noatom_16
    global_atomic_add v14, v95, v15, s[26:27] sc0 sc1
L_sequential_preLN__grouped_kv_mqa__dense_activation_gelu__prompt_kernel_noatom_16:
    s_lshl_b32 s64, s68, 10
    s_lshl_b32 s65, s50, 16
    s_add_u32 s64, s64, s65
    s_mov_b64 exec, 0xff
    buffer_load_dword v123, v119, s[32:35], s64 offen sc1
    s_mov_b64 exec, -1
    s_barrier
    ds_read_b128 a[32:35], v8 offset:0
    ds_read_b64_tr_b16 a[64:65], v12 offset:0
    ds_read_b64_tr_b16 a[66:67], v12 offset:512
    ds_read_b128 a[36:39], v9 offset:0
    ds_read_b64_tr_b16 a[68:69], v12 offset:4096
    ds_read_b64_tr_b16 a[70:71], v12 offset:4608
    ds_read_b128 a[40:43], v10 offset:0
    ds_read_b64_tr_b16 a[72:73], v12 offset:8192
    ds_read_b64_tr_b16 a[74:75], v12 offset:8704
    ds_read_b128 a[44:47], v11 offset:0
    ds_read_b64_tr_b16 a[76:77], v12 offset:12288
    ds_read_b64_tr_b16 a[78:79], v12 offset:12800
    s_waitcnt lgkmcnt(9)
    v_mfma_f32_32x32x16_bf16 v[16:31], a[64:67], a[32:35], 0
    ds_read_b128 a[48:51], v8 offset:16384
    ds_read_b64_tr_b16 a[80:81], v12 offset:16384
    ds_read_b64_tr_b16 a[82:83], v12 offset:16896
    s_waitcnt lgkmcnt(9)
    v_mfma_f32_32x32x16_bf16 v[16:31], a[68:71], a[36:39], v[16:31]
    ds_read_b128 a[52:55], v9 offset:16384
    ds_read_b64_tr_b16 a[84:85], v12 offset:20480
    ds_read_b64_tr_b16 a[86:87], v12 offset:20992
    s_waitcnt lgkmcnt(9)
    v_mfma_f32_32x32x16_bf16 v[16:31], a[72:75], a[40:43], v[16:31]
    ds_read_b128 a[56:59], v10 offset:16384
    ds_read_b64_tr_b16 a[88:89], v12 offset:24576
    ds_read_b64_tr_b16 a[90:91], v12 offset:25088
    s_waitcnt lgkmcnt(9)
    v_mfma_f32_32x32x16_bf16 v[16:31], a[76:79], a[44:47], v[16:31]
    ds_read_b128 a[60:63], v11 offset:16384
    ds_read_b64_tr_b16 a[92:93], v12 offset:28672
    ds_read_b64_tr_b16 a[94:95], v12 offset:29184
    s_waitcnt lgkmcnt(9)
    v_mfma_f32_32x32x16_bf16 v[16:31], a[80:83], a[48:51], v[16:31]
    s_waitcnt lgkmcnt(6)
    v_mfma_f32_32x32x16_bf16 v[16:31], a[84:87], a[52:55], v[16:31]
    s_waitcnt vmcnt(1)
    v_readfirstlane_b32 s64, v14
    s_nop 3
    s_cmp_lg_u32 s64, 63
    s_cbranch_scc1 L_sequential_preLN__grouped_kv_mqa__dense_activation_gelu__prompt_kernel_nogo_17
    s_mov_b64 exec, 1
    global_store_dword v95, v15, s[26:27] offset:192 sc1
    s_mov_b64 exec, -1
L_sequential_preLN__grouped_kv_mqa__dense_activation_gelu__prompt_kernel_nogo_17:
    s_waitcnt lgkmcnt(3)
    v_mfma_f32_32x32x16_bf16 v[16:31], a[88:91], a[56:59], v[16:31]
    s_waitcnt lgkmcnt(0)
    v_mfma_f32_32x32x16_bf16 v[16:31], a[92:95], a[60:63], v[16:31]
    v_mfma_f32_4x4x4_16b_bf16 v[32:35], v[120:121], a[64:65], 0
    v_mfma_f32_4x4x4_16b_bf16 v[36:39], v[120:121], a[66:67], 0
    v_mfma_f32_4x4x4_16b_bf16 v[40:43], v[120:121], a[68:69], 0
    v_mfma_f32_4x4x4_16b_bf16 v[44:47], v[120:121], a[70:71], 0
    v_mfma_f32_4x4x4_16b_bf16 v[32:35], v[120:121], a[72:73], v[32:35]
    v_mfma_f32_4x4x4_16b_bf16 v[36:39], v[120:121], a[74:75], v[36:39]
    v_mfma_f32_4x4x4_16b_bf16 v[40:43], v[120:121], a[76:77], v[40:43]
    v_mfma_f32_4x4x4_16b_bf16 v[44:47], v[120:121], a[78:79], v[44:47]
    v_mfma_f32_4x4x4_16b_bf16 v[32:35], v[120:121], a[80:81], v[32:35]
    v_mfma_f32_4x4x4_16b_bf16 v[36:39], v[120:121], a[82:83], v[36:39]
    v_mfma_f32_4x4x4_16b_bf16 v[40:43], v[120:121], a[84:85], v[40:43]
    v_mfma_f32_4x4x4_16b_bf16 v[44:47], v[120:121], a[86:87], v[44:47]
    v_mfma_f32_4x4x4_16b_bf16 v[32:35], v[120:121], a[88:89], v[32:35]
    v_mfma_f32_4x4x4_16b_bf16 v[36:39], v[120:121], a[90:91], v[36:39]
    v_mfma_f32_4x4x4_16b_bf16 v[40:43], v[120:121], a[92:93], v[40:43]
    v_mfma_f32_4x4x4_16b_bf16 v[44:47], v[120:121], a[94:95], v[44:47]
    s_branch L_sequential_preLN__grouped_kv_mqa__dense_activation_gelu__prompt_kernel_q1_10
L_sequential_preLN__grouped_kv_mqa__dense_activation_gelu__prompt_kernel_FV_12:
    buffer_store_dwordx4 v[84:87], v4, s[32:35], s66 offen sc1
    v_mul_f32 v88, v16, v16
    v_mul_f32 v89, v17, v17
    v_fmac_f32 v88, v18, v18
    v_fmac_f32 v89, v19, v19
    v_fmac_f32 v88, v20, v20
    v_fmac_f32 v89, v21, v21
    v_fmac_f32 v88, v22, v22
    v_fmac_f32 v89, v23, v23
    v_add_f32 v88, v88, v89
    s_lshl_b32 s64, s68, 4
    v_mov_b32 v89, v88
    s_lshl_b32 s65, s50, 3
    s_add_u32 s64, s64, s65
    v_permlane32_swap_b32 v88, v89
    s_add_u32 s64, s64, 0x20000
    v_add_f32 v88, v88, v89
    v_and_b32 v88, 0x7fffffff, v88
    s_branch L_sequential_preLN__grouped_kv_mqa__dense_activation_gelu__prompt_kernel_fj_15
L_sequential_preLN__grouped_kv_mqa__dense_activation_gelu__prompt_kernel_p47_5:
L_sequential_preLN__grouped_kv_mqa__dense_activation_gelu__prompt_kernel_nprod_4:
    v_and_b32 v3, 15, v1
    v_xor_b32 v2, v5, v3
    v_lshlrev_b32 v2, 4, v2
    v_and_b32 v3, 31, v1
    v_lshl_add_u32 v94, v3, 8, v2
    v_add_u32 v80, s69, v94
    v_xor_b32 v81, 32, v80
    v_xor_b32 v82, 64, v80
    v_xor_b32 v83, 96, v80
    v_xor_b32 v84, 128, v80
    v_xor_b32 v85, 160, v80
    v_xor_b32 v86, 192, v80
    v_xor_b32 v87, 224, v80
    v_lshlrev_b32 v2, 4, v5
    v_lshl_add_u32 v7, v3, 10, v2
    s_mov_b32 s57, 0x3f803f80
    v_mov_b32 v92, 0
    v_mov_b32 v93, 0
    v_mov_b32 v120, s57
    v_mov_b32 v121, s57
    v_bfe_u32 v2, v1, 2, 2
    v_lshl_add_u32 v2, v5, 3, v2
    v_lshlrev_b32 v2, 5, v2
    v_bfe_u32 v3, v1, 4, 1
    v_lshl_add_u32 v2, v3, 14, v2
    v_and_b32 v3, 3, v1
    v_lshl_add_u32 v2, v3, 3, v2
    s_add_u32 s70, s70, 131072
    v_add_u32 v14, s70, v2
    s_mov_b32 s32, s28
    s_and_b32 s33, s29, 0xffff
    s_mov_b32 s34, 0x21000
    s_mov_b32 s35, 0x20000
    s_lshl_b32 s78, s50, 11
    s_lshl_b32 s64, s55, 5
    v_xor_b32 v2, s64, v94
    s_lshl_b32 s64, s54, 13
    v_add_u32 v8, s64, v2
    v_xor_b32 v9, 64, v8
    v_xor_b32 v10, 0x80, v8
    v_xor_b32 v11, 0xc0, v8
    s_lshl_b32 s64, s55, 11
    s_add_u32 s64, s64, 65536
    v_bfe_u32 v2, v1, 2, 2
    v_lshl_add_u32 v3, v5, 3, v2
    v_lshrrev_b32 v2, 1, v2
    v_xor_b32 v2, s53, v2
    v_lshlrev_b32 v2, 6, v2
    v_lshl_add_u32 v2, v3, 7, v2
    v_bfe_u32 v3, v1, 4, 1
    v_lshl_add_u32 v2, v3, 5, v2
    v_and_b32 v3, 3, v1
    v_lshl_add_u32 v2, v3, 3, v2
    v_add_u32 v12, s64, v2
    s_mul_i32 s64, s51, 0x40000
    s_add_u32 s64, s64, 0x40000
    s_add_u32 s36, s28, s64
    s_addc_u32 s37, s29, 0
    s_and_b32 s37, s37, 0xffff
    s_mov_b32 s38, 0x40000
    s_mov_b32 s39, 0x20000
    s_mov_b32 s44, s16
    s_and_b32 s45, s17, 0xffff
    s_mov_b32 s46, 0x158000
    s_mov_b32 s47, 0x20000
    s_mov_b32 s80, s20
    s_and_b32 s81, s21, 0xffff
    s_mov_b32 s82, 0x158000
    s_mov_b32 s83, 0x20000
    s_mov_b32 s62, 1048576
    s_lshl_b32 s63, s50, 10
    s_lshl_b32 s89, s2, 13
    s_add_u32 s89, s89, s63
    s_lshl_b32 s77, s50, 14
    s_add_u32 s77, s77, s67
    s_lshl_b32 s61, s52, 5
    s_lshl_b32 s65, s50, 2
    s_add_u32 s61, s61, s65
    s_add_u32 s61, s61, 0x24000
    s_lshl_b32 s65, s52, 2
    s_lshl_b32 s66, s53, 1
    s_add_u32 s65, s65, s66
    s_add_u32 s65, s65, s55
    s_lshl_b32 s59, s54, 5
    s_add_u32 s59, s59, s65
    s_lshl_b32 s59, s59, 10
    s_lshl_b32 s64, s51, 1
    s_add_u32 s64, s64, s54
    s_lshl_b32 s60, s64, 15
    s_lshl_b32 s65, s65, 5
    s_add_u32 s60, s60, s65
    v_lshlrev_b32 v119, 7, v1
    v_mov_b32 v96, 0
    s_mov_b32 exec_lo, 0x11
    s_mov_b32 exec_hi, 0x11
    v_mov_b32 v96, s57
    s_mov_b64 exec, -1
    v_mov_b32 v97, v96
    v_mov_b32 v98, v96
    v_mov_b32 v99, v96
    v_mov_b32 v100, v96
    v_mov_b32 v101, v96
    v_mov_b32 v102, v96
    v_mov_b32 v103, v96
    v_mov_b32 v104, v96
    v_mov_b32 v105, v96
    v_mov_b32 v106, v96
    v_mov_b32 v107, v96
    v_mov_b32 v108, v96
    v_mov_b32 v109, v96
    v_mov_b32 v110, v96
    v_mov_b32 v111, v96
    v_mov_b32 v112, 0xdddddddd
    s_lshl_b32 s64, s55, 10
    v_add_u32 v113, s64, v4
    v_and_b32 v2, 15, v1
    v_lshl_add_u32 v2, v5, 4, v2
    s_add_u32 s64, s64, 65536
    v_lshl_add_u32 v114, v2, 4, s64
    s_mov_b32 s72, 0xffff0000
    s_mov_b32 s73, 0xffff0000
    s_mul_i32 s58, s52, 5
    s_min_u32 s64, s52, 3
    s_add_u32 s58, s58, s64
    s_add_u32 s64, s53, 4
    s_cmp_lt_u32 s50, 4
    s_cselect_b32 s64, s50, s64
    s_add_u32 s58, s58, s64
    v_lshrrev_b32 v2, 2, v1
    v_and_b32 v3, 3, v1
    v_lshlrev_b32 v3, 4, v3
    s_movk_i32 s64, 2752
    v_mad_u32_u24 v115, v2, s64, v3
    v_bfe_u32 v2, v1, 2, 2
    v_lshl_add_u32 v2, v5, 2, v2
    v_lshlrev_b32 v2, 6, v2
    v_lshrrev_b32 v3, 1, v3
    v_add_u32 v2, v2, v3
    v_bfe_u32 v3, v1, 4, 1
    v_lshl_add_u32 v2, v3, 5, v2
    s_lshl_b32 s75, s50, 12
    s_add_u32 s75, s75, 131072
    v_add_u32 v116, s75, v2
    s_lshl_b32 s74, s58, 6
    s_cmp_ge_u32 s52, 2
    s_cbranch_scc1 L_sequential_preLN__grouped_kv_mqa__dense_activation_gelu__prompt_kernel_np2_18
    s_lshl_b32 s64, s79, 16
    s_add_u32 s64, s64, s67
    s_lshl_b32 s65, s79, 13
    s_add_u32 m0, s65, 65536
    s_add_u32 s71, s64, 0
    buffer_load_dwordx4 v6, s[84:87], s71 offen  lds
    s_add_u32 m0, s65, 66560
    s_add_u32 s71, s64, 8192
    buffer_load_dwordx4 v6, s[84:87], s71 offen  lds
    s_add_u32 m0, s65, 67584
    s_add_u32 s71, s64, 16384
    buffer_load_dwordx4 v6, s[84:87], s71 offen  lds
    s_add_u32 m0, s65, 68608
    s_add_u32 s71, s64, 24576
    buffer_load_dwordx4 v6, s[84:87], s71 offen  lds
    s_add_u32 m0, s65, 69632
    s_add_u32 s71, s64, 32768
    buffer_load_dwordx4 v6, s[84:87], s71 offen  lds
    s_add_u32 m0, s65, 70656
    s_add_u32 s71, s64, 40960
    buffer_load_dwordx4 v6, s[84:87], s71 offen  lds
    s_add_u32 m0, s65, 71680
    s_add_u32 s71, s64, 49152
    buffer_load_dwordx4 v6, s[84:87], s71 offen  lds
    s_add_u32 m0, s65, 72704
    s_add_u32 s71, s64, 57344
    buffer_load_dwordx4 v6, s[84:87], s71 offen  lds
    v_lshlrev_b32 v2, 10, v1
    s_add_u32 s64, s64, 262144
    buffer_load_dword v123, v2, s[84:87], s64 offen
    s_waitcnt vmcnt(9)
    s_branch L_sequential_preLN__grouped_kv_mqa__dense_activation_gelu__prompt_kernel_hi2_19
L_sequential_preLN__grouped_kv_mqa__dense_activation_gelu__prompt_kernel_np2_18:
    s_lshl_b32 s64, s50, 15
    s_add_u32 s64, s64, s67
    s_lshl_b32 s65, s50, 12
    s_add_u32 m0, s65, 65536
    s_add_u32 s71, s64, 0
    buffer_load_dwordx4 v6, s[84:87], s71 offen  lds
    s_add_u32 m0, s65, 66560
    s_add_u32 s71, s64, 8192
    buffer_load_dwordx4 v6, s[84:87], s71 offen  lds
    s_add_u32 m0, s65, 67584
    s_add_u32 s71, s64, 16384
    buffer_load_dwordx4 v6, s[84:87], s71 offen  lds
    s_add_u32 m0, s65, 68608
    s_add_u32 s71, s64, 24576
    buffer_load_dwordx4 v6, s[84:87], s71 offen  lds
    s_add_u32 m0, s65, 98304
    s_add_u32 s71, s64, 262144
    buffer_load_dwordx4 v6, s[84:87], s71 offen  lds
    s_add_u32 m0, s65, 99328
    s_add_u32 s71, s64, 270336
    buffer_load_dwordx4 v6, s[84:87], s71 offen  lds
    s_add_u32 m0, s65, 100352
    s_add_u32 s71, s64, 278528
    buffer_load_dwordx4 v6, s[84:87], s71 offen  lds
    s_add_u32 m0, s65, 101376
    s_add_u32 s71, s64, 286720
    buffer_load_dwordx4 v6, s[84:87], s71 offen  lds
L_sequential_preLN__grouped_kv_mqa__dense_activation_gelu__prompt_kernel_hi_3:
L_sequential_preLN__grouped_kv_mqa__dense_activation_gelu__prompt_kernel_setup_6:
    s_waitcnt vmcnt(8)
L_sequential_preLN__grouped_kv_mqa__dense_activation_gelu__prompt_kernel_hi2_19:
    ds_read_b128 v[48:51], v80
    ds_read_b128 v[52:55], v81
    ds_read_b128 v[56:59], v82
    ds_read_b128 v[60:63], v83
    ds_read_b128 v[64:67], v84
    ds_read_b128 v[68:71], v85
    ds_read_b128 v[72:75], v86
    ds_read_b128 v[76:79], v87
    s_waitcnt lgkmcnt(4)
    v_dot2c_f32_bf16 v92, s57, v48
    v_dot2c_f32_bf16 v93, v48, v48
    v_dot2c_f32_bf16 v92, s57, v49
    v_dot2c_f32_bf16 v93, v49, v49
    v_dot2c_f32_bf16 v92, s57, v50
    v_dot2c_f32_bf16 v93, v50, v50
    v_dot2c_f32_bf16 v92, s57, v51
    v_dot2c_f32_bf16 v93, v51, v51
    v_dot2c_f32_bf16 v92, s57, v52
    v_dot2c_f32_bf16 v93, v52, v52
    v_dot2c_f32_bf16 v92, s57, v53
    v_dot2c_f32_bf16 v93, v53, v53
    v_dot2c_f32_bf16 v92, s57, v54
    v_dot2c_f32_bf16 v93, v54, v54
    v_dot2c_f32_bf16 v92, s57, v55
    v_dot2c_f32_bf16 v93, v55, v55
    v_dot2c_f32_bf16 v92, s57, v56
    v_dot2c_f32_bf16 v93, v56, v56
    v_dot2c_f32_bf16 v92, s57, v57
    v_dot2c_f32_bf16 v93, v57, v57
    v_dot2c_f32_bf16 v92, s57, v58
    v_dot2c_f32_bf16 v93, v58, v58
    v_dot2c_f32_bf16 v92, s57, v59
    v_dot2c_f32_bf16 v93, v59, v59
    v_dot2c_f32_bf16 v92, s57, v60
    v_dot2c_f32_bf16 v93, v60, v60
    v_dot2c_f32_bf16 v92, s57, v61
    v_dot2c_f32_bf16 v93, v61, v61
    v_dot2c_f32_bf16 v92, s57, v62
    v_dot2c_f32_bf16 v93, v62, v62
    v_dot2c_f32_bf16 v92, s57, v63
    v_dot2c_f32_bf16 v93, v63, v63
    s_waitcnt lgkmcnt(0)
    v_dot2c_f32_bf16 v92, s57, v64
    v_dot2c_f32_bf16 v93, v64, v64
    v_dot2c_f32_bf16 v92, s57, v65
    v_dot2c_f32_bf16 v93, v65, v65
    v_dot2c_f32_bf16 v92, s57, v66
    v_dot2c_f32_bf16 v93, v66, v66
    v_dot2c_f32_bf16 v92, s57, v67
    v_dot2c_f32_bf16 v93, v67, v67
    v_dot2c_f32_bf16 v92, s57, v68
    v_dot2c_f32_bf16 v93, v68, v68
    v_dot2c_f32_bf16 v92, s57, v69
    v_dot2c_f32_bf16 v93, v69, v69
    v_dot2c_f32_bf16 v92, s57, v70
    v_dot2c_f32_bf16 v93, v70, v70
    v_dot2c_f32_bf16 v92, s57, v71
    v_dot2c_f32_bf16 v93, v71, v71
    v_dot2c_f32_bf16 v92, s57, v72
    v_dot2c_f32_bf16 v93, v72, v72
    v_dot2c_f32_bf16 v92, s57, v73
    v_dot2c_f32_bf16 v93, v73, v73
    v_dot2c_f32_bf16 v92, s57, v74
    v_dot2c_f32_bf16 v93, v74, v74
    v_dot2c_f32_bf16 v92, s57, v75
    v_dot2c_f32_bf16 v93, v75, v75
    v_dot2c_f32_bf16 v92, s57, v76
    v_dot2c_f32_bf16 v93, v76, v76
    v_dot2c_f32_bf16 v92, s57, v77
    v_dot2c_f32_bf16 v93, v77, v77
    v_dot2c_f32_bf16 v92, s57, v78
    v_dot2c_f32_bf16 v93, v78, v78
    v_dot2c_f32_bf16 v92, s57, v79
    v_dot2c_f32_bf16 v93, v79, v79
    s_lshl_b32 s64, s88, 8
    s_add_u32 s64, s64, s70
    s_add_u32 s64, s64, 16384
    v_permlane32_swap_b32 v92, v93
    v_lshl_add_u32 v95, v1, 2, s64
    v_add_f32 v92, v92, v93
    s_cmp_lt_u32 s52, 2
    s_cbranch_scc1 L_sequential_preLN__grouped_kv_mqa__dense_activation_gelu__prompt_kernel_pord_20
    s_waitcnt vmcnt(4)
    s_barrier
    ds_write_b32 v95, v92
    s_branch L_sequential_preLN__grouped_kv_mqa__dense_activation_gelu__prompt_kernel_qproj_9
L_sequential_preLN__grouped_kv_mqa__dense_activation_gelu__prompt_kernel_pord_20:
    s_lshl_b32 s64, s79, 16
    s_add_u32 s64, s64, s67
    s_lshl_b32 s65, s79, 13
    s_waitcnt vmcnt(1)
    s_barrier
    ds_write_b32 v95, v92
    s_add_u32 m0, s65, 98304
    s_add_u32 s71, s64, 262144
    buffer_load_dwordx4 v6, s[84:87], s71 offen  lds
    s_add_u32 m0, s65, 99328
    s_add_u32 s71, s64, 270336
    buffer_load_dwordx4 v6, s[84:87], s71 offen  lds
    s_add_u32 m0, s65, 100352
    s_add_u32 s71, s64, 278528
    buffer_load_dwordx4 v6, s[84:87], s71 offen  lds
    s_add_u32 m0, s65, 101376
    s_add_u32 s71, s64, 286720
    buffer_load_dwordx4 v6, s[84:87], s71 offen  lds
    s_add_u32 m0, s65, 102400
    s_add_u32 s71, s64, 294912
    buffer_load_dwordx4 v6, s[84:87], s71 offen  lds
    s_add_u32 m0, s65, 103424
    s_add_u32 s71, s64, 303104
    buffer_load_dwordx4 v6, s[84:87], s71 offen  lds
    s_add_u32 m0, s65, 104448
    s_add_u32 s71, s64, 311296
    buffer_load_dwordx4 v6, s[84:87], s71 offen  lds
    s_add_u32 m0, s65, 105472
    s_add_u32 s71, s64, 319488
    buffer_load_dwordx4 v6, s[84:87], s71 offen  lds
    s_branch L_sequential_preLN__grouped_kv_mqa__dense_activation_gelu__prompt_kernel_qproj_9
L_sequential_preLN__grouped_kv_mqa__dense_activation_gelu__prompt_kernel_qproj_9:
    s_setprio 0
    ds_read_b128 a[32:35], v8 offset:0
    ds_read_b64_tr_b16 a[64:65], v12 offset:0
    ds_read_b64_tr_b16 a[66:67], v12 offset:512
    ds_read_b128 a[36:39], v9 offset:0
    ds_read_b64_tr_b16 a[68:69], v12 offset:4096
    ds_read_b64_tr_b16 a[70:71], v12 offset:4608
    ds_read_b128 a[40:43], v10 offset:0
    ds_read_b64_tr_b16 a[72:73], v12 offset:8192
    ds_read_b64_tr_b16 a[74:75], v12 offset:8704
    ds_read_b128 a[44:47], v11 offset:0
    ds_read_b64_tr_b16 a[76:77], v12 offset:12288
    ds_read_b64_tr_b16 a[78:79], v12 offset:12800
    s_waitcnt lgkmcnt(9)
    v_mfma_f32_32x32x16_bf16 v[16:31], a[64:67], a[32:35], 0
    ds_read_b128 a[48:51], v8 offset:16384
    ds_read_b64_tr_b16 a[80:81], v12 offset:16384
    ds_read_b64_tr_b16 a[82:83], v12 offset:16896
    s_waitcnt lgkmcnt(9)
    v_mfma_f32_32x32x16_bf16 v[16:31], a[68:71], a[36:39], v[16:31]
    ds_read_b128 a[52:55], v9 offset:16384
    ds_read_b64_tr_b16 a[84:85], v12 offset:20480
    ds_read_b64_tr_b16 a[86:87], v12 offset:20992
    s_waitcnt lgkmcnt(9)
    v_mfma_f32_32x32x16_bf16 v[16:31], a[72:75], a[40:43], v[16:31]
    ds_read_b128 a[56:59], v10 offset:16384
    ds_read_b64_tr_b16 a[88:89], v12 offset:24576
    ds_read_b64_tr_b16 a[90:91], v12 offset:25088
    s_waitcnt lgkmcnt(9)
    v_mfma_f32_32x32x16_bf16 v[16:31], a[76:79], a[44:47], v[16:31]
    ds_read_b128 a[60:63], v11 offset:16384
    ds_read_b64_tr_b16 a[92:93], v12 offset:28672
    ds_read_b64_tr_b16 a[94:95], v12 offset:29184
    s_waitcnt lgkmcnt(9)
    v_mfma_f32_32x32x16_bf16 v[16:31], a[80:83], a[48:51], v[16:31]
    s_waitcnt lgkmcnt(6)
    v_mfma_f32_32x32x16_bf16 v[16:31], a[84:87], a[52:55], v[16:31]
    s_waitcnt lgkmcnt(3)
    v_mfma_f32_32x32x16_bf16 v[16:31], a[88:91], a[56:59], v[16:31]
    s_waitcnt lgkmcnt(0)
    v_mfma_f32_32x32x16_bf16 v[16:31], a[92:95], a[60:63], v[16:31]
    v_mfma_f32_4x4x4_16b_bf16 v[32:35], v[120:121], a[64:65], 0
    v_mfma_f32_4x4x4_16b_bf16 v[36:39], v[120:121], a[66:67], 0
    v_mfma_f32_4x4x4_16b_bf16 v[40:43], v[120:121], a[68:69], 0
    v_mfma_f32_4x4x4_16b_bf16 v[44:47], v[120:121], a[70:71], 0
    v_mfma_f32_4x4x4_16b_bf16 v[32:35], v[120:121], a[72:73], v[32:35]
    v_mfma_f32_4x4x4_16b_bf16 v[36:39], v[120:121], a[74:75], v[36:39]
    v_mfma_f32_4x4x4_16b_bf16 v[40:43], v[120:121], a[76:77], v[40:43]
    v_mfma_f32_4x4x4_16b_bf16 v[44:47], v[120:121], a[78:79], v[44:47]
    v_mfma_f32_4x4x4_16b_bf16 v[32:35], v[120:121], a[80:81], v[32:35]
    v_mfma_f32_4x4x4_16b_bf16 v[36:39], v[120:121], a[82:83], v[36:39]
    v_mfma_f32_4x4x4_16b_bf16 v[40:43], v[120:121], a[84:85], v[40:43]
    v_mfma_f32_4x4x4_16b_bf16 v[44:47], v[120:121], a[86:87], v[44:47]
    v_mfma_f32_4x4x4_16b_bf16 v[32:35], v[120:121], a[88:89], v[32:35]
    v_mfma_f32_4x4x4_16b_bf16 v[36:39], v[120:121], a[90:91], v[36:39]
    v_mfma_f32_4x4x4_16b_bf16 v[40:43], v[120:121], a[92:93], v[40:43]
    v_mfma_f32_4x4x4_16b_bf16 v[44:47], v[120:121], a[94:95], v[44:47]
    s_waitcnt vmcnt(0)
L_sequential_preLN__grouped_kv_mqa__dense_activation_gelu__prompt_kernel_q1_10:
    s_barrier
    v_and_b32 v2, 31, v1
    s_lshl_b32 s64, s54, 8
    s_add_u32 s64, s64, 147456
    v_lshl_add_u32 v2, v2, 2, s64
    ds_read_b32 v80, v2 offset:0
    ds_read_b32 v81, v2 offset:128
    ds_read_b32 v82, v2 offset:4096
    ds_read_b32 v83, v2 offset:4224
    ds_read_b32 v84, v2 offset:8192
    ds_read_b32 v85, v2 offset:8320
    ds_read_b32 v86, v2 offset:12288
    ds_read_b32 v87, v2 offset:12416
    ds_read_b128 a[32:35], v8 offset:32768
    ds_read_b64_tr_b16 a[96:97], v12 offset:32768
    ds_read_b64_tr_b16 a[98:99], v12 offset:33280
    ds_read_b128 a[36:39], v9 offset:32768
    ds_read_b64_tr_b16 a[100:101], v12 offset:36864
    ds_read_b64_tr_b16 a[102:103], v12 offset:37376
    s_waitcnt lgkmcnt(3)
    v_mfma_f32_32x32x16_bf16 v[16:31], a[96:99], a[32:35], v[16:31]
    ds_read_b128 a[40:43], v10 offset:32768
    ds_read_b64_tr_b16 a[104:105], v12 offset:40960
    ds_read_b64_tr_b16 a[106:107], v12 offset:41472
    ds_read_b128 a[44:47], v11 offset:32768
    ds_read_b64_tr_b16 a[108:109], v12 offset:45056
    ds_read_b64_tr_b16 a[110:111], v12 offset:45568
    ds_read_b128 a[48:51], v8 offset:49152
    ds_read_b64_tr_b16 a[112:113], v12 offset:49152
    ds_read_b64_tr_b16 a[114:115], v12 offset:49664
    s_waitcnt lgkmcnt(9)
    v_mfma_f32_32x32x16_bf16 v[16:31], a[100:103], a[36:39], v[16:31]
    ds_read_b128 a[52:55], v9 offset:49152
    ds_read_b64_tr_b16 a[116:117], v12 offset:53248
    ds_read_b64_tr_b16 a[118:119], v12 offset:53760
    v_mov_b32 v2, 0x20800
    buffer_load_dword v123, v2, s[32:35], 0 offen sc1
    v_add_f32 v80, v80, v82
    v_add_f32 v84, v84, v86
    v_add_f32 v81, v81, v83
    v_add_f32 v85, v85, v87
    v_add_f32 v80, v80, v84
    v_add_f32 v81, v81, v85
    v_mul_f32 v80, 0x3b000000, v80
    v_mul_f32 v81, 0x3b000000, v81
    v_fma_f32 v81, -v80, v80, v81
    v_max_f32 v81, 0, v81
    v_add_f32 v81, 0x3727c5ac, v81
    v_rsq_f32 v81, v81
    s_nop 0
    v_mul_f32 v92, 0x3eb8aa3b, v81
    v_sub_f32 v80, 0, v80
    v_cvt_pk_bf16_f32 v88, v80, v80
    v_mov_b32 v90, 0
    v_and_b32 v81, 0xffff0000, v88
    v_sub_f32 v81, v80, v81
    v_mov_b32 v91, 0
    v_cvt_pk_bf16_f32 v89, v81, v90
    s_waitcnt lgkmcnt(9)
    v_mfma_f32_32x32x16_bf16 v[16:31], a[104:107], a[40:43], v[16:31]
    ds_read_b128 a[56:59], v10 offset:49152
    ds_read_b64_tr_b16 a[120:121], v12 offset:57344
    ds_read_b64_tr_b16 a[122:123], v12 offset:57856
    s_waitcnt lgkmcnt(9)
    v_mfma_f32_32x32x16_bf16 v[16:31], a[108:111], a[44:47], v[16:31]
    ds_read_b128 a[60:63], v11 offset:49152
    ds_read_b64_tr_b16 a[124:125], v12 offset:61440
    ds_read_b64_tr_b16 a[126:127], v12 offset:61952
    v_mov_b32 v64, 0
    v_mov_b32 v65, 0
    v_mov_b32 v66, 0
    v_mov_b32 v67, 0
    v_mov_b32 v68, 0
    v_mov_b32 v69, 0
    v_mov_b32 v70, 0
    v_mov_b32 v71, 0
    v_mov_b32 v72, 0
    v_mov_b32 v73, 0
    v_mov_b32 v74, 0
    v_mov_b32 v75, 0
    v_mov_b32 v76, 0
    v_mov_b32 v77, 0
    v_mov_b32 v78, 0
    v_mov_b32 v79, 0
    s_mov_b32 s84, s12
    s_and_b32 s85, s13, 0xffff
    s_mov_b32 s86, 0x80000
    s_mov_b32 s87, 0x20000
    s_waitcnt lgkmcnt(9)
    v_mfma_f32_32x32x16_bf16 v[16:31], a[112:115], a[48:51], v[16:31]
    s_waitcnt lgkmcnt(6)
    v_mfma_f32_32x32x16_bf16 v[16:31], a[116:119], a[52:55], v[16:31]
    s_barrier
    v_mov_b32 v48, 0
    v_mov_b32 v49, 0
    v_mov_b32 v50, 0
    v_mov_b32 v51, 0
    v_mov_b32 v52, 0
    v_mov_b32 v53, 0
    v_mov_b32 v54, 0
    v_mov_b32 v55, 0
    v_mov_b32 v56, 0
    v_mov_b32 v57, 0
    v_mov_b32 v58, 0
    v_mov_b32 v59, 0
    v_mov_b32 v60, 0
    v_mov_b32 v61, 0
    v_mov_b32 v62, 0
    v_mov_b32 v63, 0
    s_waitcnt lgkmcnt(3)
    v_mfma_f32_32x32x16_bf16 v[16:31], a[120:123], a[56:59], v[16:31]
    s_waitcnt lgkmcnt(0)
    v_mfma_f32_32x32x16_bf16 v[16:31], a[124:127], a[60:63], v[16:31]
    s_cmp_lg_u32 s50, 0
    s_cbranch_scc1 L_sequential_preLN__grouped_kv_mqa__dense_activation_gelu__prompt_kernel_ep_21
    global_load_dword v0, v90, s[26:27] offset:192 sc1
L_sequential_preLN__grouped_kv_mqa__dense_activation_gelu__prompt_kernel_ep_21:
    v_mfma_f32_4x4x4_16b_bf16 v[32:35], v[120:121], a[96:97], v[32:35]
    v_mfma_f32_4x4x4_16b_bf16 v[36:39], v[120:121], a[98:99], v[36:39]
    v_mfma_f32_4x4x4_16b_bf16 v[40:43], v[120:121], a[100:101], v[40:43]
    v_mfma_f32_4x4x4_16b_bf16 v[44:47], v[120:121], a[102:103], v[44:47]
    v_mfma_f32_4x4x4_16b_bf16 v[32:35], v[120:121], a[104:105], v[32:35]
    v_mfma_f32_4x4x4_16b_bf16 v[36:39], v[120:121], a[106:107], v[36:39]
    v_mfma_f32_4x4x4_16b_bf16 v[40:43], v[120:121], a[108:109], v[40:43]
    v_mfma_f32_4x4x4_16b_bf16 v[44:47], v[120:121], a[110:111], v[44:47]
    v_mfma_f32_4x4x4_16b_bf16 v[32:35], v[120:121], a[112:113], v[32:35]
    v_mfma_f32_4x4x4_16b_bf16 v[36:39], v[120:121], a[114:115], v[36:39]
    v_mfma_f32_4x4x4_16b_bf16 v[40:43], v[120:121], a[116:117], v[40:43]
    v_mfma_f32_4x4x4_16b_bf16 v[44:47], v[120:121], a[118:119], v[44:47]
    v_mfma_f32_4x4x4_16b_bf16 v[32:35], v[120:121], a[120:121], v[32:35]
    v_mfma_f32_4x4x4_16b_bf16 v[36:39], v[120:121], a[122:123], v[36:39]
    v_mfma_f32_4x4x4_16b_bf16 v[40:43], v[120:121], a[124:125], v[40:43]
    v_mfma_f32_4x4x4_16b_bf16 v[44:47], v[120:121], a[126:127], v[44:47]
    s_setprio 0
    v_add_u32 v12, s75, v4
    v_xor_b32 v13, 0x2000, v12
    s_nop 2
    v_add_f32 v32, v32, v36
    v_add_f32 v40, v40, v44
    v_mov_b32 v86, 0
    v_add_f32 v32, v32, v40
    v_mov_b32 v87, 0
    v_cvt_pk_bf16_f32 v85, v32, v86
    v_lshlrev_b32 v84, 16, v85
    v_sub_f32 v84, v32, v84
    v_cvt_pk_bf16_f32 v84, v32, v84
    s_nop 1
    v_mfma_f32_32x32x16_bf16 v[16:31], v[84:87], v[88:91], v[16:31]
    v_mov_b32 v117, 0
    v_mov_b32 v118, 0
    s_nop 7
    s_nop 1
    ds_write_b128 v12, v[16:19] offset:0
    ds_write_b128 v12, v[20:23] offset:1024
    ds_write_b128 v12, v[24:27] offset:2048
    ds_write_b128 v12, v[28:31] offset:3072
    s_cmp_lg_u32 s50, 0
    s_cbranch_scc1 L_sequential_preLN__grouped_kv_mqa__dense_activation_gelu__prompt_kernel_kvpd_23
    s_waitcnt vmcnt(0)
L_sequential_preLN__grouped_kv_mqa__dense_activation_gelu__prompt_kernel_kvpc_24:
    v_readfirstlane_b32 s64, v0
    s_nop 3
    s_cmp_eq_u32 s64, 1
    s_cbranch_scc1 L_sequential_preLN__grouped_kv_mqa__dense_activation_gelu__prompt_kernel_kvpd_23
    s_sleep 1
    global_load_dword v0, v86, s[26:27] offset:192 sc1
    s_sub_u32 s62, s62, 1
    s_cbranch_scc1 L_sequential_preLN__grouped_kv_mqa__dense_activation_gelu__prompt_kernel_to_25
    s_waitcnt vmcnt(0)
    s_branch L_sequential_preLN__grouped_kv_mqa__dense_activation_gelu__prompt_kernel_kvpc_24
L_sequential_preLN__grouped_kv_mqa__dense_activation_gelu__prompt_kernel_kvpd_23:
    s_waitcnt lgkmcnt(0)
    s_barrier
    ds_read_b128 v[32:35], v13 offset:0
    ds_read_b128 v[36:39], v13 offset:1024
    ds_read_b128 v[40:43], v13 offset:2048
    ds_read_b128 v[44:47], v13 offset:3072
    s_add_u32 s70, s89, 0
    s_and_b32 s70, s70, 0xffff
    s_add_u32 m0, s63, 0
    s_add_u32 s71, s70, 0
    buffer_load_dwordx4 v4, s[32:35], s71 offen sc1 lds
    s_add_u32 m0, s63, 65536
    s_add_u32 s71, s70, 65536
    buffer_load_dwordx4 v4, s[32:35], s71 offen sc1 lds
    s_waitcnt lgkmcnt(3)
    v_pk_add_f32 v[16:17], v[16:17], v[32:33]
    v_pk_add_f32 v[18:19], v[18:19], v[34:35]
    s_waitcnt lgkmcnt(2)
    v_pk_add_f32 v[20:21], v[20:21], v[36:37]
    v_pk_add_f32 v[22:23], v[22:23], v[38:39]
    s_waitcnt lgkmcnt(1)
    v_pk_add_f32 v[24:25], v[24:25], v[40:41]
    v_pk_add_f32 v[26:27], v[26:27], v[42:43]
    s_waitcnt lgkmcnt(0)
    v_pk_add_f32 v[28:29], v[28:29], v[44:45]
    v_pk_add_f32 v[30:31], v[30:31], v[46:47]
    v_pk_mul_f32 v[16:17], v[92:93], v[16:17] op_sel:[0,0] op_sel_hi:[0,1]
    v_pk_mul_f32 v[18:19], v[92:93], v[18:19] op_sel:[0,0] op_sel_hi:[0,1]
    v_pk_mul_f32 v[20:21], v[92:93], v[20:21] op_sel:[0,0] op_sel_hi:[0,1]
    v_pk_mul_f32 v[22:23], v[92:93], v[22:23] op_sel:[0,0] op_sel_hi:[0,1]
    v_pk_mul_f32 v[24:25], v[92:93], v[24:25] op_sel:[0,0] op_sel_hi:[0,1]
    v_pk_mul_f32 v[26:27], v[92:93], v[26:27] op_sel:[0,0] op_sel_hi:[0,1]
    v_pk_mul_f32 v[28:29], v[92:93], v[28:29] op_sel:[0,0] op_sel_hi:[0,1]
    v_pk_mul_f32 v[30:31], v[92:93], v[30:31] op_sel:[0,0] op_sel_hi:[0,1]
    v_cvt_pk_bf16_f32 v80, v16, v17
    v_cvt_pk_bf16_f32 v81, v18, v19
    v_cvt_pk_bf16_f32 v82, v20, v21
    v_cvt_pk_bf16_f32 v83, v22, v23
    v_cvt_pk_bf16_f32 v84, v24, v25
    v_cvt_pk_bf16_f32 v85, v26, v27
    v_cvt_pk_bf16_f32 v86, v28, v29
    v_cvt_pk_bf16_f32 v87, v30, v31
    v_dot2c_f32_bf16 v117, v80, v80
    v_dot2c_f32_bf16 v118, v84, v84
    v_dot2c_f32_bf16 v117, v81, v81
    v_dot2c_f32_bf16 v118, v85, v85
    v_dot2c_f32_bf16 v117, v82, v82
    v_dot2c_f32_bf16 v118, v86, v86
    v_dot2c_f32_bf16 v117, v83, v83
    v_dot2c_f32_bf16 v118, v87, v87
    s_nop 2
    v_permlane32_swap_b32 v117, v118
    s_nop 1
    v_add_f32 v117, v117, v118
    s_add_u32 s70, s89, 8192
    s_and_b32 s70, s70, 0xffff
    s_add_u32 m0, s63, 8192
    s_add_u32 s71, s70, 0
    buffer_load_dwordx4 v4, s[32:35], s71 offen sc1 lds
    s_add_u32 m0, s63, 73728
    s_add_u32 s71, s70, 65536
    buffer_load_dwordx4 v4, s[32:35], s71 offen sc1 lds
    s_mov_b32 s64, 0x20000
    buffer_load_dwordx4 v[8:11], v4, s[32:35], s64 offen sc1
    s_add_u32 s70, s89, 16384
    s_and_b32 s70, s70, 0xffff
    s_add_u32 m0, s63, 16384
    s_add_u32 s71, s70, 0
    buffer_load_dwordx4 v4, s[32:35], s71 offen sc1 lds
    s_add_u32 m0, s63, 81920
    s_add_u32 s71, s70, 65536
    buffer_load_dwordx4 v4, s[32:35], s71 offen sc1 lds
    s_waitcnt vmcnt(5)
    s_barrier
    ds_read_b128 v[88:91], v113
    ds_read_b128 v[92:95], v113 offset:2048
    s_mov_b64 exec, s[72:73]
    ds_read_b128 v[96:99], v114
    ds_read_b128 v[100:103], v114 offset:512
    s_mov_b64 exec, -1
    s_waitcnt lgkmcnt(3)
    v_mfma_f32_32x32x16_bf16 v[16:31], v[88:91], v[80:83], 0
    s_add_u32 s70, s89, 24576
    s_and_b32 s70, s70, 0xffff
    s_add_u32 m0, s63, 24576
    s_add_u32 s71, s70, 0
    buffer_load_dwordx4 v4, s[32:35], s71 offen sc1 lds
    s_add_u32 m0, s63, 90112
    s_add_u32 s71, s70, 65536
    buffer_load_dwordx4 v4, s[32:35], s71 offen sc1 lds
    s_nop 2
    s_setprio 3
    s_waitcnt lgkmcnt(0)
    v_exp_f32 v16, v16
    v_exp_f32 v17, v17
    v_exp_f32 v18, v18
    v_exp_f32 v19, v19
    v_exp_f32 v20, v20
    v_mfma_f32_32x32x16_bf16 v[32:47], v[88:91], v[84:87], 0
    v_exp_f32 v21, v21
    v_exp_f32 v22, v22
    v_exp_f32 v23, v23
    v_exp_f32 v24, v24
    v_exp_f32 v25, v25
    v_smfmac_f32_32x32x32_bf16 v[48:63], v[96:99], v[16:23], v112
    ds_read_b128 v[88:91], v113 offset:4096
    s_mov_b64 exec, s[72:73]
    ds_read_b128 v[104:107], v114 offset:2048
    ds_read_b128 v[108:111], v114 offset:2560
    s_mov_b64 exec, -1
    s_add_u32 s70, s89, 32768
    s_and_b32 s70, s70, 0xffff
    s_add_u32 m0, s63, 32768
    s_add_u32 s71, s70, 0
    buffer_load_dwordx4 v4, s[32:35], s71 offen sc1 lds
    s_add_u32 m0, s63, 98304
    s_add_u32 s71, s70, 65536
    buffer_load_dwordx4 v4, s[32:35], s71 offen sc1 lds
    v_exp_f32 v26, v26
    v_exp_f32 v27, v27
    v_exp_f32 v28, v28
    v_exp_f32 v29, v29
    v_exp_f32 v30, v30
    v_exp_f32 v31, v31
    v_exp_f32 v32, v32
    v_exp_f32 v33, v33
    v_smfmac_f32_32x32x32_bf16 v[48:63], v[100:103], v[24:31], v112
    v_exp_f32 v34, v34
    v_exp_f32 v35, v35
    v_exp_f32 v36, v36
    v_mfma_f32_32x32x16_bf16 v[16:31], v[92:95], v[80:83], 0
    v_exp_f32 v37, v37
    v_exp_f32 v38, v38
    v_exp_f32 v39, v39
    v_exp_f32 v40, v40
    v_exp_f32 v41, v41
    v_smfmac_f32_32x32x32_bf16 v[64:79], v[96:99], v[32:39], v112
    s_add_u32 s70, s89, 40960
    s_and_b32 s70, s70, 0xffff
    s_add_u32 m0, s63, 40960
    s_add_u32 s71, s70, 0
    buffer_load_dwordx4 v4, s[32:35], s71 offen sc1 lds
    s_add_u32 m0, s63, 106496
    s_add_u32 s71, s70, 65536
    buffer_load_dwordx4 v4, s[32:35], s71 offen sc1 lds
    v_exp_f32 v42, v42
    v_exp_f32 v43, v43
    v_exp_f32 v44, v44
    v_exp_f32 v45, v45
    v_exp_f32 v46, v46
    v_exp_f32 v47, v47
    s_waitcnt lgkmcnt(0)
    v_exp_f32 v16, v16
    v_exp_f32 v17, v17
    v_smfmac_f32_32x32x32_bf16 v[64:79], v[100:103], v[40:47], v112
    v_exp_f32 v18, v18
    v_exp_f32 v19, v19
    v_exp_f32 v20, v20
    v_mfma_f32_32x32x16_bf16 v[32:47], v[92:95], v[84:87], 0
    v_exp_f32 v21, v21
    v_exp_f32 v22, v22
    v_exp_f32 v23, v23
    v_exp_f32 v24, v24
    v_exp_f32 v25, v25
    v_smfmac_f32_32x32x32_bf16 v[48:63], v[104:107], v[16:23], v112
    ds_read_b128 v[92:95], v113 offset:6144
    s_mov_b64 exec, s[72:73]
    ds_read_b128 v[96:99], v114 offset:4096
    ds_read_b128 v[100:103], v114 offset:4608
    s_mov_b64 exec, -1
    s_add_u32 s70, s89, 49152
    s_and_b32 s70, s70, 0xffff
    s_add_u32 m0, s63, 49152
    s_add_u32 s71, s70, 0
    buffer_load_dwordx4 v4, s[32:35], s71 offen sc1 lds
    s_add_u32 m0, s63, 114688
    s_add_u32 s71, s70, 65536
    buffer_load_dwordx4 v4, s[32:35], s71 offen sc1 lds
    v_exp_f32 v26, v26
    v_exp_f32 v27, v27
    v_exp_f32 v28, v28
    v_exp_f32 v29, v29
    v_exp_f32 v30, v30
    v_exp_f32 v31, v31
    v_exp_f32 v32, v32
    v_exp_f32 v33, v33
    v_smfmac_f32_32x32x32_bf16 v[48:63], v[108:111], v[24:31], v112
    v_exp_f32 v34, v34
    v_exp_f32 v35, v35
    v_exp_f32 v36, v36
    v_mfma_f32_32x32x16_bf16 v[16:31], v[88:91], v[80:83], 0
    v_exp_f32 v37, v37
    v_exp_f32 v38, v38
    v_exp_f32 v39, v39
    v_exp_f32 v40, v40
    v_exp_f32 v41, v41
    v_smfmac_f32_32x32x32_bf16 v[64:79], v[104:107], v[32:39], v112
    s_add_u32 s70, s89, 57344
    s_and_b32 s70, s70, 0xffff
    s_add_u32 m0, s63, 57344
    s_add_u32 s71, s70, 0
    buffer_load_dwordx4 v4, s[32:35], s71 offen sc1 lds
    s_add_u32 m0, s63, 122880
    s_add_u32 s71, s70, 65536
    buffer_load_dwordx4 v4, s[32:35], s71 offen sc1 lds
    v_exp_f32 v42, v42
    v_exp_f32 v43, v43
    v_exp_f32 v44, v44
    v_exp_f32 v45, v45
    v_exp_f32 v46, v46
    v_exp_f32 v47, v47
    s_waitcnt vmcnt(10)
    v_max_u32 v12, v8, v9
    v_max_u32 v13, v10, v11
    s_nop 1
    v_permlane32_swap_b32 v12, v13
    s_nop 1
    v_max_u32 v12, v12, v13
    s_nop 1
    v_max_u32_dpp v12, v12, v12 row_ror:8 row_mask:0xf bank_mask:0xf
    s_nop 1
    v_max_u32_dpp v12, v12, v12 row_ror:4 row_mask:0xf bank_mask:0xf
    s_nop 1
    v_max_u32_dpp v12, v12, v12 row_ror:2 row_mask:0xf bank_mask:0xf
    s_nop 1
    v_max_u32_dpp v12, v12, v12 row_ror:1 row_mask:0xf bank_mask:0xf
    v_mov_b32 v13, 0x451c4000
    v_readlane_b32 s64, v12, 0
    v_readlane_b32 s66, v12, 16
    v_readlane_b32 s65, v12, 32
    v_readlane_b32 s67, v12, 48
    s_nop 3
    s_max_u32 s64, s64, s66
    s_max_u32 s65, s65, s67
    v_mul_f32 v117, s64, v117
    v_cmp_nle_f32 vcc, v117, v13
    s_cmp_gt_u32 s65, 0x7b800000
    s_cbranch_scc1 L_sequential_preLN__grouped_kv_mqa__dense_activation_gelu__prompt_kernel_fallback_26
    s_nop 2
    s_cmp_lg_u64 vcc, 0
    s_cbranch_scc1 L_sequential_preLN__grouped_kv_mqa__dense_activation_gelu__prompt_kernel_fallback_26
    s_barrier
    s_waitcnt lgkmcnt(0)
    v_exp_f32 v16, v16
    v_exp_f32 v17, v17
    v_smfmac_f32_32x32x32_bf16 v[64:79], v[108:111], v[40:47], v112
    v_exp_f32 v18, v18
    v_exp_f32 v19, v19
    v_exp_f32 v20, v20
    v_mfma_f32_32x32x16_bf16 v[32:47], v[88:91], v[84:87], 0
    v_exp_f32 v21, v21
    v_exp_f32 v22, v22
    v_exp_f32 v23, v23
    v_exp_f32 v24, v24
    v_exp_f32 v25, v25
    v_smfmac_f32_32x32x32_bf16 v[48:63], v[96:99], v[16:23], v112
    ds_read_b128 v[88:91], v113 offset:8192
    s_mov_b64 exec, s[72:73]
    ds_read_b128 v[104:107], v114 offset:6144
    ds_read_b128 v[108:111], v114 offset:6656
    s_mov_b64 exec, -1
    s_lshr_b32 s64, s2, 3
    s_lshl_b32 s65, s50, 5
    s_add_u32 s64, s64, s65
    s_lshl_b32 s64, s64, 13
    buffer_load_dword v2, v119, s[44:47], s64 offen
    s_lshl_b32 s64, s52, 3
    s_add_u32 s64, s64, s50
    s_mul_i32 s64, s64, 3072
    s_mov_b64 exec, 0xffffff
    buffer_load_dword v3, v119, s[36:39], s64 offen sc1
    s_mov_b64 exec, -1
    v_exp_f32 v26, v26
    v_exp_f32 v27, v27
    v_exp_f32 v28, v28
    v_exp_f32 v29, v29
    v_exp_f32 v30, v30
    v_exp_f32 v31, v31
    v_exp_f32 v32, v32
    v_exp_f32 v33, v33
    v_smfmac_f32_32x32x32_bf16 v[48:63], v[100:103], v[24:31], v112
    v_exp_f32 v34, v34
    v_exp_f32 v35, v35
    v_exp_f32 v36, v36
    v_mfma_f32_32x32x16_bf16 v[16:31], v[92:95], v[80:83], 0
    v_exp_f32 v37, v37
    v_exp_f32 v38, v38
    v_exp_f32 v39, v39
    v_exp_f32 v40, v40
    v_exp_f32 v41, v41
    v_smfmac_f32_32x32x32_bf16 v[64:79], v[96:99], v[32:39], v112
    v_exp_f32 v42, v42
    v_exp_f32 v43, v43
    v_exp_f32 v44, v44
    v_exp_f32 v45, v45
    v_exp_f32 v46, v46
    v_exp_f32 v47, v47
    s_waitcnt lgkmcnt(0)
    v_exp_f32 v16, v16
    v_exp_f32 v17, v17
    v_smfmac_f32_32x32x32_bf16 v[64:79], v[100:103], v[40:47], v112
    v_exp_f32 v18, v18
    v_exp_f32 v19, v19
    v_exp_f32 v20, v20
    v_mfma_f32_32x32x16_bf16 v[32:47], v[92:95], v[84:87], 0
    v_exp_f32 v21, v21
    v_exp_f32 v22, v22
    v_exp_f32 v23, v23
    v_exp_f32 v24, v24
    v_exp_f32 v25, v25
    v_smfmac_f32_32x32x32_bf16 v[48:63], v[104:107], v[16:23], v112
    ds_read_b128 v[92:95], v113 offset:10240
    s_mov_b64 exec, s[72:73]
    ds_read_b128 v[96:99], v114 offset:8192
    ds_read_b128 v[100:103], v114 offset:8704
    s_mov_b64 exec, -1
    s_lshl_b32 s64, s50, 2
    v_mov_b32 v12, s64
    v_mov_b32 v13, 0
    ds_write_b32 v12, v13
    v_exp_f32 v26, v26
    v_exp_f32 v27, v27
    v_exp_f32 v28, v28
    v_exp_f32 v29, v29
    v_exp_f32 v30, v30
    v_exp_f32 v31, v31
    v_exp_f32 v32, v32
    v_exp_f32 v33, v33
    v_smfmac_f32_32x32x32_bf16 v[48:63], v[108:111], v[24:31], v112
    v_exp_f32 v34, v34
    v_exp_f32 v35, v35
    v_exp_f32 v36, v36
    v_mfma_f32_32x32x16_bf16 v[16:31], v[88:91], v[80:83], 0
    v_exp_f32 v37, v37
    v_exp_f32 v38, v38
    v_exp_f32 v39, v39
    v_exp_f32 v40, v40
    v_exp_f32 v41, v41
    v_smfmac_f32_32x32x32_bf16 v[64:79], v[104:107], v[32:39], v112
    v_exp_f32 v42, v42
    v_exp_f32 v43, v43
    v_exp_f32 v44, v44
    v_exp_f32 v45, v45
    v_exp_f32 v46, v46
    v_exp_f32 v47, v47
    s_waitcnt lgkmcnt(0)
    v_exp_f32 v16, v16
    v_exp_f32 v17, v17
    v_smfmac_f32_32x32x32_bf16 v[64:79], v[108:111], v[40:47], v112
    v_exp_f32 v18, v18
    v_exp_f32 v19, v19
    v_exp_f32 v20, v20
    v_mfma_f32_32x32x16_bf16 v[32:47], v[88:91], v[84:87], 0
    v_exp_f32 v21, v21
    v_exp_f32 v22, v22
    v_exp_f32 v23, v23
    v_exp_f32 v24, v24
    v_exp_f32 v25, v25
    v_smfmac_f32_32x32x32_bf16 v[48:63], v[96:99], v[16:23], v112
    ds_read_b128 v[88:91], v113 offset:12288
    s_mov_b64 exec, s[72:73]
    ds_read_b128 v[104:107], v114 offset:10240
    ds_read_b128 v[108:111], v114 offset:10752
    s_mov_b64 exec, -1
    s_cmp_ge_u32 s52, 3
    s_cselect_b32 s64, s53, 0
    s_and_b32 s64, s64, s54
    s_cselect_b32 s46, 0, s46
    v_exp_f32 v26, v26
    v_exp_f32 v27, v27
    v_exp_f32 v28, v28
    v_exp_f32 v29, v29
    v_exp_f32 v30, v30
    v_exp_f32 v31, v31
    v_exp_f32 v32, v32
    v_exp_f32 v33, v33
    v_smfmac_f32_32x32x32_bf16 v[48:63], v[100:103], v[24:31], v112
    v_exp_f32 v34, v34
    v_exp_f32 v35, v35
    v_exp_f32 v36, v36
    v_mfma_f32_32x32x16_bf16 v[16:31], v[92:95], v[80:83], 0
    v_exp_f32 v37, v37
    v_exp_f32 v38, v38
    v_exp_f32 v39, v39
    v_exp_f32 v40, v40
    v_exp_f32 v41, v41
    v_smfmac_f32_32x32x32_bf16 v[64:79], v[96:99], v[32:39], v112
    v_exp_f32 v42, v42
    v_exp_f32 v43, v43
    v_exp_f32 v44, v44
    v_exp_f32 v45, v45
    v_exp_f32 v46, v46
    v_exp_f32 v47, v47
    s_waitcnt lgkmcnt(0)
    v_exp_f32 v16, v16
    v_exp_f32 v17, v17
    v_smfmac_f32_32x32x32_bf16 v[64:79], v[100:103], v[40:47], v112
    v_exp_f32 v18, v18
    v_exp_f32 v19, v19
    v_exp_f32 v20, v20
    v_mfma_f32_32x32x16_bf16 v[32:47], v[92:95], v[84:87], 0
    v_exp_f32 v21, v21
    v_exp_f32 v22, v22
    v_exp_f32 v23, v23
    v_exp_f32 v24, v24
    v_exp_f32 v25, v25
    v_smfmac_f32_32x32x32_bf16 v[48:63], v[104:107], v[16:23], v112
    ds_read_b128 v[92:95], v113 offset:14336
    s_mov_b64 exec, s[72:73]
    ds_read_b128 v[96:99], v114 offset:12288
    ds_read_b128 v[100:103], v114 offset:12800
    s_mov_b64 exec, -1
    v_exp_f32 v26, v26
    v_exp_f32 v27, v27
    v_exp_f32 v28, v28
    v_exp_f32 v29, v29
    v_exp_f32 v30, v30
    v_exp_f32 v31, v31
    v_exp_f32 v32, v32
    v_exp_f32 v33, v33
    v_smfmac_f32_32x32x32_bf16 v[48:63], v[108:111], v[24:31], v112
    v_exp_f32 v34, v34
    v_exp_f32 v35, v35
    v_exp_f32 v36, v36
    v_mfma_f32_32x32x16_bf16 v[16:31], v[88:91], v[80:83], 0
    v_exp_f32 v37, v37
    v_exp_f32 v38, v38
    v_exp_f32 v39, v39
    v_exp_f32 v40, v40
    v_exp_f32 v41, v41
    v_smfmac_f32_32x32x32_bf16 v[64:79], v[104:107], v[32:39], v112
    v_exp_f32 v42, v42
    v_exp_f32 v43, v43
    v_exp_f32 v44, v44
    v_exp_f32 v45, v45
    v_exp_f32 v46, v46
    v_exp_f32 v47, v47
    s_waitcnt vmcnt(2) lgkmcnt(0)
    s_barrier
    s_waitcnt lgkmcnt(0)
    v_exp_f32 v16, v16
    v_exp_f32 v17, v17
    v_smfmac_f32_32x32x32_bf16 v[64:79], v[108:111], v[40:47], v112
    v_exp_f32 v18, v18
    v_exp_f32 v19, v19
    v_exp_f32 v20, v20
    v_mfma_f32_32x32x16_bf16 v[32:47], v[88:91], v[84:87], 0
    v_exp_f32 v21, v21
    v_exp_f32 v22, v22
    v_exp_f32 v23, v23
    v_exp_f32 v24, v24
    v_exp_f32 v25, v25
    v_smfmac_f32_32x32x32_bf16 v[48:63], v[96:99], v[16:23], v112
    ds_read_b128 v[88:91], v113 offset:16384
    s_mov_b64 exec, s[72:73]
    ds_read_b128 v[104:107], v114 offset:14336
    ds_read_b128 v[108:111], v114 offset:14848
    s_mov_b64 exec, -1
    v_exp_f32 v26, v26
    v_exp_f32 v27, v27
    v_exp_f32 v28, v28
    v_exp_f32 v29, v29
    v_exp_f32 v30, v30
    v_exp_f32 v31, v31
    v_exp_f32 v32, v32
    v_exp_f32 v33, v33
    v_smfmac_f32_32x32x32_bf16 v[48:63], v[100:103], v[24:31], v112
    v_exp_f32 v34, v34
    v_exp_f32 v35, v35
    v_exp_f32 v36, v36
    v_mfma_f32_32x32x16_bf16 v[16:31], v[92:95], v[80:83], 0
    v_exp_f32 v37, v37
    v_exp_f32 v38, v38
    v_exp_f32 v39, v39
    v_exp_f32 v40, v40
    v_exp_f32 v41, v41
    v_smfmac_f32_32x32x32_bf16 v[64:79], v[96:99], v[32:39], v112
    buffer_load_dwordx4 v[8:11], v7, s[40:43], s60 offen
    v_min_u32 v12, 2688, v119
    v_min_u32 v13, 896, v119
    global_load_dword v2, v12, s[18:19]
    global_load_dword v2, v13, s[22:23]
    s_cmp_lg_u32 s50, 7
    s_cbranch_scc1 L_sequential_preLN__grouped_kv_mqa__dense_activation_gelu__prompt_kernel_noz_28
    v_lshrrev_b32 v14, 3, v1
    v_and_b32 v15, 7, v1
    v_lshlrev_b32 v15, 2, v15
    v_lshl_add_u32 v14, v14, 8, v15
    v_mov_b32 v15, 0
    s_sub_u32 s64, s61, 28
    s_mov_b32 exec_hi, 0
    buffer_store_dword v15, v14, s[36:39], s64 offen sc1
    s_mov_b64 exec, -1
L_sequential_preLN__grouped_kv_mqa__dense_activation_gelu__prompt_kernel_noz_28:
    v_exp_f32 v42, v42
    v_exp_f32 v43, v43
    v_exp_f32 v44, v44
    v_exp_f32 v45, v45
    v_exp_f32 v46, v46
    v_exp_f32 v47, v47
    s_waitcnt lgkmcnt(0)
    v_exp_f32 v16, v16
    v_exp_f32 v17, v17
    v_smfmac_f32_32x32x32_bf16 v[64:79], v[100:103], v[40:47], v112
    v_exp_f32 v18, v18
    v_exp_f32 v19, v19
    v_exp_f32 v20, v20
    v_mfma_f32_32x32x16_bf16 v[32:47], v[92:95], v[84:87], 0
    v_exp_f32 v21, v21
    v_exp_f32 v22, v22
    v_exp_f32 v23, v23
    v_exp_f32 v24, v24
    v_exp_f32 v25, v25
    v_smfmac_f32_32x32x32_bf16 v[48:63], v[104:107], v[16:23], v112
    ds_read_b128 v[92:95], v113 offset:18432
    s_mov_b64 exec, s[72:73]
    ds_read_b128 v[96:99], v114 offset:16384
    ds_read_b128 v[100:103], v114 offset:16896
    s_mov_b64 exec, -1
    v_exp_f32 v26, v26
    v_exp_f32 v27, v27
    v_exp_f32 v28, v28
    v_exp_f32 v29, v29
    v_exp_f32 v30, v30
    v_exp_f32 v31, v31
    v_exp_f32 v32, v32
    v_exp_f32 v33, v33
    v_smfmac_f32_32x32x32_bf16 v[48:63], v[108:111], v[24:31], v112
    v_exp_f32 v34, v34
    v_exp_f32 v35, v35
    v_exp_f32 v36, v36
    v_mfma_f32_32x32x16_bf16 v[16:31], v[88:91], v[80:83], 0
    v_exp_f32 v37, v37
    v_exp_f32 v38, v38
    v_exp_f32 v39, v39
    v_exp_f32 v40, v40
    v_exp_f32 v41, v41
    v_smfmac_f32_32x32x32_bf16 v[64:79], v[104:107], v[32:39], v112
    v_exp_f32 v42, v42
    v_exp_f32 v43, v43
    v_exp_f32 v44, v44
    v_exp_f32 v45, v45
    v_exp_f32 v46, v46
    v_exp_f32 v47, v47
    s_waitcnt lgkmcnt(0)
    v_exp_f32 v16, v16
    v_exp_f32 v17, v17
    v_smfmac_f32_32x32x32_bf16 v[64:79], v[108:111], v[40:47], v112
    v_exp_f32 v18, v18
    v_exp_f32 v19, v19
    v_exp_f32 v20, v20
    v_mfma_f32_32x32x16_bf16 v[32:47], v[88:91], v[84:87], 0
    v_exp_f32 v21, v21
    v_exp_f32 v22, v22
    v_exp_f32 v23, v23
    v_exp_f32 v24, v24
    v_exp_f32 v25, v25
    v_smfmac_f32_32x32x32_bf16 v[48:63], v[96:99], v[16:23], v112
    ds_read_b128 v[88:91], v113 offset:20480
    s_mov_b64 exec, s[72:73]
    ds_read_b128 v[104:107], v114 offset:18432
    ds_read_b128 v[108:111], v114 offset:18944
    s_mov_b64 exec, -1
    v_exp_f32 v26, v26
    v_exp_f32 v27, v27
    v_exp_f32 v28, v28
    v_exp_f32 v29, v29
    v_exp_f32 v30, v30
    v_exp_f32 v31, v31
    v_exp_f32 v32, v32
    v_exp_f32 v33, v33
    v_smfmac_f32_32x32x32_bf16 v[48:63], v[100:103], v[24:31], v112
    v_exp_f32 v34, v34
    v_exp_f32 v35, v35
    v_exp_f32 v36, v36
    v_mfma_f32_32x32x16_bf16 v[16:31], v[92:95], v[80:83], 0
    v_exp_f32 v37, v37
    v_exp_f32 v38, v38
    v_exp_f32 v39, v39
    v_exp_f32 v40, v40
    v_exp_f32 v41, v41
    v_smfmac_f32_32x32x32_bf16 v[64:79], v[96:99], v[32:39], v112
    v_exp_f32 v42, v42
    v_exp_f32 v43, v43
    v_exp_f32 v44, v44
    v_exp_f32 v45, v45
    v_exp_f32 v46, v46
    v_exp_f32 v47, v47
    s_waitcnt lgkmcnt(0)
    v_exp_f32 v16, v16
    v_exp_f32 v17, v17
    v_smfmac_f32_32x32x32_bf16 v[64:79], v[100:103], v[40:47], v112
    v_exp_f32 v18, v18
    v_exp_f32 v19, v19
    v_exp_f32 v20, v20
    v_mfma_f32_32x32x16_bf16 v[32:47], v[92:95], v[84:87], 0
    v_exp_f32 v21, v21
    v_exp_f32 v22, v22
    v_exp_f32 v23, v23
    v_exp_f32 v24, v24
    v_exp_f32 v25, v25
    v_smfmac_f32_32x32x32_bf16 v[48:63], v[104:107], v[16:23], v112
    ds_read_b128 v[92:95], v113 offset:22528
    s_mov_b64 exec, s[72:73]
    ds_read_b128 v[96:99], v114 offset:20480
    ds_read_b128 v[100:103], v114 offset:20992
    s_mov_b64 exec, -1
    v_exp_f32 v26, v26
    v_exp_f32 v27, v27
    v_exp_f32 v28, v28
    v_exp_f32 v29, v29
    v_exp_f32 v30, v30
    v_exp_f32 v31, v31
    v_exp_f32 v32, v32
    v_exp_f32 v33, v33
    v_smfmac_f32_32x32x32_bf16 v[48:63], v[108:111], v[24:31], v112
    v_exp_f32 v34, v34
    v_exp_f32 v35, v35
    v_exp_f32 v36, v36
    v_mfma_f32_32x32x16_bf16 v[16:31], v[88:91], v[80:83], 0
    v_exp_f32 v37, v37
    v_exp_f32 v38, v38
    v_exp_f32 v39, v39
    v_exp_f32 v40, v40
    v_exp_f32 v41, v41
    v_smfmac_f32_32x32x32_bf16 v[64:79], v[104:107], v[32:39], v112
    v_exp_f32 v42, v42
    v_exp_f32 v43, v43
    v_exp_f32 v44, v44
    v_exp_f32 v45, v45
    v_exp_f32 v46, v46
    v_exp_f32 v47, v47
    s_waitcnt lgkmcnt(0)
    v_exp_f32 v16, v16
    v_exp_f32 v17, v17
    v_smfmac_f32_32x32x32_bf16 v[64:79], v[108:111], v[40:47], v112
    v_exp_f32 v18, v18
    v_exp_f32 v19, v19
    v_exp_f32 v20, v20
    v_mfma_f32_32x32x16_bf16 v[32:47], v[88:91], v[84:87], 0
    v_exp_f32 v21, v21
    v_exp_f32 v22, v22
    v_exp_f32 v23, v23
    v_exp_f32 v24, v24
    v_exp_f32 v25, v25
    v_smfmac_f32_32x32x32_bf16 v[48:63], v[96:99], v[16:23], v112
    ds_read_b128 v[88:91], v113 offset:24576
    s_mov_b64 exec, s[72:73]
    ds_read_b128 v[104:107], v114 offset:22528
    ds_read_b128 v[108:111], v114 offset:23040
    s_mov_b64 exec, -1
    v_exp_f32 v26, v26
    v_exp_f32 v27, v27
    v_exp_f32 v28, v28
    v_exp_f32 v29, v29
    v_exp_f32 v30, v30
    v_exp_f32 v31, v31
    v_exp_f32 v32, v32
    v_exp_f32 v33, v33
    v_smfmac_f32_32x32x32_bf16 v[48:63], v[100:103], v[24:31], v112
    v_exp_f32 v34, v34
    v_exp_f32 v35, v35
    v_exp_f32 v36, v36
    v_mfma_f32_32x32x16_bf16 v[16:31], v[92:95], v[80:83], 0
    v_exp_f32 v37, v37
    v_exp_f32 v38, v38
    v_exp_f32 v39, v39
    v_exp_f32 v40, v40
    v_exp_f32 v41, v41
    v_smfmac_f32_32x32x32_bf16 v[64:79], v[96:99], v[32:39], v112
    v_exp_f32 v42, v42
    v_exp_f32 v43, v43
    v_exp_f32 v44, v44
    v_exp_f32 v45, v45
    v_exp_f32 v46, v46
    v_exp_f32 v47, v47
    s_waitcnt lgkmcnt(0)
    v_exp_f32 v16, v16
    v_exp_f32 v17, v17
    v_smfmac_f32_32x32x32_bf16 v[64:79], v[100:103], v[40:47], v112
    v_exp_f32 v18, v18
    v_exp_f32 v19, v19
    v_exp_f32 v20, v20
    v_mfma_f32_32x32x16_bf16 v[32:47], v[92:95], v[84:87], 0
    v_exp_f32 v21, v21
    v_exp_f32 v22, v22
    v_exp_f32 v23, v23
    v_exp_f32 v24, v24
    v_exp_f32 v25, v25
    v_smfmac_f32_32x32x32_bf16 v[48:63], v[104:107], v[16:23], v112
    ds_read_b128 v[92:95], v113 offset:26624
    s_mov_b64 exec, s[72:73]
    ds_read_b128 v[96:99], v114 offset:24576
    ds_read_b128 v[100:103], v114 offset:25088
    s_mov_b64 exec, -1
    s_add_u32 m0, s75, 0
    s_add_u32 s71, s74, 0
    buffer_load_dwordx4 v115, s[44:47], s71 offen  lds
    s_add_u32 m0, s75, 1024
    s_add_u32 s71, s74, 44032
    buffer_load_dwordx4 v115, s[44:47], s71 offen  lds
    v_exp_f32 v26, v26
    v_exp_f32 v27, v27
    v_exp_f32 v28, v28
    v_exp_f32 v29, v29
    v_exp_f32 v30, v30
    v_exp_f32 v31, v31
    v_exp_f32 v32, v32
    v_exp_f32 v33, v33
    v_smfmac_f32_32x32x32_bf16 v[48:63], v[108:111], v[24:31], v112
    v_exp_f32 v34, v34
    v_exp_f32 v35, v35
    v_exp_f32 v36, v36
    v_mfma_f32_32x32x16_bf16 v[16:31], v[88:91], v[80:83], 0
    v_exp_f32 v37, v37
    v_exp_f32 v38, v38
    v_exp_f32 v39, v39
    v_exp_f32 v40, v40
    v_exp_f32 v41, v41
    v_smfmac_f32_32x32x32_bf16 v[64:79], v[104:107], v[32:39], v112
    v_exp_f32 v42, v42
    v_exp_f32 v43, v43
    v_exp_f32 v44, v44
    v_exp_f32 v45, v45
    v_exp_f32 v46, v46
    v_exp_f32 v47, v47
    s_waitcnt lgkmcnt(0)
    v_exp_f32 v16, v16
    v_exp_f32 v17, v17
    v_smfmac_f32_32x32x32_bf16 v[64:79], v[108:111], v[40:47], v112
    v_exp_f32 v18, v18
    v_exp_f32 v19, v19
    v_exp_f32 v20, v20
    v_mfma_f32_32x32x16_bf16 v[32:47], v[88:91], v[84:87], 0
    v_exp_f32 v21, v21
    v_exp_f32 v22, v22
    v_exp_f32 v23, v23
    v_exp_f32 v24, v24
    v_exp_f32 v25, v25
    v_smfmac_f32_32x32x32_bf16 v[48:63], v[96:99], v[16:23], v112
    ds_read_b128 v[88:91], v113 offset:28672
    s_mov_b64 exec, s[72:73]
    ds_read_b128 v[104:107], v114 offset:26624
    ds_read_b128 v[108:111], v114 offset:27136
    s_mov_b64 exec, -1
    s_add_u32 m0, s75, 2048
    s_add_u32 s71, s74, 88064
    buffer_load_dwordx4 v115, s[44:47], s71 offen  lds
    s_add_u32 m0, s75, 3072
    s_add_u32 s71, s74, 132096
    buffer_load_dwordx4 v115, s[44:47], s71 offen  lds
    v_exp_f32 v26, v26
    v_exp_f32 v27, v27
    v_exp_f32 v28, v28
    v_exp_f32 v29, v29
    v_exp_f32 v30, v30
    v_exp_f32 v31, v31
    v_exp_f32 v32, v32
    v_exp_f32 v33, v33
    v_smfmac_f32_32x32x32_bf16 v[48:63], v[100:103], v[24:31], v112
    v_exp_f32 v34, v34
    v_exp_f32 v35, v35
    v_exp_f32 v36, v36
    v_mfma_f32_32x32x16_bf16 v[16:31], v[92:95], v[80:83], 0
    v_exp_f32 v37, v37
    v_exp_f32 v38, v38
    v_exp_f32 v39, v39
    v_exp_f32 v40, v40
    v_exp_f32 v41, v41
    v_smfmac_f32_32x32x32_bf16 v[64:79], v[96:99], v[32:39], v112
    v_exp_f32 v42, v42
    v_exp_f32 v43, v43
    v_exp_f32 v44, v44
    v_exp_f32 v45, v45
    v_exp_f32 v46, v46
    v_exp_f32 v47, v47
    s_waitcnt lgkmcnt(0)
    v_exp_f32 v16, v16
    v_exp_f32 v17, v17
    v_smfmac_f32_32x32x32_bf16 v[64:79], v[100:103], v[40:47], v112
    v_exp_f32 v18, v18
    v_exp_f32 v19, v19
    v_exp_f32 v20, v20
    v_mfma_f32_32x32x16_bf16 v[32:47], v[92:95], v[84:87], 0
    v_exp_f32 v21, v21
    v_exp_f32 v22, v22
    v_exp_f32 v23, v23
    v_exp_f32 v24, v24
    v_exp_f32 v25, v25
    v_smfmac_f32_32x32x32_bf16 v[48:63], v[104:107], v[16:23], v112
    ds_read_b128 v[92:95], v113 offset:30720
    s_mov_b64 exec, s[72:73]
    ds_read_b128 v[96:99], v114 offset:28672
    ds_read_b128 v[100:103], v114 offset:29184
    s_mov_b64 exec, -1
    s_lshr_b32 s64, s2, 3
    s_lshl_b32 s65, s50, 5
    s_add_u32 s64, s64, s65
    s_lshl_b32 s64, s64, 13
    buffer_load_dword v2, v119, s[84:87], s64 offen
    v_exp_f32 v26, v26
    v_exp_f32 v27, v27
    v_exp_f32 v28, v28
    v_exp_f32 v29, v29
    v_exp_f32 v30, v30
    v_exp_f32 v31, v31
    v_exp_f32 v32, v32
    v_exp_f32 v33, v33
    v_smfmac_f32_32x32x32_bf16 v[48:63], v[108:111], v[24:31], v112
    v_exp_f32 v34, v34
    v_exp_f32 v35, v35
    v_exp_f32 v36, v36
    v_mfma_f32_32x32x16_bf16 v[16:31], v[88:91], v[80:83], 0
    v_exp_f32 v37, v37
    v_exp_f32 v38, v38
    v_exp_f32 v39, v39
    v_exp_f32 v40, v40
    v_exp_f32 v41, v41
    v_smfmac_f32_32x32x32_bf16 v[64:79], v[104:107], v[32:39], v112
    s_waitcnt vmcnt(3)
    ds_read_b64_tr_b16 a[0:1], v116 offset:0
    ds_read_b64_tr_b16 a[2:3], v116 offset:512
    ds_read_b64_tr_b16 a[4:5], v116 offset:1024
    ds_read_b64_tr_b16 a[6:7], v116 offset:1536
    s_cmp_lg_u32 s50, 7
    s_cbranch_scc1 L_sequential_preLN__grouped_kv_mqa__dense_activation_gelu__prompt_kernel_noat_29
    s_getreg_b32 s64, hwreg(HW_REG_XCC_ID, 0, 4)
    s_lshl_b32 s64, 1, s64
    s_add_u32 s65, s52, 16
    s_lshl_b32 s65, 1, s65
    s_or_b32 s64, s64, s65
    s_lshl_b32 s65, s51, 2
    v_mov_b32 v14, s65
    v_mov_b32 v15, s64
    s_mov_b64 exec, 1
    global_atomic_or v14, v15, s[26:27] offset:4 sc1
    s_mov_b64 exec, -1
L_sequential_preLN__grouped_kv_mqa__dense_activation_gelu__prompt_kernel_noat_29:
    v_exp_f32 v42, v42
    v_exp_f32 v43, v43
    v_exp_f32 v44, v44
    v_exp_f32 v45, v45
    v_exp_f32 v46, v46
    v_exp_f32 v47, v47
    s_waitcnt lgkmcnt(0)
    s_add_u32 m0, s75, 0
    s_add_u32 s71, s74, 176128
    buffer_load_dwordx4 v115, s[44:47], s71 offen  lds
    s_add_u32 m0, s75, 1024
    s_add_u32 s71, s74, 220160
    buffer_load_dwordx4 v115, s[44:47], s71 offen  lds
    v_exp_f32 v16, v16
    v_exp_f32 v17, v17
    v_smfmac_f32_32x32x32_bf16 v[64:79], v[108:111], v[40:47], v112
    v_exp_f32 v18, v18
    v_exp_f32 v19, v19
    v_exp_f32 v20, v20
    v_mfma_f32_32x32x16_bf16 v[32:47], v[88:91], v[84:87], 0
    v_exp_f32 v21, v21
    v_exp_f32 v22, v22
    v_exp_f32 v23, v23
    v_exp_f32 v24, v24
    v_exp_f32 v25, v25
    v_smfmac_f32_32x32x32_bf16 v[48:63], v[96:99], v[16:23], v112
    ds_read_b128 v[88:91], v113 offset:32768
    s_mov_b64 exec, s[72:73]
    ds_read_b128 v[104:107], v114 offset:30720
    ds_read_b128 v[108:111], v114 offset:31232
    s_mov_b64 exec, -1
    v_exp_f32 v26, v26
    v_exp_f32 v27, v27
    v_exp_f32 v28, v28
    v_exp_f32 v29, v29
    v_exp_f32 v30, v30
    v_exp_f32 v31, v31
    v_exp_f32 v32, v32
    v_exp_f32 v33, v33
    v_smfmac_f32_32x32x32_bf16 v[48:63], v[100:103], v[24:31], v112
    v_exp_f32 v34, v34
    v_exp_f32 v35, v35
    v_exp_f32 v36, v36
    v_mfma_f32_32x32x16_bf16 v[16:31], v[92:95], v[80:83], 0
    v_exp_f32 v37, v37
    v_exp_f32 v38, v38
    v_exp_f32 v39, v39
    v_exp_f32 v40, v40
    v_exp_f32 v41, v41
    v_smfmac_f32_32x32x32_bf16 v[64:79], v[96:99], v[32:39], v112
    s_waitcnt vmcnt(3)
    ds_read_b64_tr_b16 a[8:9], v116 offset:2048
    ds_read_b64_tr_b16 a[10:11], v116 offset:2560
    ds_read_b64_tr_b16 a[12:13], v116 offset:3072
    ds_read_b64_tr_b16 a[14:15], v116 offset:3584
    v_exp_f32 v42, v42
    v_exp_f32 v43, v43
    v_exp_f32 v44, v44
    v_exp_f32 v45, v45
    v_exp_f32 v46, v46
    v_exp_f32 v47, v47
    s_waitcnt lgkmcnt(0)
    s_add_u32 m0, s75, 2048
    s_add_u32 s71, s74, 264192
    buffer_load_dwordx4 v115, s[44:47], s71 offen  lds
    s_add_u32 m0, s75, 3072
    s_add_u32 s71, s74, 308224
    buffer_load_dwordx4 v115, s[44:47], s71 offen  lds
    v_exp_f32 v16, v16
    v_exp_f32 v17, v17
    v_smfmac_f32_32x32x32_bf16 v[64:79], v[100:103], v[40:47], v112
    v_exp_f32 v18, v18
    v_exp_f32 v19, v19
    v_exp_f32 v20, v20
    v_mfma_f32_32x32x16_bf16 v[32:47], v[92:95], v[84:87], 0
    v_exp_f32 v21, v21
    v_exp_f32 v22, v22
    v_exp_f32 v23, v23
    v_exp_f32 v24, v24
    v_exp_f32 v25, v25
    v_smfmac_f32_32x32x32_bf16 v[48:63], v[104:107], v[16:23], v112
    ds_read_b128 v[92:95], v113 offset:34816
    s_mov_b64 exec, s[72:73]
    ds_read_b128 v[96:99], v114 offset:32768
    ds_read_b128 v[100:103], v114 offset:33280
    s_mov_b64 exec, -1
    v_exp_f32 v26, v26
    v_exp_f32 v27, v27
    v_exp_f32 v28, v28
    v_exp_f32 v29, v29
    v_exp_f32 v30, v30
    v_exp_f32 v31, v31
    v_exp_f32 v32, v32
    v_exp_f32 v33, v33
    v_smfmac_f32_32x32x32_bf16 v[48:63], v[108:111], v[24:31], v112
    v_exp_f32 v34, v34
    v_exp_f32 v35, v35
    v_exp_f32 v36, v36
    v_mfma_f32_32x32x16_bf16 v[16:31], v[88:91], v[80:83], 0
    v_exp_f32 v37, v37
    v_exp_f32 v38, v38
    v_exp_f32 v39, v39
    v_exp_f32 v40, v40
    v_exp_f32 v41, v41
    v_smfmac_f32_32x32x32_bf16 v[64:79], v[104:107], v[32:39], v112
    s_waitcnt vmcnt(2)
    ds_read_b64_tr_b16 a[16:17], v116 offset:0
    ds_read_b64_tr_b16 a[18:19], v116 offset:512
    ds_read_b64_tr_b16 a[20:21], v116 offset:1024
    ds_read_b64_tr_b16 a[22:23], v116 offset:1536
    v_exp_f32 v42, v42
    v_exp_f32 v43, v43
    v_exp_f32 v44, v44
    v_exp_f32 v45, v45
    v_exp_f32 v46, v46
    v_exp_f32 v47, v47
    s_waitcnt lgkmcnt(0)
    s_add_u32 m0, s75, 0
    s_add_u32 s71, s74, 352256
    buffer_load_dwordx4 v115, s[44:47], s71 offen  lds
    s_add_u32 m0, s75, 1024
    s_add_u32 s71, s74, 396288
    buffer_load_dwordx4 v115, s[44:47], s71 offen  lds
    v_exp_f32 v16, v16
    v_exp_f32 v17, v17
    v_smfmac_f32_32x32x32_bf16 v[64:79], v[108:111], v[40:47], v112
    v_exp_f32 v18, v18
    v_exp_f32 v19, v19
    v_exp_f32 v20, v20
    v_mfma_f32_32x32x16_bf16 v[32:47], v[88:91], v[84:87], 0
    v_exp_f32 v21, v21
    v_exp_f32 v22, v22
    v_exp_f32 v23, v23
    v_exp_f32 v24, v24
    v_exp_f32 v25, v25
    v_smfmac_f32_32x32x32_bf16 v[48:63], v[96:99], v[16:23], v112
    ds_read_b128 v[88:91], v113 offset:36864
    s_mov_b64 exec, s[72:73]
    ds_read_b128 v[104:107], v114 offset:34816
    ds_read_b128 v[108:111], v114 offset:35328
    s_mov_b64 exec, -1
    v_exp_f32 v26, v26
    v_exp_f32 v27, v27
    v_exp_f32 v28, v28
    v_exp_f32 v29, v29
    v_exp_f32 v30, v30
    v_exp_f32 v31, v31
    v_exp_f32 v32, v32
    v_exp_f32 v33, v33
    v_smfmac_f32_32x32x32_bf16 v[48:63], v[100:103], v[24:31], v112
    v_exp_f32 v34, v34
    v_exp_f32 v35, v35
    v_exp_f32 v36, v36
    v_mfma_f32_32x32x16_bf16 v[16:31], v[92:95], v[80:83], 0
    v_exp_f32 v37, v37
    v_exp_f32 v38, v38
    v_exp_f32 v39, v39
    v_exp_f32 v40, v40
    v_exp_f32 v41, v41
    v_smfmac_f32_32x32x32_bf16 v[64:79], v[96:99], v[32:39], v112
    s_waitcnt vmcnt(2)
    ds_read_b64_tr_b16 a[24:25], v116 offset:2048
    ds_read_b64_tr_b16 a[26:27], v116 offset:2560
    ds_read_b64_tr_b16 a[28:29], v116 offset:3072
    ds_read_b64_tr_b16 a[30:31], v116 offset:3584
    v_exp_f32 v42, v42
    v_exp_f32 v43, v43
    v_exp_f32 v44, v44
    v_exp_f32 v45, v45
    v_exp_f32 v46, v46
    v_exp_f32 v47, v47
    s_waitcnt lgkmcnt(0)
    s_add_u32 m0, s75, 2048
    s_add_u32 s71, s74, 440320
    buffer_load_dwordx4 v115, s[44:47], s71 offen  lds
    s_add_u32 m0, s75, 3072
    s_add_u32 s71, s74, 484352
    buffer_load_dwordx4 v115, s[44:47], s71 offen  lds
    v_exp_f32 v16, v16
    v_exp_f32 v17, v17
    v_smfmac_f32_32x32x32_bf16 v[64:79], v[100:103], v[40:47], v112
    v_exp_f32 v18, v18
    v_exp_f32 v19, v19
    v_exp_f32 v20, v20
    v_mfma_f32_32x32x16_bf16 v[32:47], v[92:95], v[84:87], 0
    v_exp_f32 v21, v21
    v_exp_f32 v22, v22
    v_exp_f32 v23, v23
    v_exp_f32 v24, v24
    v_exp_f32 v25, v25
    v_smfmac_f32_32x32x32_bf16 v[48:63], v[104:107], v[16:23], v112
    ds_read_b128 v[92:95], v113 offset:38912
    s_mov_b64 exec, s[72:73]
    ds_read_b128 v[96:99], v114 offset:36864
    ds_read_b128 v[100:103], v114 offset:37376
    s_mov_b64 exec, -1
    v_exp_f32 v26, v26
    v_exp_f32 v27, v27
    v_exp_f32 v28, v28
    v_exp_f32 v29, v29
    v_exp_f32 v30, v30
    v_exp_f32 v31, v31
    v_exp_f32 v32, v32
    v_exp_f32 v33, v33
    v_smfmac_f32_32x32x32_bf16 v[48:63], v[108:111], v[24:31], v112
    v_exp_f32 v34, v34
    v_exp_f32 v35, v35
    v_exp_f32 v36, v36
    v_mfma_f32_32x32x16_bf16 v[16:31], v[88:91], v[80:83], 0
    v_exp_f32 v37, v37
    v_exp_f32 v38, v38
    v_exp_f32 v39, v39
    v_exp_f32 v40, v40
    v_exp_f32 v41, v41
    v_smfmac_f32_32x32x32_bf16 v[64:79], v[104:107], v[32:39], v112
    s_waitcnt vmcnt(2)
    ds_read_b64_tr_b16 a[32:33], v116 offset:0
    ds_read_b64_tr_b16 a[34:35], v116 offset:512
    ds_read_b64_tr_b16 a[36:37], v116 offset:1024
    ds_read_b64_tr_b16 a[38:39], v116 offset:1536
    v_exp_f32 v42, v42
    v_exp_f32 v43, v43
    v_exp_f32 v44, v44
    v_exp_f32 v45, v45
    v_exp_f32 v46, v46
    v_exp_f32 v47, v47
    s_waitcnt lgkmcnt(0)
    s_add_u32 m0, s75, 0
    s_add_u32 s71, s74, 528384
    buffer_load_dwordx4 v115, s[44:47], s71 offen  lds
    s_add_u32 m0, s75, 1024
    s_add_u32 s71, s74, 572416
    buffer_load_dwordx4 v115, s[44:47], s71 offen  lds
    v_exp_f32 v16, v16
    v_exp_f32 v17, v17
    v_smfmac_f32_32x32x32_bf16 v[64:79], v[108:111], v[40:47], v112
    v_exp_f32 v18, v18
    v_exp_f32 v19, v19
    v_exp_f32 v20, v20
    v_mfma_f32_32x32x16_bf16 v[32:47], v[88:91], v[84:87], 0
    v_exp_f32 v21, v21
    v_exp_f32 v22, v22
    v_exp_f32 v23, v23
    v_exp_f32 v24, v24
    v_exp_f32 v25, v25
    v_smfmac_f32_32x32x32_bf16 v[48:63], v[96:99], v[16:23], v112
    ds_read_b128 v[88:91], v113 offset:40960
    s_mov_b64 exec, s[72:73]
    ds_read_b128 v[104:107], v114 offset:38912
    ds_read_b128 v[108:111], v114 offset:39424
    s_mov_b64 exec, -1
    s_lshl_b32 s64, s50, 2
    v_mov_b32 v12, s64
    v_mov_b32 v13, 1
    ds_write_b32 v12, v13
    v_exp_f32 v26, v26
    v_exp_f32 v27, v27
    v_exp_f32 v28, v28
    v_exp_f32 v29, v29
    v_exp_f32 v30, v30
    v_exp_f32 v31, v31
    v_exp_f32 v32, v32
    v_exp_f32 v33, v33
    v_smfmac_f32_32x32x32_bf16 v[48:63], v[100:103], v[24:31], v112
    v_exp_f32 v34, v34
    v_exp_f32 v35, v35
    v_exp_f32 v36, v36
    v_mfma_f32_32x32x16_bf16 v[16:31], v[92:95], v[80:83], 0
    v_exp_f32 v37, v37
    v_exp_f32 v38, v38
    v_exp_f32 v39, v39
    v_exp_f32 v40, v40
    v_exp_f32 v41, v41
    v_smfmac_f32_32x32x32_bf16 v[64:79], v[96:99], v[32:39], v112
    s_waitcnt vmcnt(2)
    ds_read_b64_tr_b16 a[40:41], v116 offset:2048
    ds_read_b64_tr_b16 a[42:43], v116 offset:2560
    ds_read_b64_tr_b16 a[44:45], v116 offset:3072
    ds_read_b64_tr_b16 a[46:47], v116 offset:3584
    v_exp_f32 v42, v42
    v_exp_f32 v43, v43
    v_exp_f32 v44, v44
    v_exp_f32 v45, v45
    v_exp_f32 v46, v46
    v_exp_f32 v47, v47
    s_waitcnt lgkmcnt(0)
    s_add_u32 m0, s75, 2048
    s_add_u32 s71, s74, 616448
    buffer_load_dwordx4 v115, s[44:47], s71 offen  lds
    s_add_u32 m0, s75, 3072
    s_add_u32 s71, s74, 660480
    buffer_load_dwordx4 v115, s[44:47], s71 offen  lds
    v_exp_f32 v16, v16
    v_exp_f32 v17, v17
    v_smfmac_f32_32x32x32_bf16 v[64:79], v[100:103], v[40:47], v112
    v_exp_f32 v18, v18
    v_exp_f32 v19, v19
    v_exp_f32 v20, v20
    v_mfma_f32_32x32x16_bf16 v[32:47], v[92:95], v[84:87], 0
    v_exp_f32 v21, v21
    v_exp_f32 v22, v22
    v_exp_f32 v23, v23
    v_exp_f32 v24, v24
    v_exp_f32 v25, v25
    v_smfmac_f32_32x32x32_bf16 v[48:63], v[104:107], v[16:23], v112
    ds_read_b128 v[92:95], v113 offset:43008
    s_mov_b64 exec, s[72:73]
    ds_read_b128 v[96:99], v114 offset:40960
    ds_read_b128 v[100:103], v114 offset:41472
    s_mov_b64 exec, -1
    s_lshr_b32 s64, s2, 3
    s_lshl_b32 s65, s50, 5
    s_xor_b32 s65, s65, 0xe0
    s_add_u32 s64, s64, s65
    s_lshl_b32 s64, s64, 13
    buffer_load_dword v2, v119, s[80:83], s64 offen
    v_exp_f32 v26, v26
    v_exp_f32 v27, v27
    v_exp_f32 v28, v28
    v_exp_f32 v29, v29
    v_exp_f32 v30, v30
    v_exp_f32 v31, v31
    v_exp_f32 v32, v32
    v_exp_f32 v33, v33
    v_smfmac_f32_32x32x32_bf16 v[48:63], v[108:111], v[24:31], v112
    v_exp_f32 v34, v34
    v_exp_f32 v35, v35
    v_exp_f32 v36, v36
    v_mfma_f32_32x32x16_bf16 v[16:31], v[88:91], v[80:83], 0
    v_exp_f32 v37, v37
    v_exp_f32 v38, v38
    v_exp_f32 v39, v39
    v_exp_f32 v40, v40
    v_exp_f32 v41, v41
    v_smfmac_f32_32x32x32_bf16 v[64:79], v[104:107], v[32:39], v112
    s_waitcnt vmcnt(3)
    ds_read_b64_tr_b16 a[48:49], v116 offset:0
    ds_read_b64_tr_b16 a[50:51], v116 offset:512
    ds_read_b64_tr_b16 a[52:53], v116 offset:1024
    ds_read_b64_tr_b16 a[54:55], v116 offset:1536
    v_exp_f32 v42, v42
    v_exp_f32 v43, v43
    v_exp_f32 v44, v44
    v_exp_f32 v45, v45
    v_exp_f32 v46, v46
    v_exp_f32 v47, v47
    s_waitcnt lgkmcnt(0)
    s_add_u32 m0, s75, 0
    s_add_u32 s71, s74, 704512
    buffer_load_dwordx4 v115, s[44:47], s71 offen  lds
    s_add_u32 m0, s75, 1024
    s_add_u32 s71, s74, 748544
    buffer_load_dwordx4 v115, s[44:47], s71 offen  lds
    v_exp_f32 v16, v16
    v_exp_f32 v17, v17
    v_smfmac_f32_32x32x32_bf16 v[64:79], v[108:111], v[40:47], v112
    v_exp_f32 v18, v18
    v_exp_f32 v19, v19
    v_exp_f32 v20, v20
    v_mfma_f32_32x32x16_bf16 v[32:47], v[88:91], v[84:87], 0
    v_exp_f32 v21, v21
    v_exp_f32 v22, v22
    v_exp_f32 v23, v23
    v_exp_f32 v24, v24
    v_exp_f32 v25, v25
    v_smfmac_f32_32x32x32_bf16 v[48:63], v[96:99], v[16:23], v112
    ds_read_b128 v[88:91], v113 offset:45056
    s_mov_b64 exec, s[72:73]
    ds_read_b128 v[104:107], v114 offset:43008
    ds_read_b128 v[108:111], v114 offset:43520
    s_mov_b64 exec, -1
    v_exp_f32 v26, v26
    v_exp_f32 v27, v27
    v_exp_f32 v28, v28
    v_exp_f32 v29, v29
    v_exp_f32 v30, v30
    v_exp_f32 v31, v31
    v_exp_f32 v32, v32
    v_exp_f32 v33, v33
    v_smfmac_f32_32x32x32_bf16 v[48:63], v[100:103], v[24:31], v112
    v_exp_f32 v34, v34
    v_exp_f32 v35, v35
    v_exp_f32 v36, v36
    v_mfma_f32_32x32x16_bf16 v[16:31], v[92:95], v[80:83], 0
    v_exp_f32 v37, v37
    v_exp_f32 v38, v38
    v_exp_f32 v39, v39
    v_exp_f32 v40, v40
    v_exp_f32 v41, v41
    v_smfmac_f32_32x32x32_bf16 v[64:79], v[96:99], v[32:39], v112
    s_waitcnt vmcnt(3)
    ds_read_b64_tr_b16 a[56:57], v116 offset:2048
    ds_read_b64_tr_b16 a[58:59], v116 offset:2560
    ds_read_b64_tr_b16 a[60:61], v116 offset:3072
    ds_read_b64_tr_b16 a[62:63], v116 offset:3584
    v_exp_f32 v42, v42
    v_exp_f32 v43, v43
    v_exp_f32 v44, v44
    v_exp_f32 v45, v45
    v_exp_f32 v46, v46
    v_exp_f32 v47, v47
    s_waitcnt lgkmcnt(0)
    s_add_u32 m0, s75, 2048
    s_add_u32 s71, s74, 792576
    buffer_load_dwordx4 v115, s[44:47], s71 offen  lds
    s_add_u32 m0, s75, 3072
    s_add_u32 s71, s74, 836608
    buffer_load_dwordx4 v115, s[44:47], s71 offen  lds
    v_exp_f32 v16, v16
    v_exp_f32 v17, v17
    v_smfmac_f32_32x32x32_bf16 v[64:79], v[100:103], v[40:47], v112
    v_exp_f32 v18, v18
    v_exp_f32 v19, v19
    v_exp_f32 v20, v20
    v_mfma_f32_32x32x16_bf16 v[32:47], v[92:95], v[84:87], 0
    v_exp_f32 v21, v21
    v_exp_f32 v22, v22
    v_exp_f32 v23, v23
    v_exp_f32 v24, v24
    v_exp_f32 v25, v25
    v_smfmac_f32_32x32x32_bf16 v[48:63], v[104:107], v[16:23], v112
    ds_read_b128 v[92:95], v113 offset:47104
    s_mov_b64 exec, s[72:73]
    ds_read_b128 v[96:99], v114 offset:45056
    ds_read_b128 v[100:103], v114 offset:45568
    s_mov_b64 exec, -1
    v_exp_f32 v26, v26
    v_exp_f32 v27, v27
    v_exp_f32 v28, v28
    v_exp_f32 v29, v29
    v_exp_f32 v30, v30
    v_exp_f32 v31, v31
    v_exp_f32 v32, v32
    v_exp_f32 v33, v33
    v_smfmac_f32_32x32x32_bf16 v[48:63], v[108:111], v[24:31], v112
    v_exp_f32 v34, v34
    v_exp_f32 v35, v35
    v_exp_f32 v36, v36
    v_mfma_f32_32x32x16_bf16 v[16:31], v[88:91], v[80:83], 0
    v_exp_f32 v37, v37
    v_exp_f32 v38, v38
    v_exp_f32 v39, v39
    v_exp_f32 v40, v40
    v_exp_f32 v41, v41
    v_smfmac_f32_32x32x32_bf16 v[64:79], v[104:107], v[32:39], v112
    s_waitcnt vmcnt(2)
    ds_read_b64_tr_b16 a[64:65], v116 offset:0
    ds_read_b64_tr_b16 a[66:67], v116 offset:512
    ds_read_b64_tr_b16 a[68:69], v116 offset:1024
    ds_read_b64_tr_b16 a[70:71], v116 offset:1536
    v_exp_f32 v42, v42
    v_exp_f32 v43, v43
    v_exp_f32 v44, v44
    v_exp_f32 v45, v45
    v_exp_f32 v46, v46
    v_exp_f32 v47, v47
    s_setprio 2
    s_waitcnt lgkmcnt(0)
    s_add_u32 m0, s75, 0
    s_add_u32 s71, s74, 880640
    buffer_load_dwordx4 v115, s[44:47], s71 offen  lds
    s_add_u32 m0, s75, 1024
    s_add_u32 s71, s74, 924672
    buffer_load_dwordx4 v115, s[44:47], s71 offen  lds
    v_exp_f32 v16, v16
    v_exp_f32 v17, v17
    v_smfmac_f32_32x32x32_bf16 v[64:79], v[108:111], v[40:47], v112
    v_exp_f32 v18, v18
    v_exp_f32 v19, v19
    v_exp_f32 v20, v20
    v_mfma_f32_32x32x16_bf16 v[32:47], v[88:91], v[84:87], 0
    v_exp_f32 v21, v21
    v_exp_f32 v22, v22
    v_exp_f32 v23, v23
    v_exp_f32 v24, v24
    v_exp_f32 v25, v25
    v_smfmac_f32_32x32x32_bf16 v[48:63], v[96:99], v[16:23], v112
    ds_read_b128 v[88:91], v113 offset:49152
    s_mov_b64 exec, s[72:73]
    ds_read_b128 v[104:107], v114 offset:47104
    ds_read_b128 v[108:111], v114 offset:47616
    s_mov_b64 exec, -1
    v_exp_f32 v26, v26
    v_exp_f32 v27, v27
    v_exp_f32 v28, v28
    v_exp_f32 v29, v29
    v_exp_f32 v30, v30
    v_exp_f32 v31, v31
    v_exp_f32 v32, v32
    v_exp_f32 v33, v33
    v_smfmac_f32_32x32x32_bf16 v[48:63], v[100:103], v[24:31], v112
    v_exp_f32 v34, v34
    v_exp_f32 v35, v35
    v_exp_f32 v36, v36
    v_mfma_f32_32x32x16_bf16 v[16:31], v[92:95], v[80:83], 0
    v_exp_f32 v37, v37
    v_exp_f32 v38, v38
    v_exp_f32 v39, v39
    v_exp_f32 v40, v40
    v_exp_f32 v41, v41
    v_smfmac_f32_32x32x32_bf16 v[64:79], v[96:99], v[32:39], v112
    s_waitcnt vmcnt(2)
    ds_read_b64_tr_b16 a[72:73], v116 offset:2048
    ds_read_b64_tr_b16 a[74:75], v116 offset:2560
    ds_read_b64_tr_b16 a[76:77], v116 offset:3072
    ds_read_b64_tr_b16 a[78:79], v116 offset:3584
    v_exp_f32 v42, v42
    v_exp_f32 v43, v43
    v_exp_f32 v44, v44
    v_exp_f32 v45, v45
    v_exp_f32 v46, v46
    v_exp_f32 v47, v47
    s_waitcnt lgkmcnt(0)
    s_add_u32 m0, s75, 2048
    s_add_u32 s71, s74, 968704
    buffer_load_dwordx4 v115, s[44:47], s71 offen  lds
    s_add_u32 m0, s75, 3072
    s_add_u32 s71, s74, 1012736
    buffer_load_dwordx4 v115, s[44:47], s71 offen  lds
    v_exp_f32 v16, v16
    v_exp_f32 v17, v17
    v_smfmac_f32_32x32x32_bf16 v[64:79], v[100:103], v[40:47], v112
    v_exp_f32 v18, v18
    v_exp_f32 v19, v19
    v_exp_f32 v20, v20
    v_mfma_f32_32x32x16_bf16 v[32:47], v[92:95], v[84:87], 0
    v_exp_f32 v21, v21
    v_exp_f32 v22, v22
    v_exp_f32 v23, v23
    v_exp_f32 v24, v24
    v_exp_f32 v25, v25
    v_smfmac_f32_32x32x32_bf16 v[48:63], v[104:107], v[16:23], v112
    ds_read_b128 v[92:95], v113 offset:51200
    s_mov_b64 exec, s[72:73]
    ds_read_b128 v[96:99], v114 offset:49152
    ds_read_b128 v[100:103], v114 offset:49664
    s_mov_b64 exec, -1
    v_exp_f32 v26, v26
    v_exp_f32 v27, v27
    v_exp_f32 v28, v28
    v_exp_f32 v29, v29
    v_exp_f32 v30, v30
    v_exp_f32 v31, v31
    v_exp_f32 v32, v32
    v_exp_f32 v33, v33
    v_smfmac_f32_32x32x32_bf16 v[48:63], v[108:111], v[24:31], v112
    v_exp_f32 v34, v34
    v_exp_f32 v35, v35
    v_exp_f32 v36, v36
    v_mfma_f32_32x32x16_bf16 v[16:31], v[88:91], v[80:83], 0
    v_exp_f32 v37, v37
    v_exp_f32 v38, v38
    v_exp_f32 v39, v39
    v_exp_f32 v40, v40
    v_exp_f32 v41, v41
    v_smfmac_f32_32x32x32_bf16 v[64:79], v[104:107], v[32:39], v112
    s_waitcnt vmcnt(2)
    ds_read_b64_tr_b16 a[80:81], v116 offset:0
    ds_read_b64_tr_b16 a[82:83], v116 offset:512
    ds_read_b64_tr_b16 a[84:85], v116 offset:1024
    ds_read_b64_tr_b16 a[86:87], v116 offset:1536
    v_exp_f32 v42, v42
    v_exp_f32 v43, v43
    v_exp_f32 v44, v44
    v_exp_f32 v45, v45
    v_exp_f32 v46, v46
    v_exp_f32 v47, v47
    s_waitcnt lgkmcnt(0)
    s_add_u32 m0, s75, 0
    s_add_u32 s71, s74, 1056768
    buffer_load_dwordx4 v115, s[44:47], s71 offen  lds
    s_add_u32 m0, s75, 1024
    s_add_u32 s71, s74, 1100800
    buffer_load_dwordx4 v115, s[44:47], s71 offen  lds
    v_exp_f32 v16, v16
    v_exp_f32 v17, v17
    v_smfmac_f32_32x32x32_bf16 v[64:79], v[108:111], v[40:47], v112
    v_exp_f32 v18, v18
    v_exp_f32 v19, v19
    v_exp_f32 v20, v20
    v_mfma_f32_32x32x16_bf16 v[32:47], v[88:91], v[84:87], 0
    v_exp_f32 v21, v21
    v_exp_f32 v22, v22
    v_exp_f32 v23, v23
    v_exp_f32 v24, v24
    v_exp_f32 v25, v25
    v_smfmac_f32_32x32x32_bf16 v[48:63], v[96:99], v[16:23], v112
    ds_read_b128 v[88:91], v113 offset:53248
    s_mov_b64 exec, s[72:73]
    ds_read_b128 v[104:107], v114 offset:51200
    ds_read_b128 v[108:111], v114 offset:51712
    s_mov_b64 exec, -1
    v_exp_f32 v26, v26
    v_exp_f32 v27, v27
    v_exp_f32 v28, v28
    v_exp_f32 v29, v29
    v_exp_f32 v30, v30
    v_exp_f32 v31, v31
    v_exp_f32 v32, v32
    v_exp_f32 v33, v33
    v_smfmac_f32_32x32x32_bf16 v[48:63], v[100:103], v[24:31], v112
    v_exp_f32 v34, v34
    v_exp_f32 v35, v35
    v_exp_f32 v36, v36
    v_mfma_f32_32x32x16_bf16 v[16:31], v[92:95], v[80:83], 0
    v_exp_f32 v37, v37
    v_exp_f32 v38, v38
    v_exp_f32 v39, v39
    v_exp_f32 v40, v40
    v_exp_f32 v41, v41
    v_smfmac_f32_32x32x32_bf16 v[64:79], v[96:99], v[32:39], v112
    s_waitcnt vmcnt(2)
    ds_read_b64_tr_b16 a[88:89], v116 offset:2048
    ds_read_b64_tr_b16 a[90:91], v116 offset:2560
    ds_read_b64_tr_b16 a[92:93], v116 offset:3072
    ds_read_b64_tr_b16 a[94:95], v116 offset:3584
    v_exp_f32 v42, v42
    v_exp_f32 v43, v43
    v_exp_f32 v44, v44
    v_exp_f32 v45, v45
    v_exp_f32 v46, v46
    v_exp_f32 v47, v47
    s_waitcnt lgkmcnt(0)
    s_add_u32 m0, s75, 2048
    s_add_u32 s71, s74, 1144832
    buffer_load_dwordx4 v115, s[44:47], s71 offen  lds
    s_add_u32 m0, s75, 3072
    s_add_u32 s71, s74, 1188864
    buffer_load_dwordx4 v115, s[44:47], s71 offen  lds
    v_exp_f32 v16, v16
    v_exp_f32 v17, v17
    v_smfmac_f32_32x32x32_bf16 v[64:79], v[100:103], v[40:47], v112
    v_exp_f32 v18, v18
    v_exp_f32 v19, v19
    v_exp_f32 v20, v20
    v_mfma_f32_32x32x16_bf16 v[32:47], v[92:95], v[84:87], 0
    v_exp_f32 v21, v21
    v_exp_f32 v22, v22
    v_exp_f32 v23, v23
    v_exp_f32 v24, v24
    v_exp_f32 v25, v25
    v_smfmac_f32_32x32x32_bf16 v[48:63], v[104:107], v[16:23], v112
    ds_read_b128 v[92:95], v113 offset:55296
    s_mov_b64 exec, s[72:73]
    ds_read_b128 v[96:99], v114 offset:53248
    ds_read_b128 v[100:103], v114 offset:53760
    s_mov_b64 exec, -1
    v_exp_f32 v26, v26
    v_exp_f32 v27, v27
    v_exp_f32 v28, v28
    v_exp_f32 v29, v29
    v_exp_f32 v30, v30
    v_exp_f32 v31, v31
    v_exp_f32 v32, v32
    v_exp_f32 v33, v33
    v_smfmac_f32_32x32x32_bf16 v[48:63], v[108:111], v[24:31], v112
    v_exp_f32 v34, v34
    v_exp_f32 v35, v35
    v_exp_f32 v36, v36
    v_mfma_f32_32x32x16_bf16 v[16:31], v[88:91], v[80:83], 0
    v_exp_f32 v37, v37
    v_exp_f32 v38, v38
    v_exp_f32 v39, v39
    v_exp_f32 v40, v40
    v_exp_f32 v41, v41
    v_smfmac_f32_32x32x32_bf16 v[64:79], v[104:107], v[32:39], v112
    s_waitcnt vmcnt(2)
    ds_read_b64_tr_b16 a[96:97], v116 offset:0
    ds_read_b64_tr_b16 a[98:99], v116 offset:512
    ds_read_b64_tr_b16 a[100:101], v116 offset:1024
    ds_read_b64_tr_b16 a[102:103], v116 offset:1536
    v_exp_f32 v42, v42
    v_exp_f32 v43, v43
    v_exp_f32 v44, v44
    v_exp_f32 v45, v45
    v_exp_f32 v46, v46
    v_exp_f32 v47, v47
    s_waitcnt lgkmcnt(0)
    s_add_u32 m0, s75, 0
    s_add_u32 s71, s74, 1232896
    buffer_load_dwordx4 v115, s[44:47], s71 offen  lds
    s_add_u32 m0, s75, 1024
    s_add_u32 s71, s74, 1276928
    buffer_load_dwordx4 v115, s[44:47], s71 offen  lds
    v_exp_f32 v16, v16
    v_exp_f32 v17, v17
    v_smfmac_f32_32x32x32_bf16 v[64:79], v[108:111], v[40:47], v112
    v_exp_f32 v18, v18
    v_exp_f32 v19, v19
    v_exp_f32 v20, v20
    v_mfma_f32_32x32x16_bf16 v[32:47], v[88:91], v[84:87], 0
    v_exp_f32 v21, v21
    v_exp_f32 v22, v22
    v_exp_f32 v23, v23
    v_exp_f32 v24, v24
    v_exp_f32 v25, v25
    v_smfmac_f32_32x32x32_bf16 v[48:63], v[96:99], v[16:23], v112
    ds_read_b128 v[88:91], v113 offset:57344
    s_mov_b64 exec, s[72:73]
    ds_read_b128 v[104:107], v114 offset:55296
    ds_read_b128 v[108:111], v114 offset:55808
    s_mov_b64 exec, -1
    v_exp_f32 v26, v26
    v_exp_f32 v27, v27
    v_exp_f32 v28, v28
    v_exp_f32 v29, v29
    v_exp_f32 v30, v30
    v_exp_f32 v31, v31
    v_exp_f32 v32, v32
    v_exp_f32 v33, v33
    v_smfmac_f32_32x32x32_bf16 v[48:63], v[100:103], v[24:31], v112
    v_exp_f32 v34, v34
    v_exp_f32 v35, v35
    v_exp_f32 v36, v36
    v_mfma_f32_32x32x16_bf16 v[16:31], v[92:95], v[80:83], 0
    v_exp_f32 v37, v37
    v_exp_f32 v38, v38
    v_exp_f32 v39, v39
    v_exp_f32 v40, v40
    v_exp_f32 v41, v41
    v_smfmac_f32_32x32x32_bf16 v[64:79], v[96:99], v[32:39], v112
    s_waitcnt vmcnt(2)
    ds_read_b64_tr_b16 a[104:105], v116 offset:2048
    ds_read_b64_tr_b16 a[106:107], v116 offset:2560
    ds_read_b64_tr_b16 a[108:109], v116 offset:3072
    ds_read_b64_tr_b16 a[110:111], v116 offset:3584
    v_exp_f32 v42, v42
    v_exp_f32 v43, v43
    v_exp_f32 v44, v44
    v_exp_f32 v45, v45
    v_exp_f32 v46, v46
    v_exp_f32 v47, v47
    s_waitcnt lgkmcnt(0)
    s_add_u32 m0, s75, 2048
    s_add_u32 s71, s74, 1320960
    buffer_load_dwordx4 v115, s[44:47], s71 offen  lds
    s_add_u32 m0, s75, 3072
    s_add_u32 s71, s74, 1364992
    buffer_load_dwordx4 v115, s[44:47], s71 offen  lds
    v_exp_f32 v16, v16
    v_exp_f32 v17, v17
    v_smfmac_f32_32x32x32_bf16 v[64:79], v[100:103], v[40:47], v112
    v_exp_f32 v18, v18
    v_exp_f32 v19, v19
    v_exp_f32 v20, v20
    v_mfma_f32_32x32x16_bf16 v[32:47], v[92:95], v[84:87], 0
    v_exp_f32 v21, v21
    v_exp_f32 v22, v22
    v_exp_f32 v23, v23
    v_exp_f32 v24, v24
    v_exp_f32 v25, v25
    v_smfmac_f32_32x32x32_bf16 v[48:63], v[104:107], v[16:23], v112
    ds_read_b128 v[92:95], v113 offset:59392
    s_mov_b64 exec, s[72:73]
    ds_read_b128 v[96:99], v114 offset:57344
    ds_read_b128 v[100:103], v114 offset:57856
    s_mov_b64 exec, -1
    s_lshl_b32 s64, s52, 3
    s_add_u32 s64, s64, s50
    s_mul_i32 s64, s64, 3072
    s_mov_b64 exec, 0xffffff
    buffer_load_dword v3, v119, s[36:39], s64 offen sc1
    s_mov_b64 exec, -1
    v_exp_f32 v26, v26
    v_exp_f32 v27, v27
    v_exp_f32 v28, v28
    v_exp_f32 v29, v29
    v_exp_f32 v30, v30
    v_exp_f32 v31, v31
    v_exp_f32 v32, v32
    v_exp_f32 v33, v33
    v_smfmac_f32_32x32x32_bf16 v[48:63], v[108:111], v[24:31], v112
    v_exp_f32 v34, v34
    v_exp_f32 v35, v35
    v_exp_f32 v36, v36
    v_mfma_f32_32x32x16_bf16 v[16:31], v[88:91], v[80:83], 0
    v_exp_f32 v37, v37
    v_exp_f32 v38, v38
    v_exp_f32 v39, v39
    v_exp_f32 v40, v40
    v_exp_f32 v41, v41
    v_smfmac_f32_32x32x32_bf16 v[64:79], v[104:107], v[32:39], v112
    s_waitcnt vmcnt(3)
    ds_read_b64_tr_b16 a[112:113], v116 offset:0
    ds_read_b64_tr_b16 a[114:115], v116 offset:512
    ds_read_b64_tr_b16 a[116:117], v116 offset:1024
    ds_read_b64_tr_b16 a[118:119], v116 offset:1536
    v_exp_f32 v42, v42
    v_exp_f32 v43, v43
    v_exp_f32 v44, v44
    v_exp_f32 v45, v45
    v_exp_f32 v46, v46
    v_exp_f32 v47, v47
    s_setprio 1
    s_waitcnt lgkmcnt(0)
    v_exp_f32 v16, v16
    v_exp_f32 v17, v17
    v_smfmac_f32_32x32x32_bf16 v[64:79], v[108:111], v[40:47], v112
    v_exp_f32 v18, v18
    v_exp_f32 v19, v19
    v_exp_f32 v20, v20
    v_mfma_f32_32x32x16_bf16 v[32:47], v[88:91], v[84:87], 0
    v_exp_f32 v21, v21
    v_exp_f32 v22, v22
    v_exp_f32 v23, v23
    v_exp_f32 v24, v24
    v_exp_f32 v25, v25
    v_smfmac_f32_32x32x32_bf16 v[48:63], v[96:99], v[16:23], v112
    ds_read_b128 v[88:91], v113 offset:61440
    s_mov_b64 exec, s[72:73]
    ds_read_b128 v[104:107], v114 offset:59392
    ds_read_b128 v[108:111], v114 offset:59904
    s_mov_b64 exec, -1
    v_exp_f32 v26, v26
    v_exp_f32 v27, v27
    v_exp_f32 v28, v28
    v_exp_f32 v29, v29
    v_exp_f32 v30, v30
    v_exp_f32 v31, v31
    v_exp_f32 v32, v32
    v_exp_f32 v33, v33
    v_smfmac_f32_32x32x32_bf16 v[48:63], v[100:103], v[24:31], v112
    v_exp_f32 v34, v34
    v_exp_f32 v35, v35
    v_exp_f32 v36, v36
    v_mfma_f32_32x32x16_bf16 v[16:31], v[92:95], v[80:83], 0
    v_exp_f32 v37, v37
    v_exp_f32 v38, v38
    v_exp_f32 v39, v39
    v_exp_f32 v40, v40
    v_exp_f32 v41, v41
    v_smfmac_f32_32x32x32_bf16 v[64:79], v[96:99], v[32:39], v112
    s_waitcnt vmcnt(1)
    ds_read_b64_tr_b16 a[120:121], v116 offset:2048
    ds_read_b64_tr_b16 a[122:123], v116 offset:2560
    ds_read_b64_tr_b16 a[124:125], v116 offset:3072
    ds_read_b64_tr_b16 a[126:127], v116 offset:3584
    v_exp_f32 v42, v42
    v_exp_f32 v43, v43
    v_exp_f32 v44, v44
    v_exp_f32 v45, v45
    v_exp_f32 v46, v46
    v_exp_f32 v47, v47
    s_waitcnt lgkmcnt(0)
    v_exp_f32 v16, v16
    v_exp_f32 v17, v17
    v_smfmac_f32_32x32x32_bf16 v[64:79], v[100:103], v[40:47], v112
    v_exp_f32 v18, v18
    v_exp_f32 v19, v19
    v_exp_f32 v20, v20
    v_mfma_f32_32x32x16_bf16 v[32:47], v[92:95], v[84:87], 0
    v_exp_f32 v21, v21
    v_exp_f32 v22, v22
    v_exp_f32 v23, v23
    v_exp_f32 v24, v24
    v_exp_f32 v25, v25
    v_smfmac_f32_32x32x32_bf16 v[48:63], v[104:107], v[16:23], v112
    ds_read_b128 v[92:95], v113 offset:63488
    s_mov_b64 exec, s[72:73]
    ds_read_b128 v[96:99], v114 offset:61440
    ds_read_b128 v[100:103], v114 offset:61952
    s_mov_b64 exec, -1
    v_and_b32 v12, 7, v1
    v_lshlrev_b32 v12, 2, v12
    ds_read_b32 v13, v12
    v_exp_f32 v26, v26
    v_exp_f32 v27, v27
    v_exp_f32 v28, v28
    v_exp_f32 v29, v29
    v_exp_f32 v30, v30
    v_exp_f32 v31, v31
    v_exp_f32 v32, v32
    v_exp_f32 v33, v33
    v_smfmac_f32_32x32x32_bf16 v[48:63], v[108:111], v[24:31], v112
    v_exp_f32 v34, v34
    v_exp_f32 v35, v35
    v_exp_f32 v36, v36
    v_mfma_f32_32x32x16_bf16 v[16:31], v[88:91], v[80:83], 0
    v_exp_f32 v37, v37
    v_exp_f32 v38, v38
    v_exp_f32 v39, v39
    v_exp_f32 v40, v40
    v_exp_f32 v41, v41
    v_smfmac_f32_32x32x32_bf16 v[64:79], v[104:107], v[32:39], v112
L_sequential_preLN__grouped_kv_mqa__dense_activation_gelu__prompt_kernel_sp_30:
    s_waitcnt lgkmcnt(0)
    v_cmp_ne_u32 vcc, 1, v13
    s_nop 1
    s_cmp_eq_u64 vcc, 0
    s_cbranch_scc1 L_sequential_preLN__grouped_kv_mqa__dense_activation_gelu__prompt_kernel_ok_31
    s_sleep 2
    ds_read_b32 v13, v12
    s_branch L_sequential_preLN__grouped_kv_mqa__dense_activation_gelu__prompt_kernel_sp_30
L_sequential_preLN__grouped_kv_mqa__dense_activation_gelu__prompt_kernel_ok_31:
    s_add_u32 m0, s78, 2048
    s_add_u32 s71, s77, 0
    buffer_load_dwordx4 v6, s[84:87], s71 offen  lds
    s_add_u32 m0, s78, 3072
    s_add_u32 s71, s77, 8192
    buffer_load_dwordx4 v6, s[84:87], s71 offen  lds
    s_add_u32 m0, s78, 18432
    s_add_u32 s71, s77, 131072
    buffer_load_dwordx4 v6, s[84:87], s71 offen  lds
    s_add_u32 m0, s78, 19456
    s_add_u32 s71, s77, 139264
    buffer_load_dwordx4 v6, s[84:87], s71 offen  lds
    s_add_u32 m0, s78, 67584
    s_add_u32 s71, s77, 262144
    buffer_load_dwordx4 v6, s[84:87], s71 offen  lds
    s_add_u32 m0, s78, 68608
    s_add_u32 s71, s77, 270336
    buffer_load_dwordx4 v6, s[84:87], s71 offen  lds
    s_add_u32 m0, s78, 83968
    s_add_u32 s71, s77, 393216
    buffer_load_dwordx4 v6, s[84:87], s71 offen  lds
    s_add_u32 m0, s78, 84992
    s_add_u32 s71, s77, 401408
    buffer_load_dwordx4 v6, s[84:87], s71 offen  lds
    s_lshl_b32 s65, s51, 2
    v_mov_b32 v14, s65
    global_load_dword v15, v14, s[26:27] offset:4 sc1
    v_exp_f32 v42, v42
    v_exp_f32 v43, v43
    v_exp_f32 v44, v44
    v_exp_f32 v45, v45
    v_exp_f32 v46, v46
    v_exp_f32 v47, v47
    s_waitcnt lgkmcnt(0)
    v_exp_f32 v16, v16
    v_exp_f32 v17, v17
    v_smfmac_f32_32x32x32_bf16 v[64:79], v[108:111], v[40:47], v112
    v_exp_f32 v18, v18
    v_exp_f32 v19, v19
    v_exp_f32 v20, v20
    v_mfma_f32_32x32x16_bf16 v[32:47], v[88:91], v[84:87], 0
    v_exp_f32 v21, v21
    v_exp_f32 v22, v22
    v_exp_f32 v23, v23
    v_exp_f32 v24, v24
    v_exp_f32 v25, v25
    v_smfmac_f32_32x32x32_bf16 v[48:63], v[96:99], v[16:23], v112
    s_mov_b64 exec, s[72:73]
    ds_read_b128 v[104:107], v114 offset:63488
    ds_read_b128 v[108:111], v114 offset:64000
    s_mov_b64 exec, -1
    v_exp_f32 v26, v26
    v_exp_f32 v27, v27
    v_exp_f32 v28, v28
    v_exp_f32 v29, v29
    v_exp_f32 v30, v30
    v_exp_f32 v31, v31
    v_exp_f32 v32, v32
    v_exp_f32 v33, v33
    v_smfmac_f32_32x32x32_bf16 v[48:63], v[100:103], v[24:31], v112
    v_exp_f32 v34, v34
    v_exp_f32 v35, v35
    v_exp_f32 v36, v36
    v_mfma_f32_32x32x16_bf16 v[16:31], v[92:95], v[80:83], 0
    v_exp_f32 v37, v37
    v_exp_f32 v38, v38
    v_exp_f32 v39, v39
    v_exp_f32 v40, v40
    v_exp_f32 v41, v41
    v_smfmac_f32_32x32x32_bf16 v[64:79], v[96:99], v[32:39], v112
    v_exp_f32 v42, v42
    v_exp_f32 v43, v43
    v_exp_f32 v44, v44
    v_exp_f32 v45, v45
    v_exp_f32 v46, v46
    v_exp_f32 v47, v47
    s_setprio 0
    s_waitcnt lgkmcnt(0)
    v_exp_f32 v16, v16
    v_exp_f32 v17, v17
    v_smfmac_f32_32x32x32_bf16 v[64:79], v[100:103], v[40:47], v112
    v_exp_f32 v18, v18
    v_exp_f32 v19, v19
    v_exp_f32 v20, v20
    v_mfma_f32_32x32x16_bf16 v[32:47], v[92:95], v[84:87], 0
    v_exp_f32 v21, v21
    v_exp_f32 v22, v22
    v_exp_f32 v23, v23
    v_exp_f32 v24, v24
    v_exp_f32 v25, v25
    v_smfmac_f32_32x32x32_bf16 v[48:63], v[104:107], v[16:23], v112
L_sequential_preLN__grouped_kv_mqa__dense_activation_gelu__prompt_kernel_cw_32:
    s_waitcnt vmcnt(0)
    v_readfirstlane_b32 s64, v15
    s_nop 3
    s_lshr_b32 s65, s64, 16
    s_cmp_eq_u32 s65, 0xff
    s_cbranch_scc1 L_sequential_preLN__grouped_kv_mqa__dense_activation_gelu__prompt_kernel_cw2_33
    s_sub_u32 s62, s62, 1
    s_cbranch_scc1 L_sequential_preLN__grouped_kv_mqa__dense_activation_gelu__prompt_kernel_to_34
    s_sleep 4
    global_load_dword v15, v14, s[26:27] offset:4 sc1
    s_branch L_sequential_preLN__grouped_kv_mqa__dense_activation_gelu__prompt_kernel_cw_32
L_sequential_preLN__grouped_kv_mqa__dense_activation_gelu__prompt_kernel_cw2_33:
    s_and_b32 s64, s64, 0xffff
    s_bcnt1_i32_b32 s64, s64
    s_cmp_eq_u32 s64, 1
    s_cselect_b32 s56, 1, 0
    v_exp_f32 v26, v26
    v_exp_f32 v27, v27
    v_exp_f32 v28, v28
    v_exp_f32 v29, v29
    v_exp_f32 v30, v30
    v_exp_f32 v31, v31
    v_exp_f32 v32, v32
    v_exp_f32 v33, v33
    v_smfmac_f32_32x32x32_bf16 v[48:63], v[108:111], v[24:31], v112
    v_exp_f32 v34, v34
    v_exp_f32 v35, v35
    v_exp_f32 v36, v36
    v_exp_f32 v37, v37
    v_exp_f32 v38, v38
    v_exp_f32 v39, v39
    v_exp_f32 v40, v40
    v_exp_f32 v41, v41
    v_smfmac_f32_32x32x32_bf16 v[64:79], v[104:107], v[32:39], v112
    v_exp_f32 v42, v42
    v_exp_f32 v43, v43
    v_exp_f32 v44, v44
    v_exp_f32 v45, v45
    v_exp_f32 v46, v46
    v_exp_f32 v47, v47
    v_add_u32 v12, s75, v4
    v_xor_b32 v13, 0x2000, v12
    v_smfmac_f32_32x32x32_bf16 v[64:79], v[108:111], v[40:47], v112
L_sequential_preLN__grouped_kv_mqa__dense_activation_gelu__prompt_kernel_attepi_27:
    s_cmp_eq_u32 s55, 1
    s_cbranch_scc1 L_sequential_preLN__grouped_kv_mqa__dense_activation_gelu__prompt_kernel_kh1_35
    s_nop 7
    s_nop 2
    ds_write_b128 v12, v[72:75]
    ds_write_b128 v12, v[76:79] offset:1024
    ds_write_b32 v12, v64 offset:2048
    s_branch L_sequential_preLN__grouped_kv_mqa__dense_activation_gelu__prompt_kernel_khj_36
L_sequential_preLN__grouped_kv_mqa__dense_activation_gelu__prompt_kernel_kh1_35:
    ds_write_b128 v12, v[56:59]
    ds_write_b128 v12, v[60:63] offset:1024
    ds_write_b32 v12, v48 offset:2048
    s_nop 6
    s_waitcnt lgkmcnt(0)
    v_mov_b32 v48, v64
    v_mov_b32 v56, v72
    v_mov_b32 v57, v73
    v_mov_b32 v58, v74
    v_mov_b32 v59, v75
    v_mov_b32 v60, v76
    v_mov_b32 v61, v77
    v_mov_b32 v62, v78
    v_mov_b32 v63, v79
L_sequential_preLN__grouped_kv_mqa__dense_activation_gelu__prompt_kernel_khj_36:
    s_waitcnt lgkmcnt(0)
    s_barrier
    ds_read_b32 v16, v13 offset:2048
    ds_read_b128 v[24:27], v13
    ds_read_b128 v[28:31], v13 offset:1024
    s_lshl_b32 s79, s53, 1
    s_add_u32 s79, s79, s55
    s_lshl_b32 s64, s79, 11
    s_add_u32 s64, s64, 2048
    v_bfe_u32 v2, v1, 2, 2
    v_lshl_add_u32 v3, v5, 2, v2
    v_lshrrev_b32 v2, 1, v2
    v_lshlrev_b32 v2, 6, v2
    v_lshl_add_u32 v2, v3, 7, v2
    v_bfe_u32 v3, v1, 4, 1
    v_lshl_add_u32 v2, v3, 5, v2
    v_and_b32 v3, 3, v1
    v_lshl_add_u32 v2, v3, 3, v2
    v_add_u32 v120, s64, v2
    v_xor_b32 v121, 64, v120
    v_add_u32 v124, 0x10000, v120
    v_add_u32 v125, 0x10000, v121
    s_waitcnt lgkmcnt(2)
    v_add_f32 v48, v48, v16
    v_rcp_f32 v48, v48
    s_waitcnt lgkmcnt(0)
    v_pk_add_f32 v[56:57], v[56:57], v[24:25]
    v_pk_add_f32 v[58:59], v[58:59], v[26:27]
    v_pk_add_f32 v[60:61], v[60:61], v[28:29]
    v_pk_add_f32 v[62:63], v[62:63], v[30:31]
    v_pk_mul_f32 v[56:57], v[48:49], v[56:57] op_sel:[0,0] op_sel_hi:[0,1]
    v_pk_mul_f32 v[58:59], v[48:49], v[58:59] op_sel:[0,0] op_sel_hi:[0,1]
    v_pk_mul_f32 v[60:61], v[48:49], v[60:61] op_sel:[0,0] op_sel_hi:[0,1]
    v_pk_mul_f32 v[62:63], v[48:49], v[62:63] op_sel:[0,0] op_sel_hi:[0,1]
    v_cvt_pk_bf16_f32 v16, v56, v57
    v_cvt_pk_bf16_f32 v17, v58, v59
    v_cvt_pk_bf16_f32 v18, v60, v61
    v_cvt_pk_bf16_f32 v19, v62, v63
    s_cmp_eq_u32 s56, 0
    s_cbranch_scc1 L_sequential_preLN__grouped_kv_mqa__dense_activation_gelu__prompt_kernel_slow_37
    buffer_store_dwordx4 v[16:19], v4, s[36:39], s59 offen
L_sequential_preLN__grouped_kv_mqa__dense_activation_gelu__prompt_kernel_pj_38:
    ds_read_b64_tr_b16 v[48:49], v120 offset:0
    ds_read_b64_tr_b16 v[50:51], v120 offset:1024
    ds_read_b64_tr_b16 v[52:53], v121 offset:0
    ds_read_b64_tr_b16 v[54:55], v121 offset:1024
    ds_read_b64_tr_b16 v[56:57], v120 offset:8192
    ds_read_b64_tr_b16 v[58:59], v120 offset:9216
    ds_read_b64_tr_b16 v[60:61], v121 offset:8192
    ds_read_b64_tr_b16 v[62:63], v121 offset:9216
    ds_read_b64_tr_b16 v[64:65], v120 offset:16384
    ds_read_b64_tr_b16 v[66:67], v120 offset:17408
    ds_read_b64_tr_b16 v[68:69], v121 offset:16384
    ds_read_b64_tr_b16 v[70:71], v121 offset:17408
    ds_read_b64_tr_b16 v[72:73], v120 offset:24576
    ds_read_b64_tr_b16 v[74:75], v120 offset:25600
    v_mov_b32 v2, 0
    v_mov_b32 v3, 1
    s_mov_b64 exec, 1
    s_cmp_eq_u32 s56, 0
    s_cbranch_scc1 L_sequential_preLN__grouped_kv_mqa__dense_activation_gelu__prompt_kernel_slow_39
    s_waitcnt vmcnt(0)
    buffer_store_dword v3, v2, s[36:39], s61 offen offset:0
L_sequential_preLN__grouped_kv_mqa__dense_activation_gelu__prompt_kernel_pj_40:
    s_mov_b64 exec, -1
    s_cmp_lt_u32 s50, 4
    s_cbranch_scc1 L_sequential_preLN__grouped_kv_mqa__dense_activation_gelu__prompt_kernel_skp_41
    s_add_u32 m0, s78, 34816
    s_add_u32 s71, s77, 0
    buffer_load_dwordx4 v6, s[80:83], s71 offen  lds
    s_add_u32 m0, s78, 35840
    s_add_u32 s71, s77, 8192
    buffer_load_dwordx4 v6, s[80:83], s71 offen  lds
    s_add_u32 m0, s78, 26624
    s_add_u32 s71, s77, -65536
    buffer_load_dwordx4 v6, s[80:83], s71 offen  lds
    s_add_u32 m0, s78, 27648
    s_add_u32 s71, s77, -57344
    buffer_load_dwordx4 v6, s[80:83], s71 offen  lds
    s_add_u32 m0, s78, 51200
    s_add_u32 s71, s77, 196608
    buffer_load_dwordx4 v6, s[80:83], s71 offen  lds
    s_add_u32 m0, s78, 52224
    s_add_u32 s71, s77, 204800
    buffer_load_dwordx4 v6, s[80:83], s71 offen  lds
    s_add_u32 m0, s78, 43008
    s_add_u32 s71, s77, 131072
    buffer_load_dwordx4 v6, s[80:83], s71 offen  lds
    s_add_u32 m0, s78, 44032
    s_add_u32 s71, s77, 139264
    buffer_load_dwordx4 v6, s[80:83], s71 offen  lds
L_sequential_preLN__grouped_kv_mqa__dense_activation_gelu__prompt_kernel_skp_41:
    s_waitcnt lgkmcnt(8)
    ds_read_b64_tr_b16 v[76:77], v121 offset:24576
    ds_read_b64_tr_b16 v[78:79], v121 offset:25600
    s_lshl_b32 s68, s54, 15
    s_lshl_b32 s65, s79, 10
    s_add_u32 s68, s68, s65
    v_permlane32_swap_b32 v8, v10
    v_permlane32_swap_b32 v9, v11
    s_mov_b32 s44, s18
    s_and_b32 s45, s19, 0xffff
    s_mov_b32 s46, 0xac0
    s_mov_b32 s47, 0x20000
    s_mov_b32 s84, s22
    s_and_b32 s85, s23, 0xffff
    s_mov_b32 s86, 0x400
    s_mov_b32 s87, 0x20000
    s_mul_i32 s64, s54, 24576
    s_add_u32 s64, s64, 100352
    v_add_u32 v14, s64, v4
    s_mul_i32 s65, s79, 6144
    v_add_u32 v15, s65, v14
    v_and_b32 v2, 31, v1
    v_lshlrev_b32 v12, 1, v2
    v_lshlrev_b32 v13, 3, v5
    buffer_load_ushort v114, v12, s[44:47], s74 offen
    s_and_b32 s64, s60, 0x3ff
    buffer_load_dwordx2 v[116:117], v13, s[84:87], s64 offen
    buffer_load_dwordx2 v[118:119], v13, s[84:87], s64 offen offset:16
    v_lshlrev_b32 v2, 2, v1
    s_mov_b32 s64, 0x24000
    v_mov_b32 v112, s57
    v_mov_b32 v113, s57
    s_cmp_lg_u32 s50, 0
    s_cbranch_scc1 L_sequential_preLN__grouped_kv_mqa__dense_activation_gelu__prompt_kernel_pollw_44
    buffer_load_dword v3, v2, s[36:39], s64 offen offset:0 sc1
L_sequential_preLN__grouped_kv_mqa__dense_activation_gelu__prompt_kernel_pollw_44:
    v_mfma_f32_4x4x4_16b_bf16 v[96:99], v[112:113], a[0:1], 0
    v_mfma_f32_4x4x4_16b_bf16 v[100:103], v[112:113], a[2:3], 0
    v_mfma_f32_4x4x4_16b_bf16 v[104:107], v[112:113], a[4:5], 0
    v_mfma_f32_4x4x4_16b_bf16 v[108:111], v[112:113], a[6:7], 0
    v_mfma_f32_4x4x4_16b_bf16 v[96:99], v[112:113], a[8:9], v[96:99]
    v_mfma_f32_4x4x4_16b_bf16 v[100:103], v[112:113], a[10:11], v[100:103]
    v_mfma_f32_4x4x4_16b_bf16 v[104:107], v[112:113], a[12:13], v[104:107]
    v_mfma_f32_4x4x4_16b_bf16 v[108:111], v[112:113], a[14:15], v[108:111]
    v_mfma_f32_4x4x4_16b_bf16 v[96:99], v[112:113], a[16:17], v[96:99]
    v_mfma_f32_4x4x4_16b_bf16 v[100:103], v[112:113], a[18:19], v[100:103]
    v_mfma_f32_4x4x4_16b_bf16 v[104:107], v[112:113], a[20:21], v[104:107]
    v_mfma_f32_4x4x4_16b_bf16 v[108:111], v[112:113], a[22:23], v[108:111]
    v_mfma_f32_4x4x4_16b_bf16 v[96:99], v[112:113], a[24:25], v[96:99]
    v_mfma_f32_4x4x4_16b_bf16 v[100:103], v[112:113], a[26:27], v[100:103]
    v_mfma_f32_4x4x4_16b_bf16 v[104:107], v[112:113], a[28:29], v[104:107]
    v_mfma_f32_4x4x4_16b_bf16 v[108:111], v[112:113], a[30:31], v[108:111]
    v_mfma_f32_4x4x4_16b_bf16 v[96:99], v[112:113], a[32:33], v[96:99]
    v_mfma_f32_4x4x4_16b_bf16 v[100:103], v[112:113], a[34:35], v[100:103]
    v_mfma_f32_4x4x4_16b_bf16 v[104:107], v[112:113], a[36:37], v[104:107]
    v_mfma_f32_4x4x4_16b_bf16 v[108:111], v[112:113], a[38:39], v[108:111]
    v_mfma_f32_4x4x4_16b_bf16 v[96:99], v[112:113], a[40:41], v[96:99]
    v_mfma_f32_4x4x4_16b_bf16 v[100:103], v[112:113], a[42:43], v[100:103]
    v_mfma_f32_4x4x4_16b_bf16 v[104:107], v[112:113], a[44:45], v[104:107]
    v_mfma_f32_4x4x4_16b_bf16 v[108:111], v[112:113], a[46:47], v[108:111]
    v_mfma_f32_4x4x4_16b_bf16 v[96:99], v[112:113], a[48:49], v[96:99]
    v_mfma_f32_4x4x4_16b_bf16 v[100:103], v[112:113], a[50:51], v[100:103]
    v_mfma_f32_4x4x4_16b_bf16 v[104:107], v[112:113], a[52:53], v[104:107]
    v_mfma_f32_4x4x4_16b_bf16 v[108:111], v[112:113], a[54:55], v[108:111]
    v_mfma_f32_4x4x4_16b_bf16 v[96:99], v[112:113], a[56:57], v[96:99]
    v_mfma_f32_4x4x4_16b_bf16 v[100:103], v[112:113], a[58:59], v[100:103]
    v_mfma_f32_4x4x4_16b_bf16 v[104:107], v[112:113], a[60:61], v[104:107]
    v_mfma_f32_4x4x4_16b_bf16 v[108:111], v[112:113], a[62:63], v[108:111]
    s_nop 3
    v_add_f32 v96, v96, v100
    v_add_f32 v104, v104, v108
    v_add_f32 v122, v96, v104
    s_cmp_lg_u32 s50, 0
    s_cbranch_scc1 L_sequential_preLN__grouped_kv_mqa__dense_activation_gelu__prompt_kernel_polld_43
    s_branch L_sequential_preLN__grouped_kv_mqa__dense_activation_gelu__prompt_kernel_pollc_45
L_sequential_preLN__grouped_kv_mqa__dense_activation_gelu__prompt_kernel_poll_42:
    buffer_load_dword v3, v2, s[36:39], s64 offen offset:0 sc1
    s_sub_u32 s62, s62, 1
    s_cbranch_scc1 L_sequential_preLN__grouped_kv_mqa__dense_activation_gelu__prompt_kernel_to_46
L_sequential_preLN__grouped_kv_mqa__dense_activation_gelu__prompt_kernel_pollc_45:
    s_waitcnt vmcnt(0)
    v_cmp_ne_u32 vcc, 1, v3
    s_nop 1
    s_cmp_lg_u64 vcc, 0
    s_cbranch_scc1 L_sequential_preLN__grouped_kv_mqa__dense_activation_gelu__prompt_kernel_poll_42
L_sequential_preLN__grouped_kv_mqa__dense_activation_gelu__prompt_kernel_polld_43:
    s_barrier
    s_add_u32 s71, s68, 0
    buffer_load_dwordx4 v[80:83], v4, s[36:39], s71 offen sc1
    s_add_u32 s71, s68, 4096
    buffer_load_dwordx4 v[84:87], v4, s[36:39], s71 offen sc1
    s_add_u32 s71, s68, 8192
    buffer_load_dwordx4 v[88:91], v4, s[36:39], s71 offen sc1
    s_add_u32 s71, s68, 12288
    buffer_load_dwordx4 v[92:95], v4, s[36:39], s71 offen sc1
    s_waitcnt vmcnt(3) lgkmcnt(0)
    v_mfma_f32_32x32x16_bf16 v[16:31], v[48:51], v[80:83], 0
    v_mfma_f32_32x32x16_bf16 v[32:47], v[52:55], v[80:83], 0
    s_add_u32 s71, s68, 16384
    buffer_load_dwordx4 v[96:99], v4, s[36:39], s71 offen sc1
    ds_read_b64_tr_b16 v[48:49], v124 offset:0
    ds_read_b64_tr_b16 v[50:51], v124 offset:1024
    ds_read_b64_tr_b16 v[52:53], v125 offset:0
    ds_read_b64_tr_b16 v[54:55], v125 offset:1024
    s_waitcnt vmcnt(3)
    v_mfma_f32_32x32x16_bf16 v[16:31], v[56:59], v[84:87], v[16:31]
    v_mfma_f32_32x32x16_bf16 v[32:47], v[60:63], v[84:87], v[32:47]
    s_add_u32 s71, s68, 20480
    buffer_load_dwordx4 v[100:103], v4, s[36:39], s71 offen sc1
    ds_read_b64_tr_b16 v[56:57], v124 offset:8192
    ds_read_b64_tr_b16 v[58:59], v124 offset:9216
    ds_read_b64_tr_b16 v[60:61], v125 offset:8192
    ds_read_b64_tr_b16 v[62:63], v125 offset:9216
    s_waitcnt vmcnt(3)
    v_mfma_f32_32x32x16_bf16 v[16:31], v[64:67], v[88:91], v[16:31]
    v_mfma_f32_32x32x16_bf16 v[32:47], v[68:71], v[88:91], v[32:47]
    s_add_u32 s71, s68, 24576
    buffer_load_dwordx4 v[104:107], v4, s[36:39], s71 offen sc1
    ds_read_b64_tr_b16 v[64:65], v124 offset:16384
    ds_read_b64_tr_b16 v[66:67], v124 offset:17408
    ds_read_b64_tr_b16 v[68:69], v125 offset:16384
    ds_read_b64_tr_b16 v[70:71], v125 offset:17408
    s_waitcnt vmcnt(3)
    v_mfma_f32_32x32x16_bf16 v[16:31], v[72:75], v[92:95], v[16:31]
    v_mfma_f32_32x32x16_bf16 v[32:47], v[76:79], v[92:95], v[32:47]
    s_add_u32 s71, s68, 28672
    buffer_load_dwordx4 v[108:111], v4, s[36:39], s71 offen sc1
    s_waitcnt lgkmcnt(8)
    ds_read_b64_tr_b16 v[72:73], v124 offset:24576
    ds_read_b64_tr_b16 v[74:75], v124 offset:25600
    ds_read_b64_tr_b16 v[76:77], v125 offset:24576
    ds_read_b64_tr_b16 v[78:79], v125 offset:25600
    s_waitcnt vmcnt(3) lgkmcnt(12)
    v_mfma_f32_32x32x16_bf16 v[16:31], v[48:51], v[96:99], v[16:31]
    v_mfma_f32_32x32x16_bf16 v[32:47], v[52:55], v[96:99], v[32:47]
    s_waitcnt vmcnt(2) lgkmcnt(8)
    v_mfma_f32_32x32x16_bf16 v[16:31], v[56:59], v[100:103], v[16:31]
    v_mfma_f32_32x32x16_bf16 v[32:47], v[60:63], v[100:103], v[32:47]
    s_waitcnt vmcnt(1) lgkmcnt(4)
    v_mfma_f32_32x32x16_bf16 v[16:31], v[64:67], v[104:107], v[16:31]
    v_mfma_f32_32x32x16_bf16 v[32:47], v[68:71], v[104:107], v[32:47]
    s_waitcnt vmcnt(0) lgkmcnt(0)
    v_mfma_f32_32x32x16_bf16 v[16:31], v[72:75], v[108:111], v[16:31]
    v_mfma_f32_32x32x16_bf16 v[32:47], v[76:79], v[108:111], v[32:47]
    v_lshlrev_b32 v96, 16, v8
    v_and_b32 v97, 0xffff0000, v8
    v_lshlrev_b32 v98, 16, v9
    v_and_b32 v99, 0xffff0000, v9
    v_lshlrev_b32 v100, 16, v10
    v_and_b32 v101, 0xffff0000, v10
    v_lshlrev_b32 v102, 16, v11
    v_and_b32 v103, 0xffff0000, v11
    v_and_b32 v12, 31, v1
    v_lshlrev_b32 v80, 4, v12
    s_nop 1
    s_cmp_eq_u32 s79, 1
    s_cbranch_scc1 L_sequential_preLN__grouped_kv_mqa__dense_activation_gelu__prompt_kernel_rq_48
    s_cmp_eq_u32 s79, 2
    s_cbranch_scc1 L_sequential_preLN__grouped_kv_mqa__dense_activation_gelu__prompt_kernel_rq_49
    s_cmp_eq_u32 s79, 3
    s_cbranch_scc1 L_sequential_preLN__grouped_kv_mqa__dense_activation_gelu__prompt_kernel_rq_50
L_sequential_preLN__grouped_kv_mqa__dense_activation_gelu__prompt_kernel_rq_47:
    ds_write_b128 v14, v[24:27] offset:6144
    ds_write_b128 v14, v[28:31] offset:7168
    ds_write_b128 v14, v[32:35] offset:12288
    ds_write_b128 v14, v[36:39] offset:13312
    ds_write_b128 v14, v[40:43] offset:18432
    ds_write_b128 v14, v[44:47] offset:19456
    v_pk_add_f32 v[96:97], v[96:97], v[16:17]
    v_pk_add_f32 v[98:99], v[98:99], v[18:19]
    v_pk_add_f32 v[100:101], v[100:101], v[20:21]
    v_pk_add_f32 v[102:103], v[102:103], v[22:23]
    s_branch L_sequential_preLN__grouped_kv_mqa__dense_activation_gelu__prompt_kernel_rj_51
L_sequential_preLN__grouped_kv_mqa__dense_activation_gelu__prompt_kernel_rq_48:
    ds_write_b128 v14, v[16:19] offset:0
    ds_write_b128 v14, v[20:23] offset:1024
    ds_write_b128 v14, v[32:35] offset:14336
    ds_write_b128 v14, v[36:39] offset:15360
    ds_write_b128 v14, v[40:43] offset:20480
    ds_write_b128 v14, v[44:47] offset:21504
    v_pk_add_f32 v[96:97], v[96:97], v[24:25]
    v_pk_add_f32 v[98:99], v[98:99], v[26:27]
    v_pk_add_f32 v[100:101], v[100:101], v[28:29]
    v_pk_add_f32 v[102:103], v[102:103], v[30:31]
    s_branch L_sequential_preLN__grouped_kv_mqa__dense_activation_gelu__prompt_kernel_rj_51
L_sequential_preLN__grouped_kv_mqa__dense_activation_gelu__prompt_kernel_rq_49:
    ds_write_b128 v14, v[16:19] offset:2048
    ds_write_b128 v14, v[20:23] offset:3072
    ds_write_b128 v14, v[24:27] offset:8192
    ds_write_b128 v14, v[28:31] offset:9216
    ds_write_b128 v14, v[40:43] offset:22528
    ds_write_b128 v14, v[44:47] offset:23552
    v_pk_add_f32 v[96:97], v[96:97], v[32:33]
    v_pk_add_f32 v[98:99], v[98:99], v[34:35]
    v_pk_add_f32 v[100:101], v[100:101], v[36:37]
    v_pk_add_f32 v[102:103], v[102:103], v[38:39]
    s_branch L_sequential_preLN__grouped_kv_mqa__dense_activation_gelu__prompt_kernel_rj_51
L_sequential_preLN__grouped_kv_mqa__dense_activation_gelu__prompt_kernel_rq_50:
    ds_write_b128 v14, v[16:19] offset:4096
    ds_write_b128 v14, v[20:23] offset:5120
    ds_write_b128 v14, v[24:27] offset:10240
    ds_write_b128 v14, v[28:31] offset:11264
    ds_write_b128 v14, v[32:35] offset:16384
    ds_write_b128 v14, v[36:39] offset:17408
    v_pk_add_f32 v[96:97], v[96:97], v[40:41]
    v_pk_add_f32 v[98:99], v[98:99], v[42:43]
    v_pk_add_f32 v[100:101], v[100:101], v[44:45]
    v_pk_add_f32 v[102:103], v[102:103], v[46:47]
L_sequential_preLN__grouped_kv_mqa__dense_activation_gelu__prompt_kernel_rj_51:
    s_waitcnt lgkmcnt(0)
    s_barrier
    ds_read_b128 v[48:51], v15 offset:0
    ds_read_b128 v[52:55], v15 offset:1024
    ds_read_b128 v[56:59], v15 offset:2048
    ds_read_b128 v[60:63], v15 offset:3072
    ds_read_b128 v[64:67], v15 offset:4096
    ds_read_b128 v[68:71], v15 offset:5120
    v_mov_b32 v24, 0
    v_mov_b32 v25, 0
    s_add_u32 s68, s59, 0x10000
    s_lshr_b32 s69, s59, 2
    s_add_u32 s69, s69, 0x20000
    v_lshlrev_b32 v12, 2, v1
    s_waitcnt lgkmcnt(4)
    v_pk_add_f32 v[96:97], v[96:97], v[48:49]
    v_pk_add_f32 v[98:99], v[98:99], v[50:51]
    v_pk_add_f32 v[100:101], v[100:101], v[52:53]
    v_pk_add_f32 v[102:103], v[102:103], v[54:55]
    s_waitcnt lgkmcnt(2)
    v_pk_add_f32 v[96:97], v[96:97], v[56:57]
    v_pk_add_f32 v[98:99], v[98:99], v[58:59]
    v_pk_add_f32 v[100:101], v[100:101], v[60:61]
    v_pk_add_f32 v[102:103], v[102:103], v[62:63]
    s_waitcnt lgkmcnt(0)
    v_pk_add_f32 v[96:97], v[96:97], v[64:65]
    v_pk_add_f32 v[98:99], v[98:99], v[66:67]
    v_pk_add_f32 v[100:101], v[100:101], v[68:69]
    v_pk_add_f32 v[102:103], v[102:103], v[70:71]
    v_cvt_pk_bf16_f32 v8, v96, v97
    v_cvt_pk_bf16_f32 v9, v98, v99
    v_cvt_pk_bf16_f32 v10, v100, v101
    v_cvt_pk_bf16_f32 v11, v102, v103
    s_cmp_eq_u32 s56, 0
    s_cbranch_scc1 L_sequential_preLN__grouped_kv_mqa__dense_activation_gelu__prompt_kernel_slow_52
    buffer_store_dwordx4 v[8:11], v4, s[36:39], s68 offen
L_sequential_preLN__grouped_kv_mqa__dense_activation_gelu__prompt_kernel_pj_53:
    v_dot2c_f32_bf16 v24, s57, v8
    v_dot2c_f32_bf16 v25, v8, v8
    v_dot2c_f32_bf16 v24, s57, v9
    v_dot2c_f32_bf16 v25, v9, v9
    v_dot2c_f32_bf16 v24, s57, v10
    v_dot2c_f32_bf16 v25, v10, v10
    v_dot2c_f32_bf16 v24, s57, v11
    v_dot2c_f32_bf16 v25, v11, v11
    s_nop 2
    v_permlane32_swap_b32 v24, v25
    s_nop 0
    v_add_f32 v24, v24, v25
    s_cmp_eq_u32 s56, 0
    s_cbranch_scc1 L_sequential_preLN__grouped_kv_mqa__dense_activation_gelu__prompt_kernel_slow_54
    buffer_store_dword v24, v12, s[36:39], s69 offen
L_sequential_preLN__grouped_kv_mqa__dense_activation_gelu__prompt_kernel_pj_55:
    v_mov_b32 v2, 0
    v_mov_b32 v3, 1
    s_mov_b64 exec, 1
    s_cmp_eq_u32 s56, 0
    s_cbranch_scc1 L_sequential_preLN__grouped_kv_mqa__dense_activation_gelu__prompt_kernel_slow_56
    s_waitcnt vmcnt(0)
    buffer_store_dword v3, v2, s[36:39], s61 offen offset:256
L_sequential_preLN__grouped_kv_mqa__dense_activation_gelu__prompt_kernel_pj_57:
    s_mov_b64 exec, -1
    v_add_u32 v82, 2048, v4
    v_add_u32 v83, 67584, v4
    s_and_b32 s67, s50, 3
    s_lshl_b32 s66, s67, 13
    s_lshl_b32 s65, s52, 7
    s_add_u32 s66, s66, s65
    s_lshl_b32 s67, s67, 10
    s_mul_i32 s64, s55, s54
    s_lshl_b32 s64, s64, 16
    v_add_u32 v82, s64, v82
    s_lshl_b32 s64, s55, 10
    v_add_u32 v102, s64, v80
    v_and_b32 v104, 7, v1
    v_lshl_add_u32 v104, v104, 2, v5
    v_bfe_u32 v105, v1, 4, 1
    v_lshl_add_u32 v104, v105, 1, v104
    s_lshl_b32 s64, s53, 10
    v_lshl_add_u32 v105, v104, 4, s64
    v_lshlrev_b32 v2, 2, v1
    s_mov_b32 s64, 0x24000
    v_mov_b32 v112, s57
    v_mov_b32 v113, s57
    s_cmp_lg_u32 s50, 0
    s_cbranch_scc1 L_sequential_preLN__grouped_kv_mqa__dense_activation_gelu__prompt_kernel_pollw_60
    buffer_load_dword v3, v2, s[36:39], s64 offen offset:256 sc1
L_sequential_preLN__grouped_kv_mqa__dense_activation_gelu__prompt_kernel_pollw_60:
    v_mfma_f32_4x4x4_16b_bf16 v[48:51], v[112:113], a[64:65], 0
    v_mfma_f32_4x4x4_16b_bf16 v[52:55], v[112:113], a[66:67], 0
    v_mfma_f32_4x4x4_16b_bf16 v[56:59], v[112:113], a[68:69], 0
    v_mfma_f32_4x4x4_16b_bf16 v[60:63], v[112:113], a[70:71], 0
    v_mfma_f32_4x4x4_16b_bf16 v[48:51], v[112:113], a[72:73], v[48:51]
    v_mfma_f32_4x4x4_16b_bf16 v[52:55], v[112:113], a[74:75], v[52:55]
    v_mfma_f32_4x4x4_16b_bf16 v[56:59], v[112:113], a[76:77], v[56:59]
    v_mfma_f32_4x4x4_16b_bf16 v[60:63], v[112:113], a[78:79], v[60:63]
    v_mfma_f32_4x4x4_16b_bf16 v[48:51], v[112:113], a[80:81], v[48:51]
    v_mfma_f32_4x4x4_16b_bf16 v[52:55], v[112:113], a[82:83], v[52:55]
    v_mfma_f32_4x4x4_16b_bf16 v[56:59], v[112:113], a[84:85], v[56:59]
    v_mfma_f32_4x4x4_16b_bf16 v[60:63], v[112:113], a[86:87], v[60:63]
    v_mfma_f32_4x4x4_16b_bf16 v[48:51], v[112:113], a[88:89], v[48:51]
    v_mfma_f32_4x4x4_16b_bf16 v[52:55], v[112:113], a[90:91], v[52:55]
    v_mfma_f32_4x4x4_16b_bf16 v[56:59], v[112:113], a[92:93], v[56:59]
    v_mfma_f32_4x4x4_16b_bf16 v[60:63], v[112:113], a[94:95], v[60:63]
    v_mfma_f32_4x4x4_16b_bf16 v[48:51], v[112:113], a[96:97], v[48:51]
    v_mfma_f32_4x4x4_16b_bf16 v[52:55], v[112:113], a[98:99], v[52:55]
    v_mfma_f32_4x4x4_16b_bf16 v[56:59], v[112:113], a[100:101], v[56:59]
    v_mfma_f32_4x4x4_16b_bf16 v[60:63], v[112:113], a[102:103], v[60:63]
    v_mfma_f32_4x4x4_16b_bf16 v[48:51], v[112:113], a[104:105], v[48:51]
    v_mfma_f32_4x4x4_16b_bf16 v[52:55], v[112:113], a[106:107], v[52:55]
    v_mfma_f32_4x4x4_16b_bf16 v[56:59], v[112:113], a[108:109], v[56:59]
    v_mfma_f32_4x4x4_16b_bf16 v[60:63], v[112:113], a[110:111], v[60:63]
    v_mfma_f32_4x4x4_16b_bf16 v[48:51], v[112:113], a[112:113], v[48:51]
    v_mfma_f32_4x4x4_16b_bf16 v[52:55], v[112:113], a[114:115], v[52:55]
    v_mfma_f32_4x4x4_16b_bf16 v[56:59], v[112:113], a[116:117], v[56:59]
    v_mfma_f32_4x4x4_16b_bf16 v[60:63], v[112:113], a[118:119], v[60:63]
    v_mfma_f32_4x4x4_16b_bf16 v[48:51], v[112:113], a[120:121], v[48:51]
    v_mfma_f32_4x4x4_16b_bf16 v[52:55], v[112:113], a[122:123], v[52:55]
    v_mfma_f32_4x4x4_16b_bf16 v[56:59], v[112:113], a[124:125], v[56:59]
    v_mfma_f32_4x4x4_16b_bf16 v[60:63], v[112:113], a[126:127], v[60:63]
    s_nop 3
    v_add_f32 v48, v48, v52
    v_add_f32 v56, v56, v60
    v_add_f32 v48, v48, v122
    v_add_f32 v122, v48, v56
    s_cmp_lg_u32 s50, 0
    s_cbranch_scc1 L_sequential_preLN__grouped_kv_mqa__dense_activation_gelu__prompt_kernel_polld_59
    s_branch L_sequential_preLN__grouped_kv_mqa__dense_activation_gelu__prompt_kernel_pollc_61
L_sequential_preLN__grouped_kv_mqa__dense_activation_gelu__prompt_kernel_poll_58:
    buffer_load_dword v3, v2, s[36:39], s64 offen offset:256 sc1
    s_sub_u32 s62, s62, 1
    s_cbranch_scc1 L_sequential_preLN__grouped_kv_mqa__dense_activation_gelu__prompt_kernel_to_62
L_sequential_preLN__grouped_kv_mqa__dense_activation_gelu__prompt_kernel_pollc_61:
    s_waitcnt vmcnt(0)
    v_cmp_ne_u32 vcc, 1, v3
    s_nop 1
    s_cmp_lg_u64 vcc, 0
    s_cbranch_scc1 L_sequential_preLN__grouped_kv_mqa__dense_activation_gelu__prompt_kernel_poll_58
L_sequential_preLN__grouped_kv_mqa__dense_activation_gelu__prompt_kernel_polld_59:
    s_barrier
    s_cmp_ge_u32 s50, 4
    s_cbranch_scc1 L_sequential_preLN__grouped_kv_mqa__dense_activation_gelu__prompt_kernel_half_63
    s_add_u32 m0, s67, 2048
    s_add_u32 s71, s67, 65536
    buffer_load_dwordx4 v4, s[36:39], s71 offen sc1 lds
    s_add_u32 m0, s67, 6144
    s_add_u32 s71, s67, 69632
    buffer_load_dwordx4 v4, s[36:39], s71 offen sc1 lds
    s_add_u32 m0, s67, 10240
    s_add_u32 s71, s67, 73728
    buffer_load_dwordx4 v4, s[36:39], s71 offen sc1 lds
    s_add_u32 m0, s67, 14336
    s_add_u32 s71, s67, 77824
    buffer_load_dwordx4 v4, s[36:39], s71 offen sc1 lds
    s_add_u32 m0, s67, 18432
    s_add_u32 s71, s67, 81920
    buffer_load_dwordx4 v4, s[36:39], s71 offen sc1 lds
    s_add_u32 m0, s67, 22528
    s_add_u32 s71, s67, 86016
    buffer_load_dwordx4 v4, s[36:39], s71 offen sc1 lds
    s_add_u32 m0, s67, 26624
    s_add_u32 s71, s67, 90112
    buffer_load_dwordx4 v4, s[36:39], s71 offen sc1 lds
    s_add_u32 m0, s67, 30720
    s_add_u32 s71, s67, 94208
    buffer_load_dwordx4 v4, s[36:39], s71 offen sc1 lds
    s_waitcnt vmcnt(4)
    s_barrier
    ds_read_b128 v[48:51], v82 offset:0
    ds_read_b128 v[52:55], v82 offset:1024
    ds_read_b128 v[56:59], v82 offset:2048
    ds_read_b128 v[60:63], v82 offset:3072
    s_waitcnt lgkmcnt(3)
    v_mfma_f32_32x32x16_bf16 v[16:31], a[0:3], v[48:51], 0
    ds_read_b128 v[64:67], v82 offset:4096
    s_waitcnt lgkmcnt(3)
    v_mfma_f32_32x32x16_bf16 v[16:31], a[4:7], v[52:55], v[16:31]
    ds_read_b128 v[68:71], v82 offset:5120
    s_waitcnt lgkmcnt(3)
    v_mfma_f32_32x32x16_bf16 v[16:31], a[8:11], v[56:59], v[16:31]
    ds_read_b128 v[72:75], v82 offset:6144
    s_waitcnt lgkmcnt(3)
    v_mfma_f32_32x32x16_bf16 v[16:31], a[12:15], v[60:63], v[16:31]
    ds_read_b128 v[76:79], v82 offset:7168
    s_waitcnt lgkmcnt(3)
    v_mfma_f32_32x32x16_bf16 v[16:31], a[16:19], v[64:67], v[16:31]
    ds_read_b128 v[48:51], v82 offset:8192
    s_waitcnt lgkmcnt(3)
    v_mfma_f32_32x32x16_bf16 v[16:31], a[20:23], v[68:71], v[16:31]
    ds_read_b128 v[52:55], v82 offset:9216
    s_waitcnt lgkmcnt(3)
    v_mfma_f32_32x32x16_bf16 v[16:31], a[24:27], v[72:75], v[16:31]
    ds_read_b128 v[56:59], v82 offset:10240
    s_waitcnt lgkmcnt(3)
    v_mfma_f32_32x32x16_bf16 v[16:31], a[28:31], v[76:79], v[16:31]
    ds_read_b128 v[60:63], v82 offset:11264
    s_waitcnt lgkmcnt(3)
    v_mfma_f32_32x32x16_bf16 v[16:31], a[32:35], v[48:51], v[16:31]
    ds_read_b128 v[64:67], v82 offset:12288
    s_waitcnt lgkmcnt(3)
    v_mfma_f32_32x32x16_bf16 v[16:31], a[36:39], v[52:55], v[16:31]
    ds_read_b128 v[68:71], v82 offset:13312
    s_waitcnt lgkmcnt(3)
    v_mfma_f32_32x32x16_bf16 v[16:31], a[40:43], v[56:59], v[16:31]
    ds_read_b128 v[72:75], v82 offset:14336
    s_waitcnt lgkmcnt(3)
    v_mfma_f32_32x32x16_bf16 v[16:31], a[44:47], v[60:63], v[16:31]
    ds_read_b128 v[76:79], v82 offset:15360
    s_waitcnt lgkmcnt(3)
    v_mfma_f32_32x32x16_bf16 v[16:31], a[48:51], v[64:67], v[16:31]
    v_mov_b32 v123, v122
    s_nop 1
    v_permlane32_swap_b32 v122, v123
    s_nop 0
    v_add_f32 v122, v122, v123
    v_cvt_pk_bf16_f32 v106, v122, v122
    v_and_b32 v107, 0xffff0000, v106
    v_sub_f32 v107, v122, v107
    v_cvt_pk_bf16_f32 v112, v122, v107
    v_and_b32 v106, 0xffff, v106
    v_lshl_or_b32 v113, v114, 16, v106
    v_mov_b32 v115, 0
    s_mov_b32 exec_lo, 0
    v_mov_b32 v112, 0
    v_mov_b32 v113, 0
    v_mov_b32 v114, 0
    s_mov_b32 exec_lo, -1
    s_waitcnt vmcnt(0)
    s_barrier
    ds_read_b128 v[48:51], v82 offset:16384
    s_waitcnt lgkmcnt(3)
    v_mfma_f32_32x32x16_bf16 v[16:31], a[52:55], v[68:71], v[16:31]
    ds_read_b128 v[52:55], v82 offset:17408
    s_waitcnt lgkmcnt(3)
    v_mfma_f32_32x32x16_bf16 v[16:31], a[56:59], v[72:75], v[16:31]
    ds_read_b128 v[56:59], v82 offset:18432
    s_waitcnt lgkmcnt(3)
    v_mfma_f32_32x32x16_bf16 v[16:31], a[60:63], v[76:79], v[16:31]
    ds_read_b128 v[60:63], v82 offset:19456
    s_waitcnt lgkmcnt(3)
    v_mfma_f32_32x32x16_bf16 v[16:31], a[64:67], v[48:51], v[16:31]
    ds_read_b128 v[64:67], v82 offset:20480
    s_waitcnt lgkmcnt(3)
    v_mfma_f32_32x32x16_bf16 v[16:31], a[68:71], v[52:55], v[16:31]
    ds_read_b128 v[68:71], v82 offset:21504
    s_waitcnt lgkmcnt(3)
    v_mfma_f32_32x32x16_bf16 v[16:31], a[72:75], v[56:59], v[16:31]
    ds_read_b128 v[72:75], v82 offset:22528
    s_waitcnt lgkmcnt(3)
    v_mfma_f32_32x32x16_bf16 v[16:31], a[76:79], v[60:63], v[16:31]
    ds_read_b128 v[76:79], v82 offset:23552
    s_waitcnt lgkmcnt(3)
    v_mfma_f32_32x32x16_bf16 v[16:31], a[80:83], v[64:67], v[16:31]
    ds_read_b128 v[48:51], v82 offset:24576
    s_waitcnt lgkmcnt(3)
    v_mfma_f32_32x32x16_bf16 v[16:31], a[84:87], v[68:71], v[16:31]
    ds_read_b128 v[52:55], v82 offset:25600
    s_waitcnt lgkmcnt(3)
    v_mfma_f32_32x32x16_bf16 v[16:31], a[88:91], v[72:75], v[16:31]
    ds_read_b128 v[56:59], v82 offset:26624
    s_waitcnt lgkmcnt(3)
    v_mfma_f32_32x32x16_bf16 v[16:31], a[92:95], v[76:79], v[16:31]
    ds_read_b128 v[60:63], v82 offset:27648
    s_waitcnt lgkmcnt(3)
    v_mfma_f32_32x32x16_bf16 v[16:31], a[96:99], v[48:51], v[16:31]
    ds_read_b128 v[64:67], v82 offset:28672
    s_waitcnt lgkmcnt(3)
    v_mfma_f32_32x32x16_bf16 v[16:31], a[100:103], v[52:55], v[16:31]
    ds_read_b128 v[68:71], v82 offset:29696
    s_waitcnt lgkmcnt(3)
    v_mfma_f32_32x32x16_bf16 v[16:31], a[104:107], v[56:59], v[16:31]
    ds_read_b128 v[72:75], v82 offset:30720
    s_waitcnt lgkmcnt(3)
    v_mfma_f32_32x32x16_bf16 v[16:31], a[108:111], v[60:63], v[16:31]
    ds_read_b128 v[76:79], v82 offset:31744
    s_waitcnt lgkmcnt(3)
    v_mfma_f32_32x32x16_bf16 v[16:31], a[112:115], v[64:67], v[16:31]
    s_barrier
    ds_read_b128 v[84:87], v80 offset:0
    ds_read_b128 v[92:95], v80 offset:512
    ds_read_b128 v[88:91], v80 offset:1024
    ds_read_b128 v[96:99], v80 offset:1536
    s_waitcnt lgkmcnt(6)
    v_mfma_f32_32x32x16_bf16 v[16:31], a[116:119], v[68:71], v[16:31]
    s_waitcnt lgkmcnt(5)
    v_mfma_f32_32x32x16_bf16 v[16:31], a[120:123], v[72:75], v[16:31]
    s_waitcnt lgkmcnt(4)
    v_mfma_f32_32x32x16_bf16 v[16:31], a[124:127], v[76:79], v[16:31]
    s_waitcnt lgkmcnt(0)
    v_mfma_f32_32x32x16_bf16 v[16:31], v[112:115], v[84:87], v[16:31]
    v_lshlrev_b32 v104, 7, v1
    s_add_u32 m0, s67, 116736
    s_add_u32 s71, s66, 393216
    buffer_load_dwordx4 v6, s[80:83], s71 offen  lds
    s_add_u32 m0, s67, 120832
    s_add_u32 s71, s66, 425984
    buffer_load_dwordx4 v6, s[80:83], s71 offen  lds
    s_add_u32 m0, s67, 124928
    s_add_u32 s71, s66, 458752
    buffer_load_dwordx4 v6, s[80:83], s71 offen  lds
    s_add_u32 m0, s67, 129024
    s_add_u32 s71, s66, 491520
    buffer_load_dwordx4 v6, s[80:83], s71 offen  lds
    v_mul_f32 v64, v16, v16
    v_mul_f32 v65, v17, v17
    v_mul_f32 v66, v18, v18
    s_add_u32 m0, s67, 100352
    v_mul_f32 v67, v19, v19
    v_mul_f32 v68, v20, v20
    v_mul_f32 v69, v21, v21
    s_add_u32 s71, s66, 589824
    v_mul_f32 v70, v22, v22
    v_mul_f32 v71, v23, v23
    v_mul_f32 v72, v24, v24
    buffer_load_dwordx4 v6, s[80:83], s71 offen  lds
    v_mul_f32 v73, v25, v25
    v_mul_f32 v74, v26, v26
    v_mul_f32 v75, v27, v27
    s_add_u32 m0, s67, 104448
    v_mul_f32 v76, v28, v28
    v_mul_f32 v77, v29, v29
    v_mul_f32 v78, v30, v30
    s_add_u32 s71, s66, 622592
    v_mul_f32 v79, v31, v31
    v_fma_f32 v64, v64, v93, v92
    v_fma_f32 v65, v65, v93, v92
    buffer_load_dwordx4 v6, s[80:83], s71 offen  lds
    v_fma_f32 v66, v66, v93, v92
    v_fma_f32 v67, v67, v93, v92
    v_fma_f32 v68, v68, v93, v92
    s_add_u32 m0, s67, 108544
    v_fma_f32 v69, v69, v93, v92
    v_fma_f32 v70, v70, v93, v92
    v_fma_f32 v71, v71, v93, v92
    s_add_u32 s71, s66, 655360
    v_fma_f32 v72, v72, v93, v92
    v_fma_f32 v73, v73, v93, v92
    v_fma_f32 v74, v74, v93, v92
    buffer_load_dwordx4 v6, s[80:83], s71 offen  lds
    v_fma_f32 v75, v75, v93, v92
    v_fma_f32 v76, v76, v93, v92
    v_fma_f32 v77, v77, v93, v92
    s_add_u32 m0, s67, 112640
    v_fma_f32 v78, v78, v93, v92
    v_fma_f32 v79, v79, v93, v92
    v_mul_f32 v64, v64, v16
    s_add_u32 s71, s66, 688128
    v_mul_f32 v65, v65, v17
    v_mul_f32 v66, v66, v18
    v_mul_f32 v67, v67, v19
    buffer_load_dwordx4 v6, s[80:83], s71 offen  lds
    v_mul_f32 v68, v68, v20
    v_mul_f32 v69, v69, v21
    v_mul_f32 v70, v70, v22
    s_add_u32 m0, s67, 151552
    v_mul_f32 v71, v71, v23
    v_mul_f32 v72, v72, v24
    v_mul_f32 v73, v73, v25
    s_add_u32 s71, s66, 1048576
    v_mul_f32 v74, v74, v26
    v_mul_f32 v75, v75, v27
    v_mul_f32 v76, v76, v28
    buffer_load_dwordx4 v6, s[80:83], s71 offen  lds
    v_mul_f32 v77, v77, v29
    v_mul_f32 v78, v78, v30
    v_mul_f32 v79, v79, v31
    s_add_u32 m0, s67, 155648
    v_exp_f32 v64, v64
    v_exp_f32 v65, v65
    v_exp_f32 v66, v66
    s_add_u32 s71, s66, 1212416
    v_exp_f32 v67, v67
    v_exp_f32 v68, v68
    v_exp_f32 v69, v69
    buffer_load_dwordx4 v6, s[80:83], s71 offen  lds
    v_exp_f32 v70, v70
    v_exp_f32 v71, v71
    v_exp_f32 v72, v72
    s_add_u32 m0, s67, 159744
    v_exp_f32 v73, v73
    v_exp_f32 v74, v74
    v_exp_f32 v75, v75
    s_add_u32 s71, s66, 1376256
    v_exp_f32 v76, v76
    v_exp_f32 v77, v77
    v_exp_f32 v78, v78
    buffer_load_dwordx4 v6, s[80:83], s71 offen  lds
    v_exp_f32 v79, v79
    v_fma_f32 v64, v64, v94, v94
    v_fma_f32 v65, v65, v94, v94
    s_add_u32 m0, s67, 133120
    v_fma_f32 v66, v66, v94, v94
    v_fma_f32 v67, v67, v94, v94
    v_fma_f32 v68, v68, v94, v94
    s_add_u32 s71, s66, 131072
    v_fma_f32 v69, v69, v94, v94
    v_fma_f32 v70, v70, v94, v94
    v_fma_f32 v71, v71, v94, v94
    buffer_load_dwordx4 v6, s[80:83], s71 offen  lds
    v_fma_f32 v72, v72, v94, v94
    v_fma_f32 v73, v73, v94, v94
    v_fma_f32 v74, v74, v94, v94
    s_add_u32 m0, s67, 137216
    v_fma_f32 v75, v75, v94, v94
    v_fma_f32 v76, v76, v94, v94
    v_fma_f32 v77, v77, v94, v94
    s_add_u32 s71, s66, 163840
    v_fma_f32 v78, v78, v94, v94
    v_fma_f32 v79, v79, v94, v94
    v_rcp_f32 v64, v64
    buffer_load_dwordx4 v6, s[80:83], s71 offen  lds
    v_rcp_f32 v65, v65
    v_rcp_f32 v66, v66
    v_rcp_f32 v67, v67
    s_add_u32 m0, s67, 141312
    v_rcp_f32 v68, v68
    v_rcp_f32 v69, v69
    v_rcp_f32 v70, v70
    s_add_u32 s71, s66, 327680
    v_rcp_f32 v71, v71
    v_rcp_f32 v72, v72
    v_rcp_f32 v73, v73
    buffer_load_dwordx4 v6, s[80:83], s71 offen  lds
    v_rcp_f32 v74, v74
    v_rcp_f32 v75, v75
    v_rcp_f32 v76, v76
    s_add_u32 m0, s67, 145408
    v_rcp_f32 v77, v77
    v_rcp_f32 v78, v78
    v_rcp_f32 v79, v79
    s_add_u32 s71, s66, 360448
    v_mul_f32 v64, v16, v64
    v_mul_f32 v65, v17, v65
    v_mul_f32 v66, v18, v66
    buffer_load_dwordx4 v6, s[80:83], s71 offen  lds
    v_mul_f32 v67, v19, v67
    v_mul_f32 v68, v20, v68
    v_mul_f32 v69, v21, v69
    v_mul_f32 v70, v22, v70
    v_mul_f32 v71, v23, v71
    v_mul_f32 v72, v24, v72
    v_mul_f32 v73, v25, v73
    v_mul_f32 v74, v26, v74
    v_mul_f32 v75, v27, v75
    v_mul_f32 v76, v28, v76
    v_mul_f32 v77, v29, v77
    v_mul_f32 v78, v30, v78
    v_mul_f32 v79, v31, v79
    v_cvt_pk_bf16_f32 v16, v64, v65
    v_cvt_pk_bf16_f32 v17, v66, v67
    v_cvt_pk_bf16_f32 v18, v68, v69
    v_cvt_pk_bf16_f32 v19, v70, v71
    v_cvt_pk_bf16_f32 v20, v72, v73
    v_cvt_pk_bf16_f32 v21, v74, v75
    v_cvt_pk_bf16_f32 v22, v76, v77
    v_cvt_pk_bf16_f32 v23, v78, v79
    s_lshl_b32 s69, s52, 13
    s_add_u32 s69, s69, s78
    s_add_u32 s69, s69, 0x30000
    buffer_store_dwordx4 v[16:19], v4, s[36:39], s69 offen sc1
    buffer_store_dwordx4 v[20:23], v4, s[36:39], s69 offen offset:1024 sc1
    ds_read_b128 v[48:51], v83 offset:0
    ds_read_b128 v[52:55], v83 offset:1024
    ds_read_b128 v[56:59], v83 offset:2048
    ds_read_b128 v[60:63], v83 offset:3072
    s_waitcnt vmcnt(9)
    s_barrier
    ds_read_b128 v[64:67], v83 offset:4096
    s_waitcnt lgkmcnt(4)
    v_mfma_f32_32x32x16_bf16 v[32:47], a[0:3], v[48:51], 0
    ds_read_b64_tr_b16 a[0:1], v120 offset:32768
    ds_read_b64_tr_b16 a[2:3], v120 offset:33792
    ds_read_b128 v[68:71], v83 offset:5120
    s_waitcnt lgkmcnt(6)
    v_mfma_f32_32x32x16_bf16 v[32:47], a[4:7], v[52:55], v[32:47]
    v_mfma_f32_32x32x16_bf16 v[32:47], v[112:115], v[88:91], v[32:47]
    ds_read_b64_tr_b16 a[4:5], v121 offset:32768
    ds_read_b64_tr_b16 a[6:7], v121 offset:33792
    ds_read_b128 v[72:75], v83 offset:6144
    s_waitcnt lgkmcnt(8)
    v_mfma_f32_32x32x16_bf16 v[32:47], a[8:11], v[56:59], v[32:47]
    ds_read_b64_tr_b16 a[8:9], v120 offset:40960
    ds_read_b64_tr_b16 a[10:11], v120 offset:41984
    ds_read_b128 v[76:79], v83 offset:7168
    s_waitcnt lgkmcnt(9)
    v_mfma_f32_32x32x16_bf16 v[32:47], a[12:15], v[60:63], v[32:47]
    ds_read_b64_tr_b16 a[12:13], v121 offset:40960
    ds_read_b64_tr_b16 a[14:15], v121 offset:41984
    ds_read_b128 v[48:51], v83 offset:8192
    s_waitcnt lgkmcnt(9)
    v_mfma_f32_32x32x16_bf16 v[32:47], a[16:19], v[64:67], v[32:47]
    ds_read_b64_tr_b16 a[16:17], v120 offset:49152
    ds_read_b64_tr_b16 a[18:19], v120 offset:50176
    ds_read_b128 v[52:55], v83 offset:9216
    s_waitcnt lgkmcnt(9)
    v_mfma_f32_32x32x16_bf16 v[32:47], a[20:23], v[68:71], v[32:47]
    ds_read_b64_tr_b16 a[20:21], v121 offset:49152
    ds_read_b64_tr_b16 a[22:23], v121 offset:50176
    ds_read_b128 v[56:59], v83 offset:10240
    s_waitcnt lgkmcnt(9)
    v_mfma_f32_32x32x16_bf16 v[32:47], a[24:27], v[72:75], v[32:47]
    ds_read_b64_tr_b16 a[24:25], v120 offset:57344
    ds_read_b64_tr_b16 a[26:27], v120 offset:58368
    ds_read_b128 v[60:63], v83 offset:11264
    s_waitcnt lgkmcnt(9)
    v_mfma_f32_32x32x16_bf16 v[32:47], a[28:31], v[76:79], v[32:47]
    ds_read_b64_tr_b16 a[28:29], v121 offset:57344
    ds_read_b64_tr_b16 a[30:31], v121 offset:58368
    ds_read_b128 v[64:67], v83 offset:12288
    s_waitcnt lgkmcnt(9)
    v_mfma_f32_32x32x16_bf16 v[32:47], a[32:35], v[48:51], v[32:47]
    ds_read_b128 v[68:71], v83 offset:13312
    s_waitcnt lgkmcnt(9)
    v_mfma_f32_32x32x16_bf16 v[32:47], a[36:39], v[52:55], v[32:47]
    ds_read_b128 v[72:75], v83 offset:14336
    s_waitcnt lgkmcnt(8)
    v_mfma_f32_32x32x16_bf16 v[32:47], a[40:43], v[56:59], v[32:47]
    ds_read_b128 v[76:79], v83 offset:15360
    s_waitcnt lgkmcnt(6)
    v_mfma_f32_32x32x16_bf16 v[32:47], a[44:47], v[60:63], v[32:47]
    s_waitcnt lgkmcnt(4)
    s_barrier
    ds_read_b128 v[48:51], v83 offset:16384
    s_waitcnt lgkmcnt(4)
    v_mfma_f32_32x32x16_bf16 v[32:47], a[48:51], v[64:67], v[32:47]
    ds_read_b64_tr_b16 a[32:33], v124 offset:49152
    ds_read_b128 v[52:55], v83 offset:17408
    s_waitcnt lgkmcnt(5)
    v_mfma_f32_32x32x16_bf16 v[32:47], a[52:55], v[68:71], v[32:47]
    ds_read_b64_tr_b16 a[34:35], v124 offset:50176
    ds_read_b128 v[56:59], v83 offset:18432
    s_waitcnt lgkmcnt(6)
    v_mfma_f32_32x32x16_bf16 v[32:47], a[56:59], v[72:75], v[32:47]
    ds_read_b64_tr_b16 a[36:37], v125 offset:49152
    ds_read_b128 v[60:63], v83 offset:19456
    s_waitcnt lgkmcnt(7)
    v_mfma_f32_32x32x16_bf16 v[32:47], a[60:63], v[76:79], v[32:47]
    ds_read_b64_tr_b16 a[38:39], v125 offset:50176
    ds_read_b128 v[64:67], v83 offset:20480
    s_waitcnt lgkmcnt(8)
    v_mfma_f32_32x32x16_bf16 v[32:47], a[64:67], v[48:51], v[32:47]
    ds_read_b64_tr_b16 a[40:41], v124 offset:57344
    ds_read_b128 v[68:71], v83 offset:21504
    s_waitcnt lgkmcnt(8)
    v_mfma_f32_32x32x16_bf16 v[32:47], a[68:71], v[52:55], v[32:47]
    ds_read_b64_tr_b16 a[42:43], v124 offset:58368
    ds_read_b128 v[72:75], v83 offset:22528
    s_waitcnt lgkmcnt(8)
    v_mfma_f32_32x32x16_bf16 v[32:47], a[72:75], v[56:59], v[32:47]
    ds_read_b64_tr_b16 a[44:45], v125 offset:57344
    ds_read_b128 v[76:79], v83 offset:23552
    s_waitcnt lgkmcnt(8)
    v_mfma_f32_32x32x16_bf16 v[32:47], a[76:79], v[60:63], v[32:47]
    ds_read_b64_tr_b16 a[46:47], v125 offset:58368
    ds_read_b128 v[48:51], v83 offset:24576
    s_waitcnt lgkmcnt(8)
    v_mfma_f32_32x32x16_bf16 v[32:47], a[80:83], v[64:67], v[32:47]
    ds_read_b64_tr_b16 a[48:49], v124 offset:32768
    ds_read_b128 v[52:55], v83 offset:25600
    s_waitcnt lgkmcnt(8)
    v_mfma_f32_32x32x16_bf16 v[32:47], a[84:87], v[68:71], v[32:47]
    v_mov_b32 v2, 0
    v_mov_b32 v3, 1
    s_mov_b64 exec, 1
    s_cmp_eq_u32 s56, 0
    s_cbranch_scc1 L_sequential_preLN__grouped_kv_mqa__dense_activation_gelu__prompt_kernel_slow_65
    s_waitcnt vmcnt(0)
    buffer_store_dword v3, v2, s[36:39], s61 offen offset:512
L_sequential_preLN__grouped_kv_mqa__dense_activation_gelu__prompt_kernel_pj_66:
    s_mov_b64 exec, -1
    s_mov_b64 exec, 0xffff
    buffer_load_dword v106, v104, s[36:39], s69 offen sc1
    s_mov_b64 exec, -1
    ds_read_b64_tr_b16 a[50:51], v124 offset:33792
    ds_read_b128 v[56:59], v83 offset:26624
    s_waitcnt lgkmcnt(8)
    v_mfma_f32_32x32x16_bf16 v[32:47], a[88:91], v[72:75], v[32:47]
    ds_read_b64_tr_b16 a[52:53], v125 offset:32768
    ds_read_b128 v[60:63], v83 offset:27648
    s_waitcnt lgkmcnt(8)
    v_mfma_f32_32x32x16_bf16 v[32:47], a[92:95], v[76:79], v[32:47]
    ds_read_b64_tr_b16 a[54:55], v125 offset:33792
    ds_read_b128 v[64:67], v83 offset:28672
    s_waitcnt lgkmcnt(8)
    v_mfma_f32_32x32x16_bf16 v[32:47], a[96:99], v[48:51], v[32:47]
    ds_read_b64_tr_b16 a[56:57], v124 offset:40960
    ds_read_b128 v[68:71], v83 offset:29696
    s_waitcnt lgkmcnt(8)
    v_mfma_f32_32x32x16_bf16 v[32:47], a[100:103], v[52:55], v[32:47]
    ds_read_b64_tr_b16 a[58:59], v124 offset:41984
    ds_read_b128 v[72:75], v83 offset:30720
    s_waitcnt lgkmcnt(8)
    v_mfma_f32_32x32x16_bf16 v[32:47], a[104:107], v[56:59], v[32:47]
    ds_read_b64_tr_b16 a[60:61], v125 offset:40960
    ds_read_b128 v[76:79], v83 offset:31744
    s_waitcnt lgkmcnt(8)
    v_mfma_f32_32x32x16_bf16 v[32:47], a[108:111], v[60:63], v[32:47]
    ds_read_b64_tr_b16 a[62:63], v125 offset:41984
    s_waitcnt lgkmcnt(7)
    v_mfma_f32_32x32x16_bf16 v[32:47], a[112:115], v[64:67], v[32:47]
    s_waitcnt lgkmcnt(5)
    v_mfma_f32_32x32x16_bf16 v[32:47], a[116:119], v[68:71], v[32:47]
    s_waitcnt lgkmcnt(3)
    v_mfma_f32_32x32x16_bf16 v[32:47], a[120:123], v[72:75], v[32:47]
    s_waitcnt lgkmcnt(1)
    v_mfma_f32_32x32x16_bf16 v[32:47], a[124:127], v[76:79], v[32:47]
    s_nop 7
    s_nop 3
    v_pk_mul_f32 v[64:65], v[32:33], v[32:33]
    v_pk_mul_f32 v[66:67], v[34:35], v[34:35]
    v_pk_mul_f32 v[68:69], v[36:37], v[36:37]
    v_pk_mul_f32 v[70:71], v[38:39], v[38:39]
    v_pk_mul_f32 v[72:73], v[40:41], v[40:41]
    v_pk_mul_f32 v[74:75], v[42:43], v[42:43]
    v_pk_mul_f32 v[76:77], v[44:45], v[44:45]
    v_pk_mul_f32 v[78:79], v[46:47], v[46:47]
    v_pk_fma_f32 v[64:65], v[64:65], v[96:97], v[96:97] op_sel:[0,1,0] op_sel_hi:[1,1,0]
    v_pk_fma_f32 v[66:67], v[66:67], v[96:97], v[96:97] op_sel:[0,1,0] op_sel_hi:[1,1,0]
    v_pk_fma_f32 v[68:69], v[68:69], v[96:97], v[96:97] op_sel:[0,1,0] op_sel_hi:[1,1,0]
    v_pk_fma_f32 v[70:71], v[70:71], v[96:97], v[96:97] op_sel:[0,1,0] op_sel_hi:[1,1,0]
    v_pk_fma_f32 v[72:73], v[72:73], v[96:97], v[96:97] op_sel:[0,1,0] op_sel_hi:[1,1,0]
    v_pk_fma_f32 v[74:75], v[74:75], v[96:97], v[96:97] op_sel:[0,1,0] op_sel_hi:[1,1,0]
    v_pk_fma_f32 v[76:77], v[76:77], v[96:97], v[96:97] op_sel:[0,1,0] op_sel_hi:[1,1,0]
    v_pk_fma_f32 v[78:79], v[78:79], v[96:97], v[96:97] op_sel:[0,1,0] op_sel_hi:[1,1,0]
    v_pk_mul_f32 v[64:65], v[64:65], v[32:33]
    v_pk_mul_f32 v[66:67], v[66:67], v[34:35]
    v_pk_mul_f32 v[68:69], v[68:69], v[36:37]
    v_pk_mul_f32 v[70:71], v[70:71], v[38:39]
    v_pk_mul_f32 v[72:73], v[72:73], v[40:41]
    v_pk_mul_f32 v[74:75], v[74:75], v[42:43]
    v_pk_mul_f32 v[76:77], v[76:77], v[44:45]
    v_pk_mul_f32 v[78:79], v[78:79], v[46:47]
    v_exp_f32 v64, v64
    v_exp_f32 v65, v65
    v_exp_f32 v66, v66
    v_exp_f32 v67, v67
    v_exp_f32 v68, v68
    v_exp_f32 v69, v69
    v_exp_f32 v70, v70
    v_exp_f32 v71, v71
    v_exp_f32 v72, v72
    v_exp_f32 v73, v73
    v_exp_f32 v74, v74
    v_exp_f32 v75, v75
    v_exp_f32 v76, v76
    v_exp_f32 v77, v77
    v_exp_f32 v78, v78
    v_exp_f32 v79, v79
    v_pk_fma_f32 v[64:65], v[64:65], v[98:99], v[98:99]
    v_pk_fma_f32 v[66:67], v[66:67], v[98:99], v[98:99]
    v_pk_fma_f32 v[68:69], v[68:69], v[98:99], v[98:99]
    v_pk_fma_f32 v[70:71], v[70:71], v[98:99], v[98:99]
    v_pk_fma_f32 v[72:73], v[72:73], v[98:99], v[98:99]
    v_pk_fma_f32 v[74:75], v[74:75], v[98:99], v[98:99]
    v_pk_fma_f32 v[76:77], v[76:77], v[98:99], v[98:99]
    v_pk_fma_f32 v[78:79], v[78:79], v[98:99], v[98:99]
    v_rcp_f32 v64, v64
    v_rcp_f32 v65, v65
    v_rcp_f32 v66, v66
    v_rcp_f32 v67, v67
    v_rcp_f32 v68, v68
    v_rcp_f32 v69, v69
    v_rcp_f32 v70, v70
    v_rcp_f32 v71, v71
    v_rcp_f32 v72, v72
    v_rcp_f32 v73, v73
    v_rcp_f32 v74, v74
    v_rcp_f32 v75, v75
    v_rcp_f32 v76, v76
    v_rcp_f32 v77, v77
    v_rcp_f32 v78, v78
    v_rcp_f32 v79, v79
    v_pk_mul_f32 v[64:65], v[64:65], v[32:33]
    v_pk_mul_f32 v[66:67], v[66:67], v[34:35]
    v_pk_mul_f32 v[68:69], v[68:69], v[36:37]
    v_pk_mul_f32 v[70:71], v[70:71], v[38:39]
    v_pk_mul_f32 v[72:73], v[72:73], v[40:41]
    v_pk_mul_f32 v[74:75], v[74:75], v[42:43]
    v_pk_mul_f32 v[76:77], v[76:77], v[44:45]
    v_pk_mul_f32 v[78:79], v[78:79], v[46:47]
    v_cvt_pk_bf16_f32 v32, v64, v65
    v_cvt_pk_bf16_f32 v33, v66, v67
    v_cvt_pk_bf16_f32 v34, v68, v69
    v_cvt_pk_bf16_f32 v35, v70, v71
    v_cvt_pk_bf16_f32 v36, v72, v73
    v_cvt_pk_bf16_f32 v37, v74, v75
    v_cvt_pk_bf16_f32 v38, v76, v77
    v_cvt_pk_bf16_f32 v39, v78, v79
    s_lshl_b32 s69, s52, 13
    s_add_u32 s69, s69, s78
    s_cmp_eq_u32 s56, 0
    s_cbranch_scc1 L_sequential_preLN__grouped_kv_mqa__dense_activation_gelu__prompt_kernel_slow_67
    buffer_store_dwordx4 v[32:35], v4, s[36:39], s69 offen
    buffer_store_dwordx4 v[36:39], v4, s[36:39], s69 offen offset:1024
L_sequential_preLN__grouped_kv_mqa__dense_activation_gelu__prompt_kernel_pj_68:
    s_waitcnt lgkmcnt(0)
    s_barrier
    v_mov_b32 v2, 0
    v_mov_b32 v3, 1
    s_mov_b64 exec, 1
    s_cmp_eq_u32 s56, 0
    s_cbranch_scc1 L_sequential_preLN__grouped_kv_mqa__dense_activation_gelu__prompt_kernel_slow_69
    s_waitcnt vmcnt(0)
    buffer_store_dword v3, v2, s[36:39], s61 offen offset:768
L_sequential_preLN__grouped_kv_mqa__dense_activation_gelu__prompt_kernel_pj_70:
    s_mov_b64 exec, -1
    s_branch L_sequential_preLN__grouped_kv_mqa__dense_activation_gelu__prompt_kernel_ffn2_64
L_sequential_preLN__grouped_kv_mqa__dense_activation_gelu__prompt_kernel_half_63:
    s_cmp_lt_u32 s50, 6
    s_cbranch_scc1 L_sequential_preLN__grouped_kv_mqa__dense_activation_gelu__prompt_kernel_nostat_71
    s_lshl_b32 s64, s53, 13
    s_add_u32 s64, s64, 0x20000
    s_add_u32 s65, s64, 4096
    buffer_load_dwordx4 v[16:19], v4, s[36:39], s64 offen offset:0 sc1
    buffer_load_dwordx4 v[20:23], v4, s[36:39], s64 offen offset:1024 sc1
    buffer_load_dwordx4 v[24:27], v4, s[36:39], s64 offen offset:2048 sc1
    buffer_load_dwordx4 v[28:31], v4, s[36:39], s64 offen offset:3072 sc1
    buffer_load_dwordx4 v[32:35], v4, s[36:39], s65 offen offset:0 sc1
    buffer_load_dwordx4 v[36:39], v4, s[36:39], s65 offen offset:1024 sc1
    buffer_load_dwordx4 v[40:43], v4, s[36:39], s65 offen offset:2048 sc1
    buffer_load_dwordx4 v[44:47], v4, s[36:39], s65 offen offset:3072 sc1
    v_mov_b32 v123, v122
    s_nop 1
    v_permlane32_swap_b32 v122, v123
    s_nop 0
    v_add_f32 v122, v122, v123
    v_cvt_pk_bf16_f32 v106, v122, v122
    v_and_b32 v107, 0xffff0000, v106
    v_sub_f32 v107, v122, v107
    v_cvt_pk_bf16_f32 v112, v122, v107
    v_and_b32 v106, 0xffff, v106
    v_lshl_or_b32 v113, v114, 16, v106
    v_mov_b32 v115, 0
    s_mov_b32 exec_lo, 0
    v_mov_b32 v112, 0
    v_mov_b32 v113, 0
    v_mov_b32 v114, 0
    s_mov_b32 exec_lo, -1
    v_mov_b32 v87, 0
    s_setprio 3
    s_barrier
    s_waitcnt vmcnt(6)
    v_add_f32 v16, v16, v20
    v_add_f32 v17, v17, v21
    v_add_f32 v18, v18, v22
    v_add_f32 v19, v19, v23
    s_waitcnt vmcnt(4)
    v_add_f32 v24, v24, v28
    v_add_f32 v25, v25, v29
    v_add_f32 v26, v26, v30
    v_add_f32 v27, v27, v31
    v_add_f32 v16, v16, v24
    v_add_f32 v17, v17, v25
    v_add_f32 v18, v18, v26
    v_add_f32 v19, v19, v27
    s_waitcnt vmcnt(2)
    v_add_f32 v32, v32, v36
    v_add_f32 v33, v33, v37
    v_add_f32 v34, v34, v38
    v_add_f32 v35, v35, v39
    s_waitcnt vmcnt(0)
    v_add_f32 v40, v40, v44
    v_add_f32 v41, v41, v45
    v_add_f32 v42, v42, v46
    v_add_f32 v43, v43, v47
    v_add_f32 v32, v32, v40
    v_add_f32 v33, v33, v41
    v_add_f32 v34, v34, v42
    v_add_f32 v35, v35, v43
    v_add_f32 v16, v16, v32
    v_add_f32 v17, v17, v33
    v_add_f32 v18, v18, v34
    v_add_f32 v19, v19, v35
    s_nop 0
    v_permlane32_swap_b32 v16, v17
    v_permlane32_swap_b32 v18, v19
    v_add_f32 v12, v16, v17
    v_add_f32 v13, v18, v19
    s_nop 1
    v_permlane16_swap_b32 v12, v13
    s_nop 0
    v_add_f32 v12, v12, v13
    s_nop 1
    v_mov_b32_dpp v13, v12 row_ror:8 row_mask:0xf bank_mask:0xf
    s_barrier
    v_mul_f32 v12, 0xbb000000, v12
    v_mul_f32 v13, 0x3b000000, v13
    v_fma_f32 v13, -v12, v12, v13
    v_cvt_pk_bf16_f32 v84, v12, v12
    v_max_f32 v13, 0, v13
    v_and_b32 v17, 0xffff0000, v84
    v_add_f32 v13, 0x3727c5ac, v13
    v_sub_f32 v17, v12, v17
    v_rsq_f32 v16, v13
    s_nop 0
    v_mul_f32 v94, v13, v16
    v_mul_f32 v92, 0xc0135761, v16
    v_mul_f32 v93, v16, v16
    v_cvt_pk_bf16_f32 v85, v17, v94
    v_mov_b32 v95, v94
    v_mul_f32 v93, v93, v92
    v_and_b32 v17, 0xffff0000, v85
    v_mul_f32 v93, 0x3d372713, v93
    v_sub_f32 v17, v94, v17
    v_cvt_pk_bf16_f32 v86, v17, v87
    s_mov_b32 exec_lo, 0x00ff00ff
    s_mov_b32 exec_hi, 0x00ff00ff
    ds_write_b128 v105, v[92:95] offset:512
    ds_write_b128 v105, v[84:87]
    s_mov_b64 exec, -1
    s_setprio 0
    s_branch L_sequential_preLN__grouped_kv_mqa__dense_activation_gelu__prompt_kernel_sj_72
L_sequential_preLN__grouped_kv_mqa__dense_activation_gelu__prompt_kernel_nostat_71:
    v_mov_b32 v123, v122
    s_nop 1
    v_permlane32_swap_b32 v122, v123
    s_nop 0
    v_add_f32 v122, v122, v123
    v_cvt_pk_bf16_f32 v106, v122, v122
    v_and_b32 v107, 0xffff0000, v106
    v_sub_f32 v107, v122, v107
    v_cvt_pk_bf16_f32 v112, v122, v107
    v_and_b32 v106, 0xffff, v106
    v_lshl_or_b32 v113, v114, 16, v106
    v_mov_b32 v115, 0
    s_mov_b32 exec_lo, 0
    v_mov_b32 v112, 0
    v_mov_b32 v113, 0
    v_mov_b32 v114, 0
    s_mov_b32 exec_lo, -1
    s_add_u32 m0, s67, 67584
    s_add_u32 s71, s67, 98304
    buffer_load_dwordx4 v4, s[36:39], s71 offen sc1 lds
    s_add_u32 m0, s67, 69632
    s_add_u32 s71, s67, 100352
    buffer_load_dwordx4 v4, s[36:39], s71 offen sc1 lds
    s_add_u32 m0, s67, 71680
    s_add_u32 s71, s67, 102400
    buffer_load_dwordx4 v4, s[36:39], s71 offen sc1 lds
    s_add_u32 m0, s67, 73728
    s_add_u32 s71, s67, 104448
    buffer_load_dwordx4 v4, s[36:39], s71 offen sc1 lds
    s_barrier
    s_add_u32 m0, s67, 75776
    s_add_u32 s71, s67, 106496
    buffer_load_dwordx4 v4, s[36:39], s71 offen sc1 lds
    s_add_u32 m0, s67, 77824
    s_add_u32 s71, s67, 108544
    buffer_load_dwordx4 v4, s[36:39], s71 offen sc1 lds
    s_add_u32 m0, s67, 79872
    s_add_u32 s71, s67, 110592
    buffer_load_dwordx4 v4, s[36:39], s71 offen sc1 lds
    s_add_u32 m0, s67, 81920
    s_add_u32 s71, s67, 112640
    buffer_load_dwordx4 v4, s[36:39], s71 offen sc1 lds
    s_add_u32 m0, s67, 83968
    s_add_u32 s71, s67, 114688
    buffer_load_dwordx4 v4, s[36:39], s71 offen sc1 lds
    s_add_u32 m0, s67, 86016
    s_add_u32 s71, s67, 116736
    buffer_load_dwordx4 v4, s[36:39], s71 offen sc1 lds
    s_add_u32 m0, s67, 88064
    s_add_u32 s71, s67, 118784
    buffer_load_dwordx4 v4, s[36:39], s71 offen sc1 lds
    s_add_u32 m0, s67, 90112
    s_add_u32 s71, s67, 120832
    buffer_load_dwordx4 v4, s[36:39], s71 offen sc1 lds
    s_add_u32 m0, s67, 92160
    s_add_u32 s71, s67, 122880
    buffer_load_dwordx4 v4, s[36:39], s71 offen sc1 lds
    s_add_u32 m0, s67, 94208
    s_add_u32 s71, s67, 124928
    buffer_load_dwordx4 v4, s[36:39], s71 offen sc1 lds
    s_add_u32 m0, s67, 96256
    s_add_u32 s71, s67, 126976
    buffer_load_dwordx4 v4, s[36:39], s71 offen sc1 lds
    s_add_u32 m0, s67, 98304
    s_add_u32 s71, s67, 129024
    buffer_load_dwordx4 v4, s[36:39], s71 offen sc1 lds
    s_barrier
L_sequential_preLN__grouped_kv_mqa__dense_activation_gelu__prompt_kernel_sj_72:
    s_waitcnt vmcnt(0) lgkmcnt(0)
    s_barrier
    s_cmp_ge_u32 s52, 3
    s_cselect_b32 s64, s53, 0
    s_cmp_lg_u32 s64, 0
    s_cbranch_scc1 L_sequential_preLN__grouped_kv_mqa__dense_activation_gelu__prompt_kernel_idle_73
    ds_read_b128 v[84:87], v102
    ds_read_b128 v[92:95], v102 offset:512
    ds_read_b128 v[48:51], v82 offset:0
    ds_read_b128 v[52:55], v82 offset:1024
    ds_read_b128 v[56:59], v82 offset:2048
    ds_read_b128 v[60:63], v82 offset:3072
    ds_read_b128 v[64:67], v82 offset:4096
    s_waitcnt lgkmcnt(4)
    v_mfma_f32_32x32x16_bf16 v[16:31], a[0:3], v[48:51], 0
    ds_read_b128 v[68:71], v82 offset:5120
    s_waitcnt lgkmcnt(4)
    v_mfma_f32_32x32x16_bf16 v[16:31], a[4:7], v[52:55], v[16:31]
    ds_read_b128 v[72:75], v82 offset:6144
    s_waitcnt lgkmcnt(4)
    v_mfma_f32_32x32x16_bf16 v[16:31], a[8:11], v[56:59], v[16:31]
    v_mfma_f32_32x32x16_bf16 v[16:31], v[112:115], v[84:87], v[16:31]
    ds_read_b128 v[76:79], v82 offset:7168
    s_waitcnt lgkmcnt(4)
    v_mfma_f32_32x32x16_bf16 v[16:31], a[12:15], v[60:63], v[16:31]
    ds_read_b64_tr_b16 a[0:1], v120 offset:32768
    ds_read_b128 v[48:51], v82 offset:8192
    s_waitcnt lgkmcnt(5)
    v_mfma_f32_32x32x16_bf16 v[16:31], a[16:19], v[64:67], v[16:31]
    ds_read_b64_tr_b16 a[2:3], v120 offset:33792
    ds_read_b128 v[52:55], v82 offset:9216
    s_waitcnt lgkmcnt(6)
    v_mfma_f32_32x32x16_bf16 v[16:31], a[20:23], v[68:71], v[16:31]
    ds_read_b64_tr_b16 a[4:5], v121 offset:32768
    ds_read_b128 v[56:59], v82 offset:10240
    s_waitcnt lgkmcnt(7)
    v_mfma_f32_32x32x16_bf16 v[16:31], a[24:27], v[72:75], v[16:31]
    ds_read_b64_tr_b16 a[6:7], v121 offset:33792
    ds_read_b128 v[60:63], v82 offset:11264
    s_waitcnt lgkmcnt(8)
    v_mfma_f32_32x32x16_bf16 v[16:31], a[28:31], v[76:79], v[16:31]
    ds_read_b64_tr_b16 a[8:9], v120 offset:40960
    ds_read_b128 v[64:67], v82 offset:12288
    s_waitcnt lgkmcnt(8)
    v_mfma_f32_32x32x16_bf16 v[16:31], a[32:35], v[48:51], v[16:31]
    ds_read_b64_tr_b16 a[10:11], v120 offset:41984
    ds_read_b128 v[68:71], v82 offset:13312
    s_waitcnt lgkmcnt(8)
    v_mfma_f32_32x32x16_bf16 v[16:31], a[36:39], v[52:55], v[16:31]
    ds_read_b64_tr_b16 a[12:13], v121 offset:40960
    ds_read_b128 v[72:75], v82 offset:14336
    s_waitcnt lgkmcnt(8)
    v_mfma_f32_32x32x16_bf16 v[16:31], a[40:43], v[56:59], v[16:31]
    ds_read_b64_tr_b16 a[14:15], v121 offset:41984
    ds_read_b128 v[76:79], v82 offset:15360
    s_waitcnt lgkmcnt(8)
    v_mfma_f32_32x32x16_bf16 v[16:31], a[44:47], v[60:63], v[16:31]
    ds_read_b64_tr_b16 a[16:17], v120 offset:49152
    ds_read_b128 v[48:51], v82 offset:16384
    s_waitcnt lgkmcnt(8)
    v_mfma_f32_32x32x16_bf16 v[16:31], a[48:51], v[64:67], v[16:31]
    ds_read_b64_tr_b16 a[18:19], v120 offset:50176
    ds_read_b128 v[52:55], v82 offset:17408
    s_waitcnt lgkmcnt(8)
    v_mfma_f32_32x32x16_bf16 v[16:31], a[52:55], v[68:71], v[16:31]
    ds_read_b64_tr_b16 a[20:21], v121 offset:49152
    ds_read_b128 v[56:59], v82 offset:18432
    s_waitcnt lgkmcnt(8)
    v_mfma_f32_32x32x16_bf16 v[16:31], a[56:59], v[72:75], v[16:31]
    ds_read_b64_tr_b16 a[22:23], v121 offset:50176
    ds_read_b128 v[60:63], v82 offset:19456
    s_waitcnt lgkmcnt(8)
    v_mfma_f32_32x32x16_bf16 v[16:31], a[60:63], v[76:79], v[16:31]
    ds_read_b64_tr_b16 a[24:25], v120 offset:57344
    ds_read_b128 v[64:67], v82 offset:20480
    s_waitcnt lgkmcnt(8)
    v_mfma_f32_32x32x16_bf16 v[16:31], a[64:67], v[48:51], v[16:31]
    ds_read_b64_tr_b16 a[26:27], v120 offset:58368
    ds_read_b128 v[68:71], v82 offset:21504
    s_waitcnt lgkmcnt(8)
    v_mfma_f32_32x32x16_bf16 v[16:31], a[68:71], v[52:55], v[16:31]
    ds_read_b64_tr_b16 a[28:29], v121 offset:57344
    ds_read_b128 v[72:75], v82 offset:22528
    s_waitcnt lgkmcnt(8)
    v_mfma_f32_32x32x16_bf16 v[16:31], a[72:75], v[56:59], v[16:31]
    ds_read_b64_tr_b16 a[30:31], v121 offset:58368
    ds_read_b128 v[76:79], v82 offset:23552
    s_waitcnt lgkmcnt(8)
    v_mfma_f32_32x32x16_bf16 v[16:31], a[76:79], v[60:63], v[16:31]
    ds_read_b128 v[48:51], v82 offset:24576
    s_waitcnt lgkmcnt(7)
    v_mfma_f32_32x32x16_bf16 v[16:31], a[80:83], v[64:67], v[16:31]
    ds_read_b128 v[52:55], v82 offset:25600
    s_waitcnt lgkmcnt(6)
    v_mfma_f32_32x32x16_bf16 v[16:31], a[84:87], v[68:71], v[16:31]
    ds_read_b128 v[56:59], v82 offset:26624
    s_waitcnt lgkmcnt(5)
    v_mfma_f32_32x32x16_bf16 v[16:31], a[88:91], v[72:75], v[16:31]
    ds_read_b128 v[60:63], v82 offset:27648
    s_waitcnt lgkmcnt(4)
    v_mfma_f32_32x32x16_bf16 v[16:31], a[92:95], v[76:79], v[16:31]
    ds_read_b128 v[64:67], v82 offset:28672
    s_waitcnt lgkmcnt(4)
    v_mfma_f32_32x32x16_bf16 v[16:31], a[96:99], v[48:51], v[16:31]
    ds_read_b128 v[68:71], v82 offset:29696
    s_waitcnt lgkmcnt(4)
    v_mfma_f32_32x32x16_bf16 v[16:31], a[100:103], v[52:55], v[16:31]
    ds_read_b128 v[72:75], v82 offset:30720
    s_waitcnt lgkmcnt(4)
    v_mfma_f32_32x32x16_bf16 v[16:31], a[104:107], v[56:59], v[16:31]
    ds_read_b128 v[76:79], v82 offset:31744
    s_waitcnt lgkmcnt(4)
    v_mfma_f32_32x32x16_bf16 v[16:31], a[108:111], v[60:63], v[16:31]
    s_waitcnt lgkmcnt(3)
    v_mfma_f32_32x32x16_bf16 v[16:31], a[112:115], v[64:67], v[16:31]
    s_waitcnt lgkmcnt(2)
    v_mfma_f32_32x32x16_bf16 v[16:31], a[116:119], v[68:71], v[16:31]
    s_waitcnt lgkmcnt(1)
    v_mfma_f32_32x32x16_bf16 v[16:31], a[120:123], v[72:75], v[16:31]
    s_waitcnt lgkmcnt(0)
    v_mfma_f32_32x32x16_bf16 v[16:31], a[124:127], v[76:79], v[16:31]
    s_lshl_b32 s64, s52, 1
    s_add_u32 s64, s64, s53
    s_add_u32 s65, s52, 3
    s_min_u32 s69, s64, s65
    s_mul_i32 s64, s55, 11
    s_add_u32 s69, s69, s64
    s_lshl_b32 s69, s69, 11
    s_add_u32 s69, s69, 0x25000
    s_nop 3
    v_mul_f32 v64, v16, v16
    v_mul_f32 v65, v17, v17
    v_mul_f32 v66, v18, v18
    v_mul_f32 v67, v19, v19
    v_mul_f32 v68, v20, v20
    v_mul_f32 v69, v21, v21
    v_mul_f32 v70, v22, v22
    v_mul_f32 v71, v23, v23
    v_mul_f32 v72, v24, v24
    v_mul_f32 v73, v25, v25
    v_mul_f32 v74, v26, v26
    v_mul_f32 v75, v27, v27
    v_mul_f32 v76, v28, v28
    v_mul_f32 v77, v29, v29
    v_mul_f32 v78, v30, v30
    v_mul_f32 v79, v31, v31
    v_fma_f32 v64, v64, v93, v92
    v_fma_f32 v65, v65, v93, v92
    v_fma_f32 v66, v66, v93, v92
    v_fma_f32 v67, v67, v93, v92
    v_fma_f32 v68, v68, v93, v92
    v_fma_f32 v69, v69, v93, v92
    v_fma_f32 v70, v70, v93, v92
    v_fma_f32 v71, v71, v93, v92
    v_fma_f32 v72, v72, v93, v92
    v_fma_f32 v73, v73, v93, v92
    v_fma_f32 v74, v74, v93, v92
    v_fma_f32 v75, v75, v93, v92
    v_fma_f32 v76, v76, v93, v92
    v_fma_f32 v77, v77, v93, v92
    v_fma_f32 v78, v78, v93, v92
    v_fma_f32 v79, v79, v93, v92
    v_mul_f32 v64, v64, v16
    v_mul_f32 v65, v65, v17
    v_mul_f32 v66, v66, v18
    v_mul_f32 v67, v67, v19
    v_mul_f32 v68, v68, v20
    v_mul_f32 v69, v69, v21
    v_mul_f32 v70, v70, v22
    v_mul_f32 v71, v71, v23
    v_mul_f32 v72, v72, v24
    v_mul_f32 v73, v73, v25
    v_mul_f32 v74, v74, v26
    v_mul_f32 v75, v75, v27
    v_mul_f32 v76, v76, v28
    v_mul_f32 v77, v77, v29
    v_mul_f32 v78, v78, v30
    v_mul_f32 v79, v79, v31
    v_exp_f32 v64, v64
    v_exp_f32 v65, v65
    v_exp_f32 v66, v66
    v_exp_f32 v67, v67
    s_barrier
    v_exp_f32 v68, v68
    v_exp_f32 v69, v69
    v_exp_f32 v70, v70
    v_exp_f32 v71, v71
    v_exp_f32 v72, v72
    v_exp_f32 v73, v73
    v_exp_f32 v74, v74
    v_exp_f32 v75, v75
    v_exp_f32 v76, v76
    v_exp_f32 v77, v77
    v_exp_f32 v78, v78
    v_exp_f32 v79, v79
    v_fma_f32 v64, v64, v94, v94
    v_fma_f32 v65, v65, v94, v94
    v_fma_f32 v66, v66, v94, v94
    v_fma_f32 v67, v67, v94, v94
    v_fma_f32 v68, v68, v94, v94
    v_fma_f32 v69, v69, v94, v94
    v_fma_f32 v70, v70, v94, v94
    v_fma_f32 v71, v71, v94, v94
    v_fma_f32 v72, v72, v94, v94
    v_fma_f32 v73, v73, v94, v94
    v_fma_f32 v74, v74, v94, v94
    v_fma_f32 v75, v75, v94, v94
    v_fma_f32 v76, v76, v94, v94
    v_fma_f32 v77, v77, v94, v94
    v_fma_f32 v78, v78, v94, v94
    v_fma_f32 v79, v79, v94, v94
    v_rcp_f32 v64, v64
    v_rcp_f32 v65, v65
    v_rcp_f32 v66, v66
    v_rcp_f32 v67, v67
    v_rcp_f32 v68, v68
    v_rcp_f32 v69, v69
    v_rcp_f32 v70, v70
    v_rcp_f32 v71, v71
    v_rcp_f32 v72, v72
    v_rcp_f32 v73, v73
    v_rcp_f32 v74, v74
    v_rcp_f32 v75, v75
    v_rcp_f32 v76, v76
    v_rcp_f32 v77, v77
    v_rcp_f32 v78, v78
    v_rcp_f32 v79, v79
    v_mul_f32 v64, v16, v64
    v_mul_f32 v65, v17, v65
    v_mul_f32 v66, v18, v66
    v_mul_f32 v67, v19, v67
    v_mul_f32 v68, v20, v68
    v_mul_f32 v69, v21, v69
    v_mul_f32 v70, v22, v70
    v_mul_f32 v71, v23, v71
    v_mul_f32 v72, v24, v72
    v_mul_f32 v73, v25, v73
    v_mul_f32 v74, v26, v74
    v_mul_f32 v75, v27, v75
    v_mul_f32 v76, v28, v76
    v_mul_f32 v77, v29, v77
    v_mul_f32 v78, v30, v78
    v_mul_f32 v79, v31, v79
    v_cvt_pk_bf16_f32 v16, v64, v65
    v_cvt_pk_bf16_f32 v17, v66, v67
    v_cvt_pk_bf16_f32 v18, v68, v69
    v_cvt_pk_bf16_f32 v19, v70, v71
    v_cvt_pk_bf16_f32 v20, v72, v73
    v_cvt_pk_bf16_f32 v21, v74, v75
    v_cvt_pk_bf16_f32 v22, v76, v77
    s_barrier
    v_cvt_pk_bf16_f32 v23, v78, v79
    s_cmp_eq_u32 s56, 0
    s_cbranch_scc1 L_sequential_preLN__grouped_kv_mqa__dense_activation_gelu__prompt_kernel_slow_75
    buffer_store_dwordx4 v[16:19], v4, s[36:39], s69 offen
    buffer_store_dwordx4 v[20:23], v4, s[36:39], s69 offen offset:1024
L_sequential_preLN__grouped_kv_mqa__dense_activation_gelu__prompt_kernel_pj_76:
    s_add_u32 m0, s67, 2048
    s_add_u32 s71, s66, 753664
    buffer_load_dwordx4 v6, s[80:83], s71 offen  lds
    s_add_u32 m0, s67, 6144
    s_add_u32 s71, s66, 786432
    buffer_load_dwordx4 v6, s[80:83], s71 offen  lds
    s_add_u32 m0, s67, 10240
    s_add_u32 s71, s66, 819200
    buffer_load_dwordx4 v6, s[80:83], s71 offen  lds
    s_add_u32 m0, s67, 14336
    s_add_u32 s71, s66, 851968
    buffer_load_dwordx4 v6, s[80:83], s71 offen  lds
    s_add_u32 m0, s67, 18432
    s_add_u32 s71, s66, 917504
    buffer_load_dwordx4 v6, s[80:83], s71 offen  lds
    s_add_u32 m0, s67, 22528
    s_add_u32 s71, s66, 950272
    buffer_load_dwordx4 v6, s[80:83], s71 offen  lds
    s_add_u32 m0, s67, 26624
    s_add_u32 s71, s66, 983040
    buffer_load_dwordx4 v6, s[80:83], s71 offen  lds
    s_add_u32 m0, s67, 30720
    s_add_u32 s71, s66, 1015808
    buffer_load_dwordx4 v6, s[80:83], s71 offen  lds
    s_branch L_sequential_preLN__grouped_kv_mqa__dense_activation_gelu__prompt_kernel_idlej_74
L_sequential_preLN__grouped_kv_mqa__dense_activation_gelu__prompt_kernel_idle_73:
    ds_read_b64_tr_b16 a[0:1], v120 offset:32768
    ds_read_b64_tr_b16 a[2:3], v120 offset:33792
    ds_read_b64_tr_b16 a[4:5], v121 offset:32768
    ds_read_b64_tr_b16 a[6:7], v121 offset:33792
    ds_read_b64_tr_b16 a[8:9], v120 offset:40960
    ds_read_b64_tr_b16 a[10:11], v120 offset:41984
    ds_read_b64_tr_b16 a[12:13], v121 offset:40960
    ds_read_b64_tr_b16 a[14:15], v121 offset:41984
    ds_read_b64_tr_b16 a[16:17], v120 offset:49152
    ds_read_b64_tr_b16 a[18:19], v120 offset:50176
    ds_read_b64_tr_b16 a[20:21], v121 offset:49152
    ds_read_b64_tr_b16 a[22:23], v121 offset:50176
    ds_read_b64_tr_b16 a[24:25], v120 offset:57344
    ds_read_b64_tr_b16 a[26:27], v120 offset:58368
    s_waitcnt lgkmcnt(8)
    ds_read_b64_tr_b16 a[28:29], v121 offset:57344
    ds_read_b64_tr_b16 a[30:31], v121 offset:58368
    s_waitcnt lgkmcnt(0)
    s_barrier
    s_add_u32 m0, s67, 2048
    s_add_u32 s71, s66, 753664
    buffer_load_dwordx4 v6, s[80:83], s71 offen  lds
    s_add_u32 m0, s67, 6144
    s_add_u32 s71, s66, 786432
    buffer_load_dwordx4 v6, s[80:83], s71 offen  lds
    s_add_u32 m0, s67, 10240
    s_add_u32 s71, s66, 819200
    buffer_load_dwordx4 v6, s[80:83], s71 offen  lds
    s_add_u32 m0, s67, 14336
    s_add_u32 s71, s66, 851968
    buffer_load_dwordx4 v6, s[80:83], s71 offen  lds
    s_add_u32 m0, s67, 18432
    s_add_u32 s71, s66, 917504
    buffer_load_dwordx4 v6, s[80:83], s71 offen  lds
    s_add_u32 m0, s67, 22528
    s_add_u32 s71, s66, 950272
    buffer_load_dwordx4 v6, s[80:83], s71 offen  lds
    s_add_u32 m0, s67, 26624
    s_add_u32 s71, s66, 983040
    buffer_load_dwordx4 v6, s[80:83], s71 offen  lds
    s_add_u32 m0, s67, 30720
    s_add_u32 s71, s66, 1015808
    buffer_load_dwordx4 v6, s[80:83], s71 offen  lds
    s_barrier
L_sequential_preLN__grouped_kv_mqa__dense_activation_gelu__prompt_kernel_idlej_74:
    ds_read_b64_tr_b16 a[32:33], v124 offset:49152
    ds_read_b64_tr_b16 a[34:35], v124 offset:50176
    ds_read_b64_tr_b16 a[36:37], v125 offset:49152
    ds_read_b64_tr_b16 a[38:39], v125 offset:50176
    ds_read_b64_tr_b16 a[40:41], v124 offset:57344
    ds_read_b64_tr_b16 a[42:43], v124 offset:58368
    ds_read_b64_tr_b16 a[44:45], v125 offset:57344
    ds_read_b64_tr_b16 a[46:47], v125 offset:58368
    v_mov_b32 v2, 0
    v_mov_b32 v3, 1
    s_mov_b64 exec, 1
    s_cmp_eq_u32 s56, 0
    s_cbranch_scc1 L_sequential_preLN__grouped_kv_mqa__dense_activation_gelu__prompt_kernel_slow_77
    s_waitcnt vmcnt(8)
    buffer_store_dword v3, v2, s[36:39], s61 offen offset:512
L_sequential_preLN__grouped_kv_mqa__dense_activation_gelu__prompt_kernel_pj_78:
    s_mov_b64 exec, -1
    s_add_u32 m0, s67, 34816
    s_add_u32 s71, s66, 1081344
    buffer_load_dwordx4 v6, s[80:83], s71 offen  lds
    s_add_u32 m0, s67, 38912
    s_add_u32 s71, s66, 1114112
    buffer_load_dwordx4 v6, s[80:83], s71 offen  lds
    s_add_u32 m0, s67, 43008
    s_add_u32 s71, s66, 1146880
    buffer_load_dwordx4 v6, s[80:83], s71 offen  lds
    s_add_u32 m0, s67, 47104
    s_add_u32 s71, s66, 1179648
    buffer_load_dwordx4 v6, s[80:83], s71 offen  lds
    s_add_u32 m0, s67, 51200
    s_add_u32 s71, s66, 1245184
    buffer_load_dwordx4 v6, s[80:83], s71 offen  lds
    s_add_u32 m0, s67, 55296
    s_add_u32 s71, s66, 1277952
    buffer_load_dwordx4 v6, s[80:83], s71 offen  lds
    s_add_u32 m0, s67, 59392
    s_add_u32 s71, s66, 1310720
    buffer_load_dwordx4 v6, s[80:83], s71 offen  lds
    s_add_u32 m0, s67, 63488
    s_add_u32 s71, s66, 1343488
    buffer_load_dwordx4 v6, s[80:83], s71 offen  lds
    s_waitcnt lgkmcnt(0)
    s_barrier
    s_add_u32 m0, s67, 116736
    s_add_u32 s71, s66, 524288
    buffer_load_dwordx4 v6, s[80:83], s71 offen  lds
    s_add_u32 m0, s67, 120832
    s_add_u32 s71, s66, 557056
    buffer_load_dwordx4 v6, s[80:83], s71 offen  lds
    s_add_u32 m0, s67, 124928
    s_add_u32 s71, s66, 720896
    buffer_load_dwordx4 v6, s[80:83], s71 offen  lds
    s_add_u32 m0, s67, 129024
    s_add_u32 s71, s66, 884736
    buffer_load_dwordx4 v6, s[80:83], s71 offen  lds
    ds_read_b64_tr_b16 a[48:49], v124 offset:32768
    ds_read_b64_tr_b16 a[50:51], v124 offset:33792
    ds_read_b64_tr_b16 a[52:53], v125 offset:32768
    ds_read_b64_tr_b16 a[54:55], v125 offset:33792
    ds_read_b64_tr_b16 a[56:57], v124 offset:40960
    ds_read_b64_tr_b16 a[58:59], v124 offset:41984
    ds_read_b64_tr_b16 a[60:61], v125 offset:40960
    ds_read_b64_tr_b16 a[62:63], v125 offset:41984
    s_waitcnt lgkmcnt(0)
L_sequential_preLN__grouped_kv_mqa__dense_activation_gelu__prompt_kernel_ffn2_64:
    s_mov_b32 s40, s24
    s_and_b32 s41, s25, 0xffff
    s_mov_b32 s42, 0x200000
    s_mov_b32 s43, 0x20000
    s_lshl_b32 s64, s79, 10
    s_cmp_eq_u32 s54, 0
    s_cselect_b32 s74, 0x30000, 0
    s_add_u32 s74, s74, s64
    s_mul_i32 s75, s54, 22528
    s_add_u32 s75, s75, s64
    v_add_u32 v12, 131072, v120
    v_add_u32 v13, 131072, v121
    v_lshlrev_b32 v96, 16, v8
    v_and_b32 v97, 0xffff0000, v8
    v_lshlrev_b32 v104, 16, v116
    v_and_b32 v105, 0xffff0000, v116
    v_lshlrev_b32 v98, 16, v9
    v_and_b32 v99, 0xffff0000, v9
    v_lshlrev_b32 v106, 16, v117
    v_and_b32 v107, 0xffff0000, v117
    v_lshlrev_b32 v100, 16, v10
    v_and_b32 v101, 0xffff0000, v10
    v_lshlrev_b32 v108, 16, v118
    v_and_b32 v109, 0xffff0000, v118
    v_lshlrev_b32 v102, 16, v11
    v_and_b32 v103, 0xffff0000, v11
    v_lshlrev_b32 v110, 16, v119
    v_and_b32 v111, 0xffff0000, v119
    v_add_f32 v112, v96, v104
    v_add_f32 v113, v97, v105
    v_add_f32 v114, v98, v106
    v_add_f32 v115, v99, v107
    v_add_f32 v116, v100, v108
    v_add_f32 v117, v101, v109
    v_add_f32 v118, v102, v110
    v_add_f32 v119, v103, v111
    v_subrev_u32 v14, 32768, v14
    v_subrev_u32 v15, 32768, v15
    s_cmp_eq_u32 s54, 1
    s_cbranch_scc1 L_sequential_preLN__grouped_kv_mqa__dense_activation_gelu__prompt_kernel_f2b_79
    s_barrier
    s_add_u32 s71, s74, 0
    buffer_load_dwordx4 v[48:51], v4, s[36:39], s71 offen sc1
    s_add_u32 s71, s74, 4096
    buffer_load_dwordx4 v[52:55], v4, s[36:39], s71 offen sc1
    s_add_u32 s71, s74, 8192
    buffer_load_dwordx4 v[56:59], v4, s[36:39], s71 offen sc1
    s_add_u32 s71, s74, 12288
    buffer_load_dwordx4 v[60:63], v4, s[36:39], s71 offen sc1
    s_add_u32 s71, s74, 16384
    buffer_load_dwordx4 v[64:67], v4, s[36:39], s71 offen sc1
    s_add_u32 s71, s74, 20480
    buffer_load_dwordx4 v[68:71], v4, s[36:39], s71 offen sc1
    s_add_u32 s71, s74, 24576
    buffer_load_dwordx4 v[72:75], v4, s[36:39], s71 offen sc1
    s_add_u32 s71, s74, 28672
    buffer_load_dwordx4 v[76:79], v4, s[36:39], s71 offen sc1
    s_waitcnt vmcnt(7)
    v_mfma_f32_32x32x16_bf16 v[16:31], a[0:3], v[48:51], 0
    v_mfma_f32_32x32x16_bf16 v[32:47], a[4:7], v[48:51], 0
    s_add_u32 s71, s74, 32768
    buffer_load_dwordx4 v[80:83], v4, s[36:39], s71 offen sc1
    s_waitcnt vmcnt(7)
    v_mfma_f32_32x32x16_bf16 v[16:31], a[8:11], v[52:55], v[16:31]
    v_mfma_f32_32x32x16_bf16 v[32:47], a[12:15], v[52:55], v[32:47]
    s_add_u32 s71, s74, 36864
    buffer_load_dwordx4 v[84:87], v4, s[36:39], s71 offen sc1
    s_waitcnt vmcnt(7)
    v_mfma_f32_32x32x16_bf16 v[16:31], a[16:19], v[56:59], v[16:31]
    v_mfma_f32_32x32x16_bf16 v[32:47], a[20:23], v[56:59], v[32:47]
    s_add_u32 s71, s74, 40960
    buffer_load_dwordx4 v[88:91], v4, s[36:39], s71 offen sc1
    s_waitcnt vmcnt(7)
    v_mfma_f32_32x32x16_bf16 v[16:31], a[24:27], v[60:63], v[16:31]
    v_mfma_f32_32x32x16_bf16 v[32:47], a[28:31], v[60:63], v[32:47]
    s_add_u32 s71, s74, 45056
    buffer_load_dwordx4 v[92:95], v4, s[36:39], s71 offen sc1
    s_waitcnt vmcnt(7)
    v_mfma_f32_32x32x16_bf16 v[16:31], a[32:35], v[64:67], v[16:31]
    v_mfma_f32_32x32x16_bf16 v[32:47], a[36:39], v[64:67], v[32:47]
    s_add_u32 s71, s74, 49152
    buffer_load_dwordx4 v[96:99], v4, s[36:39], s71 offen sc1
    ds_read_b64_tr_b16 a[64:65], v120 offset:0
    ds_read_b64_tr_b16 a[66:67], v120 offset:1024
    ds_read_b64_tr_b16 a[68:69], v121 offset:0
    ds_read_b64_tr_b16 a[70:71], v121 offset:1024
    s_waitcnt vmcnt(7) lgkmcnt(8)
    v_mfma_f32_32x32x16_bf16 v[16:31], a[40:43], v[68:71], v[16:31]
    v_mfma_f32_32x32x16_bf16 v[32:47], a[44:47], v[68:71], v[32:47]
    s_add_u32 s71, s74, 53248
    buffer_load_dwordx4 v[100:103], v4, s[36:39], s71 offen sc1
    ds_read_b64_tr_b16 a[72:73], v120 offset:8192
    ds_read_b64_tr_b16 a[74:75], v120 offset:9216
    ds_read_b64_tr_b16 a[76:77], v121 offset:8192
    ds_read_b64_tr_b16 a[78:79], v121 offset:9216
    s_waitcnt vmcnt(7) lgkmcnt(8)
    v_mfma_f32_32x32x16_bf16 v[16:31], a[48:51], v[72:75], v[16:31]
    v_mfma_f32_32x32x16_bf16 v[32:47], a[52:55], v[72:75], v[32:47]
    s_add_u32 s71, s74, 57344
    buffer_load_dwordx4 v[104:107], v4, s[36:39], s71 offen sc1
    ds_read_b64_tr_b16 a[80:81], v120 offset:16384
    ds_read_b64_tr_b16 a[82:83], v120 offset:17408
    ds_read_b64_tr_b16 a[84:85], v121 offset:16384
    ds_read_b64_tr_b16 a[86:87], v121 offset:17408
    s_waitcnt vmcnt(7) lgkmcnt(8)
    v_mfma_f32_32x32x16_bf16 v[16:31], a[56:59], v[76:79], v[16:31]
    v_mfma_f32_32x32x16_bf16 v[32:47], a[60:63], v[76:79], v[32:47]
    s_add_u32 s71, s74, 61440
    buffer_load_dwordx4 v[108:111], v4, s[36:39], s71 offen sc1
    ds_read_b64_tr_b16 a[88:89], v120 offset:24576
    ds_read_b64_tr_b16 a[90:91], v120 offset:25600
    ds_read_b64_tr_b16 a[92:93], v121 offset:24576
    ds_read_b64_tr_b16 a[94:95], v121 offset:25600
    s_waitcnt vmcnt(7) lgkmcnt(8)
    v_mfma_f32_32x32x16_bf16 v[16:31], a[64:67], v[80:83], v[16:31]
    v_mfma_f32_32x32x16_bf16 v[32:47], a[68:71], v[80:83], v[32:47]
    s_add_u32 s71, s75, 151552
    buffer_load_dwordx4 v[48:51], v4, s[36:39], s71 offen sc1
    ds_read_b64_tr_b16 a[96:97], v120 offset:32768
    ds_read_b64_tr_b16 a[98:99], v120 offset:33792
    ds_read_b64_tr_b16 a[100:101], v121 offset:32768
    ds_read_b64_tr_b16 a[102:103], v121 offset:33792
    s_waitcnt vmcnt(7) lgkmcnt(8)
    v_mfma_f32_32x32x16_bf16 v[16:31], a[72:75], v[84:87], v[16:31]
    v_mfma_f32_32x32x16_bf16 v[32:47], a[76:79], v[84:87], v[32:47]
    s_add_u32 s71, s75, 155648
    buffer_load_dwordx4 v[52:55], v4, s[36:39], s71 offen sc1
    ds_read_b64_tr_b16 a[104:105], v120 offset:40960
    ds_read_b64_tr_b16 a[106:107], v120 offset:41984
    ds_read_b64_tr_b16 a[108:109], v121 offset:40960
    ds_read_b64_tr_b16 a[110:111], v121 offset:41984
    s_waitcnt vmcnt(7) lgkmcnt(8)
    v_mfma_f32_32x32x16_bf16 v[16:31], a[80:83], v[88:91], v[16:31]
    v_mfma_f32_32x32x16_bf16 v[32:47], a[84:87], v[88:91], v[32:47]
    s_add_u32 s71, s75, 159744
    buffer_load_dwordx4 v[56:59], v4, s[36:39], s71 offen sc1
    ds_read_b64_tr_b16 a[112:113], v120 offset:49152
    ds_read_b64_tr_b16 a[114:115], v120 offset:50176
    ds_read_b64_tr_b16 a[116:117], v121 offset:49152
    ds_read_b64_tr_b16 a[118:119], v121 offset:50176
    s_waitcnt vmcnt(7) lgkmcnt(8)
    v_mfma_f32_32x32x16_bf16 v[16:31], a[88:91], v[92:95], v[16:31]
    v_mfma_f32_32x32x16_bf16 v[32:47], a[92:95], v[92:95], v[32:47]
    s_add_u32 s71, s75, 163840
    buffer_load_dwordx4 v[60:63], v4, s[36:39], s71 offen sc1
    ds_read_b64_tr_b16 a[120:121], v120 offset:57344
    ds_read_b64_tr_b16 a[122:123], v120 offset:58368
    ds_read_b64_tr_b16 a[124:125], v121 offset:57344
    ds_read_b64_tr_b16 a[126:127], v121 offset:58368
    s_waitcnt vmcnt(7) lgkmcnt(8)
    v_mfma_f32_32x32x16_bf16 v[16:31], a[96:99], v[96:99], v[16:31]
    v_mfma_f32_32x32x16_bf16 v[32:47], a[100:103], v[96:99], v[32:47]
    s_add_u32 s71, s75, 167936
    buffer_load_dwordx4 v[64:67], v4, s[36:39], s71 offen sc1
    ds_read_b64_tr_b16 a[0:1], v12 offset:0
    ds_read_b64_tr_b16 a[2:3], v12 offset:1024
    ds_read_b64_tr_b16 a[4:5], v13 offset:0
    ds_read_b64_tr_b16 a[6:7], v13 offset:1024
    s_waitcnt vmcnt(7) lgkmcnt(8)
    v_mfma_f32_32x32x16_bf16 v[16:31], a[104:107], v[100:103], v[16:31]
    v_mfma_f32_32x32x16_bf16 v[32:47], a[108:111], v[100:103], v[32:47]
    s_add_u32 s71, s75, 172032
    buffer_load_dwordx4 v[68:71], v4, s[36:39], s71 offen sc1
    ds_read_b64_tr_b16 a[8:9], v12 offset:8192
    ds_read_b64_tr_b16 a[10:11], v12 offset:9216
    ds_read_b64_tr_b16 a[12:13], v13 offset:8192
    ds_read_b64_tr_b16 a[14:15], v13 offset:9216
    s_waitcnt vmcnt(7) lgkmcnt(8)
    v_mfma_f32_32x32x16_bf16 v[16:31], a[112:115], v[104:107], v[16:31]
    v_mfma_f32_32x32x16_bf16 v[32:47], a[116:119], v[104:107], v[32:47]
    ds_read_b64_tr_b16 a[16:17], v124 offset:49152
    ds_read_b64_tr_b16 a[18:19], v124 offset:50176
    ds_read_b64_tr_b16 a[20:21], v125 offset:49152
    ds_read_b64_tr_b16 a[22:23], v125 offset:50176
    s_waitcnt vmcnt(6) lgkmcnt(8)
    v_mfma_f32_32x32x16_bf16 v[16:31], a[120:123], v[108:111], v[16:31]
    v_mfma_f32_32x32x16_bf16 v[32:47], a[124:127], v[108:111], v[32:47]
    ds_read_b64_tr_b16 a[24:25], v124 offset:57344
    ds_read_b64_tr_b16 a[26:27], v124 offset:58368
    ds_read_b64_tr_b16 a[28:29], v125 offset:57344
    ds_read_b64_tr_b16 a[30:31], v125 offset:58368
    s_waitcnt vmcnt(5) lgkmcnt(8)
    v_mfma_f32_32x32x16_bf16 v[16:31], a[0:3], v[48:51], v[16:31]
    v_mfma_f32_32x32x16_bf16 v[32:47], a[4:7], v[48:51], v[32:47]
    ds_read_b64_tr_b16 a[32:33], v12 offset:18432
    ds_read_b64_tr_b16 a[34:35], v12 offset:19456
    ds_read_b64_tr_b16 a[36:37], v13 offset:18432
    ds_read_b64_tr_b16 a[38:39], v13 offset:19456
    s_waitcnt vmcnt(4) lgkmcnt(8)
    v_mfma_f32_32x32x16_bf16 v[16:31], a[8:11], v[52:55], v[16:31]
    v_mfma_f32_32x32x16_bf16 v[32:47], a[12:15], v[52:55], v[32:47]
    ds_read_b64_tr_b16 a[40:41], v12 offset:26624
    ds_read_b64_tr_b16 a[42:43], v12 offset:27648
    ds_read_b64_tr_b16 a[44:45], v13 offset:26624
    ds_read_b64_tr_b16 a[46:47], v13 offset:27648
    s_waitcnt vmcnt(3) lgkmcnt(8)
    v_mfma_f32_32x32x16_bf16 v[16:31], a[16:19], v[56:59], v[16:31]
    v_mfma_f32_32x32x16_bf16 v[32:47], a[20:23], v[56:59], v[32:47]
    s_waitcnt vmcnt(2) lgkmcnt(8)
    v_mfma_f32_32x32x16_bf16 v[16:31], a[24:27], v[60:63], v[16:31]
    v_mfma_f32_32x32x16_bf16 v[32:47], a[28:31], v[60:63], v[32:47]
    s_waitcnt vmcnt(1) lgkmcnt(4)
    v_mfma_f32_32x32x16_bf16 v[16:31], a[32:35], v[64:67], v[16:31]
    v_mfma_f32_32x32x16_bf16 v[32:47], a[36:39], v[64:67], v[32:47]
    s_cmp_ge_u32 s79, 2
    s_cbranch_scc1 L_sequential_preLN__grouped_kv_mqa__dense_activation_gelu__prompt_kernel_skip_81
    s_waitcnt vmcnt(0) lgkmcnt(0)
    v_mfma_f32_32x32x16_bf16 v[16:31], a[40:43], v[68:71], v[16:31]
    v_mfma_f32_32x32x16_bf16 v[32:47], a[44:47], v[68:71], v[32:47]
L_sequential_preLN__grouped_kv_mqa__dense_activation_gelu__prompt_kernel_skip_81:
    s_waitcnt lgkmcnt(8)
    s_branch L_sequential_preLN__grouped_kv_mqa__dense_activation_gelu__prompt_kernel_f2e_80
L_sequential_preLN__grouped_kv_mqa__dense_activation_gelu__prompt_kernel_f2b_79:
    s_cmp_lg_u32 s50, 4
    s_cbranch_scc1 L_sequential_preLN__grouped_kv_mqa__dense_activation_gelu__prompt_kernel_np4_82
    v_lshlrev_b32 v2, 2, v1
    s_mov_b32 s64, 0x24000
L_sequential_preLN__grouped_kv_mqa__dense_activation_gelu__prompt_kernel_poll_83:
    buffer_load_dword v3, v2, s[36:39], s64 offen offset:512 sc1
    s_sub_u32 s62, s62, 1
    s_cbranch_scc1 L_sequential_preLN__grouped_kv_mqa__dense_activation_gelu__prompt_kernel_to_84
    s_waitcnt vmcnt(0)
    v_cmp_ne_u32 vcc, 1, v3
    s_nop 1
    s_cmp_lg_u64 vcc, 0
    s_cbranch_scc1 L_sequential_preLN__grouped_kv_mqa__dense_activation_gelu__prompt_kernel_poll_83
L_sequential_preLN__grouped_kv_mqa__dense_activation_gelu__prompt_kernel_poll_83_d:
L_sequential_preLN__grouped_kv_mqa__dense_activation_gelu__prompt_kernel_np4_82:
    s_waitcnt vmcnt(0)
    s_barrier
    s_add_u32 s71, s75, 151552
    buffer_load_dwordx4 v[48:51], v4, s[36:39], s71 offen sc1
    s_add_u32 s71, s75, 155648
    buffer_load_dwordx4 v[52:55], v4, s[36:39], s71 offen sc1
    s_add_u32 s71, s75, 159744
    buffer_load_dwordx4 v[56:59], v4, s[36:39], s71 offen sc1
    s_add_u32 s71, s75, 163840
    buffer_load_dwordx4 v[60:63], v4, s[36:39], s71 offen sc1
    s_add_u32 s71, s75, 167936
    buffer_load_dwordx4 v[64:67], v4, s[36:39], s71 offen sc1
    s_add_u32 s71, s75, 172032
    buffer_load_dwordx4 v[68:71], v4, s[36:39], s71 offen sc1
    ds_read_b64_tr_b16 a[64:65], v12 offset:0
    ds_read_b64_tr_b16 a[66:67], v12 offset:1024
    ds_read_b64_tr_b16 a[68:69], v13 offset:0
    ds_read_b64_tr_b16 a[70:71], v13 offset:1024
    ds_read_b64_tr_b16 a[72:73], v12 offset:8192
    ds_read_b64_tr_b16 a[74:75], v12 offset:9216
    ds_read_b64_tr_b16 a[76:77], v13 offset:8192
    ds_read_b64_tr_b16 a[78:79], v13 offset:9216
    ds_read_b64_tr_b16 a[80:81], v124 offset:49152
    ds_read_b64_tr_b16 a[82:83], v124 offset:50176
    ds_read_b64_tr_b16 a[84:85], v125 offset:49152
    ds_read_b64_tr_b16 a[86:87], v125 offset:50176
    s_setprio 2
    v_lshlrev_b32 v2, 2, v1
    s_mov_b32 s64, 0x24000
    s_mov_b32 exec_lo, 0xf0f0f0f
    s_mov_b32 exec_hi, 0xf0f0f0f
L_sequential_preLN__grouped_kv_mqa__dense_activation_gelu__prompt_kernel_poll_85:
    buffer_load_dword v3, v2, s[36:39], s64 offen offset:768 sc1
    s_sub_u32 s62, s62, 1
    s_cbranch_scc1 L_sequential_preLN__grouped_kv_mqa__dense_activation_gelu__prompt_kernel_to_86
    s_waitcnt vmcnt(0)
    v_cmp_ne_u32 vcc, 1, v3
    s_nop 1
    s_cmp_lg_u64 vcc, 0
    s_cbranch_scc1 L_sequential_preLN__grouped_kv_mqa__dense_activation_gelu__prompt_kernel_poll_85
L_sequential_preLN__grouped_kv_mqa__dense_activation_gelu__prompt_kernel_poll_85_d:
    s_mov_b64 exec, -1
    s_add_u32 s71, s74, 0
    buffer_load_dwordx4 v[72:75], v4, s[36:39], s71 offen sc1
    s_add_u32 s71, s74, 4096
    buffer_load_dwordx4 v[76:79], v4, s[36:39], s71 offen sc1
    s_add_u32 s71, s74, 8192
    buffer_load_dwordx4 v[80:83], v4, s[36:39], s71 offen sc1
    s_add_u32 s71, s74, 12288
    buffer_load_dwordx4 v[84:87], v4, s[36:39], s71 offen sc1
    s_waitcnt vmcnt(9) lgkmcnt(8)
    v_mfma_f32_32x32x16_bf16 v[16:31], a[64:67], v[48:51], 0
    v_mfma_f32_32x32x16_bf16 v[32:47], a[68:71], v[48:51], 0
    s_add_u32 s71, s74, 16384
    buffer_load_dwordx4 v[88:91], v4, s[36:39], s71 offen sc1
    ds_read_b64_tr_b16 a[88:89], v124 offset:57344
    ds_read_b64_tr_b16 a[90:91], v124 offset:58368
    ds_read_b64_tr_b16 a[92:93], v125 offset:57344
    ds_read_b64_tr_b16 a[94:95], v125 offset:58368
    s_waitcnt vmcnt(9) lgkmcnt(8)
    v_mfma_f32_32x32x16_bf16 v[16:31], a[72:75], v[52:55], v[16:31]
    v_mfma_f32_32x32x16_bf16 v[32:47], a[76:79], v[52:55], v[32:47]
    s_add_u32 s71, s74, 20480
    buffer_load_dwordx4 v[92:95], v4, s[36:39], s71 offen sc1
    ds_read_b64_tr_b16 a[96:97], v12 offset:18432
    ds_read_b64_tr_b16 a[98:99], v12 offset:19456
    ds_read_b64_tr_b16 a[100:101], v13 offset:18432
    ds_read_b64_tr_b16 a[102:103], v13 offset:19456
    s_waitcnt vmcnt(9) lgkmcnt(8)
    v_mfma_f32_32x32x16_bf16 v[16:31], a[80:83], v[56:59], v[16:31]
    v_mfma_f32_32x32x16_bf16 v[32:47], a[84:87], v[56:59], v[32:47]
    s_add_u32 s71, s74, 24576
    buffer_load_dwordx4 v[96:99], v4, s[36:39], s71 offen sc1
    ds_read_b64_tr_b16 a[104:105], v12 offset:26624
    ds_read_b64_tr_b16 a[106:107], v12 offset:27648
    ds_read_b64_tr_b16 a[108:109], v13 offset:26624
    ds_read_b64_tr_b16 a[110:111], v13 offset:27648
    s_waitcnt vmcnt(9) lgkmcnt(8)
    v_mfma_f32_32x32x16_bf16 v[16:31], a[88:91], v[60:63], v[16:31]
    v_mfma_f32_32x32x16_bf16 v[32:47], a[92:95], v[60:63], v[32:47]
    s_add_u32 s71, s74, 28672
    buffer_load_dwordx4 v[100:103], v4, s[36:39], s71 offen sc1
    s_waitcnt vmcnt(9) lgkmcnt(4)
    v_mfma_f32_32x32x16_bf16 v[16:31], a[96:99], v[64:67], v[16:31]
    v_mfma_f32_32x32x16_bf16 v[32:47], a[100:103], v[64:67], v[32:47]
    s_add_u32 s71, s74, 32768
    buffer_load_dwordx4 v[104:107], v4, s[36:39], s71 offen sc1
    s_cmp_ge_u32 s79, 2
    s_cbranch_scc1 L_sequential_preLN__grouped_kv_mqa__dense_activation_gelu__prompt_kernel_skip_87
    s_waitcnt vmcnt(9) lgkmcnt(0)
    v_mfma_f32_32x32x16_bf16 v[16:31], a[104:107], v[68:71], v[16:31]
    v_mfma_f32_32x32x16_bf16 v[32:47], a[108:111], v[68:71], v[32:47]
L_sequential_preLN__grouped_kv_mqa__dense_activation_gelu__prompt_kernel_skip_87:
    s_waitcnt lgkmcnt(8)
    s_add_u32 s71, s74, 36864
    buffer_load_dwordx4 v[108:111], v4, s[36:39], s71 offen sc1
    s_waitcnt vmcnt(9) lgkmcnt(8)
    v_mfma_f32_32x32x16_bf16 v[16:31], a[0:3], v[72:75], v[16:31]
    v_mfma_f32_32x32x16_bf16 v[32:47], a[4:7], v[72:75], v[32:47]
    s_add_u32 s71, s74, 40960
    buffer_load_dwordx4 v[48:51], v4, s[36:39], s71 offen sc1
    ds_read_b64_tr_b16 a[112:113], v120 offset:0
    ds_read_b64_tr_b16 a[114:115], v120 offset:1024
    ds_read_b64_tr_b16 a[116:117], v121 offset:0
    ds_read_b64_tr_b16 a[118:119], v121 offset:1024
    s_waitcnt vmcnt(9) lgkmcnt(8)
    v_mfma_f32_32x32x16_bf16 v[16:31], a[8:11], v[76:79], v[16:31]
    v_mfma_f32_32x32x16_bf16 v[32:47], a[12:15], v[76:79], v[32:47]
    s_add_u32 s71, s74, 45056
    buffer_load_dwordx4 v[52:55], v4, s[36:39], s71 offen sc1
    ds_read_b64_tr_b16 a[120:121], v120 offset:8192
    ds_read_b64_tr_b16 a[122:123], v120 offset:9216
    ds_read_b64_tr_b16 a[124:125], v121 offset:8192
    ds_read_b64_tr_b16 a[126:127], v121 offset:9216
    s_waitcnt vmcnt(9) lgkmcnt(8)
    v_mfma_f32_32x32x16_bf16 v[16:31], a[16:19], v[80:83], v[16:31]
    v_mfma_f32_32x32x16_bf16 v[32:47], a[20:23], v[80:83], v[32:47]
    s_add_u32 s71, s74, 49152
    buffer_load_dwordx4 v[56:59], v4, s[36:39], s71 offen sc1
    ds_read_b64_tr_b16 a[64:65], v120 offset:16384
    ds_read_b64_tr_b16 a[66:67], v120 offset:17408
    ds_read_b64_tr_b16 a[68:69], v121 offset:16384
    ds_read_b64_tr_b16 a[70:71], v121 offset:17408
    s_waitcnt vmcnt(9) lgkmcnt(8)
    v_mfma_f32_32x32x16_bf16 v[16:31], a[24:27], v[84:87], v[16:31]
    v_mfma_f32_32x32x16_bf16 v[32:47], a[28:31], v[84:87], v[32:47]
    s_add_u32 s71, s74, 53248
    buffer_load_dwordx4 v[60:63], v4, s[36:39], s71 offen sc1
    ds_read_b64_tr_b16 a[72:73], v120 offset:24576
    ds_read_b64_tr_b16 a[74:75], v120 offset:25600
    ds_read_b64_tr_b16 a[76:77], v121 offset:24576
    ds_read_b64_tr_b16 a[78:79], v121 offset:25600
    s_waitcnt vmcnt(9) lgkmcnt(8)
    v_mfma_f32_32x32x16_bf16 v[16:31], a[32:35], v[88:91], v[16:31]
    v_mfma_f32_32x32x16_bf16 v[32:47], a[36:39], v[88:91], v[32:47]
    s_add_u32 s71, s74, 57344
    buffer_load_dwordx4 v[64:67], v4, s[36:39], s71 offen sc1
    ds_read_b64_tr_b16 a[80:81], v120 offset:32768
    ds_read_b64_tr_b16 a[82:83], v120 offset:33792
    ds_read_b64_tr_b16 a[84:85], v121 offset:32768
    ds_read_b64_tr_b16 a[86:87], v121 offset:33792
    s_waitcnt vmcnt(9) lgkmcnt(8)
    v_mfma_f32_32x32x16_bf16 v[16:31], a[40:43], v[92:95], v[16:31]
    v_mfma_f32_32x32x16_bf16 v[32:47], a[44:47], v[92:95], v[32:47]
    s_add_u32 s71, s74, 61440
    buffer_load_dwordx4 v[68:71], v4, s[36:39], s71 offen sc1
    ds_read_b64_tr_b16 a[88:89], v120 offset:40960
    ds_read_b64_tr_b16 a[90:91], v120 offset:41984
    ds_read_b64_tr_b16 a[92:93], v121 offset:40960
    ds_read_b64_tr_b16 a[94:95], v121 offset:41984
    s_waitcnt vmcnt(9) lgkmcnt(8)
    v_mfma_f32_32x32x16_bf16 v[16:31], a[48:51], v[96:99], v[16:31]
    v_mfma_f32_32x32x16_bf16 v[32:47], a[52:55], v[96:99], v[32:47]
    ds_read_b64_tr_b16 a[96:97], v120 offset:49152
    ds_read_b64_tr_b16 a[98:99], v120 offset:50176
    ds_read_b64_tr_b16 a[100:101], v121 offset:49152
    ds_read_b64_tr_b16 a[102:103], v121 offset:50176
    s_waitcnt vmcnt(8) lgkmcnt(8)
    v_mfma_f32_32x32x16_bf16 v[16:31], a[56:59], v[100:103], v[16:31]
    v_mfma_f32_32x32x16_bf16 v[32:47], a[60:63], v[100:103], v[32:47]
    ds_read_b64_tr_b16 a[104:105], v120 offset:57344
    ds_read_b64_tr_b16 a[106:107], v120 offset:58368
    ds_read_b64_tr_b16 a[108:109], v121 offset:57344
    ds_read_b64_tr_b16 a[110:111], v121 offset:58368
    s_waitcnt vmcnt(7) lgkmcnt(8)
    v_mfma_f32_32x32x16_bf16 v[16:31], a[112:115], v[104:107], v[16:31]
    v_mfma_f32_32x32x16_bf16 v[32:47], a[116:119], v[104:107], v[32:47]
    s_waitcnt vmcnt(6) lgkmcnt(8)
    v_mfma_f32_32x32x16_bf16 v[16:31], a[120:123], v[108:111], v[16:31]
    v_mfma_f32_32x32x16_bf16 v[32:47], a[124:127], v[108:111], v[32:47]
    s_waitcnt vmcnt(5) lgkmcnt(8)
    v_mfma_f32_32x32x16_bf16 v[16:31], a[64:67], v[48:51], v[16:31]
    v_mfma_f32_32x32x16_bf16 v[32:47], a[68:71], v[48:51], v[32:47]
    s_waitcnt vmcnt(4) lgkmcnt(8)
    v_mfma_f32_32x32x16_bf16 v[16:31], a[72:75], v[52:55], v[16:31]
    v_mfma_f32_32x32x16_bf16 v[32:47], a[76:79], v[52:55], v[32:47]
    s_waitcnt vmcnt(3) lgkmcnt(8)
    v_mfma_f32_32x32x16_bf16 v[16:31], a[80:83], v[56:59], v[16:31]
    v_mfma_f32_32x32x16_bf16 v[32:47], a[84:87], v[56:59], v[32:47]
    s_waitcnt vmcnt(2) lgkmcnt(8)
    v_mfma_f32_32x32x16_bf16 v[16:31], a[88:91], v[60:63], v[16:31]
    v_mfma_f32_32x32x16_bf16 v[32:47], a[92:95], v[60:63], v[32:47]
    s_waitcnt vmcnt(1) lgkmcnt(4)
    v_mfma_f32_32x32x16_bf16 v[16:31], a[96:99], v[64:67], v[16:31]
    v_mfma_f32_32x32x16_bf16 v[32:47], a[100:103], v[64:67], v[32:47]
    s_waitcnt vmcnt(0) lgkmcnt(0)
    v_mfma_f32_32x32x16_bf16 v[16:31], a[104:107], v[68:71], v[16:31]
    v_mfma_f32_32x32x16_bf16 v[32:47], a[108:111], v[68:71], v[32:47]
L_sequential_preLN__grouped_kv_mqa__dense_activation_gelu__prompt_kernel_f2e_80:
    s_waitcnt vmcnt(0) lgkmcnt(0)
    s_nop 7
    s_nop 0
    s_cmp_eq_u32 s79, 1
    s_cbranch_scc1 L_sequential_preLN__grouped_kv_mqa__dense_activation_gelu__prompt_kernel_rq_89
    s_cmp_eq_u32 s79, 2
    s_cbranch_scc1 L_sequential_preLN__grouped_kv_mqa__dense_activation_gelu__prompt_kernel_rq_90
    s_cmp_eq_u32 s79, 3
    s_cbranch_scc1 L_sequential_preLN__grouped_kv_mqa__dense_activation_gelu__prompt_kernel_rq_91
L_sequential_preLN__grouped_kv_mqa__dense_activation_gelu__prompt_kernel_rq_88:
    ds_write_b128 v14, v[24:27] offset:6144
    ds_write_b128 v14, v[28:31] offset:7168
    ds_write_b128 v14, v[32:35] offset:12288
    ds_write_b128 v14, v[36:39] offset:13312
    ds_write_b128 v14, v[40:43] offset:18432
    ds_write_b128 v14, v[44:47] offset:19456
    v_pk_add_f32 v[112:113], v[112:113], v[16:17]
    v_pk_add_f32 v[114:115], v[114:115], v[18:19]
    v_pk_add_f32 v[116:117], v[116:117], v[20:21]
    v_pk_add_f32 v[118:119], v[118:119], v[22:23]
    s_branch L_sequential_preLN__grouped_kv_mqa__dense_activation_gelu__prompt_kernel_rj_92
L_sequential_preLN__grouped_kv_mqa__dense_activation_gelu__prompt_kernel_rq_89:
    ds_write_b128 v14, v[16:19] offset:0
    ds_write_b128 v14, v[20:23] offset:1024
    ds_write_b128 v14, v[32:35] offset:14336
    ds_write_b128 v14, v[36:39] offset:15360
    ds_write_b128 v14, v[40:43] offset:20480
    ds_write_b128 v14, v[44:47] offset:21504
    v_pk_add_f32 v[112:113], v[112:113], v[24:25]
    v_pk_add_f32 v[114:115], v[114:115], v[26:27]
    v_pk_add_f32 v[116:117], v[116:117], v[28:29]
    v_pk_add_f32 v[118:119], v[118:119], v[30:31]
    s_branch L_sequential_preLN__grouped_kv_mqa__dense_activation_gelu__prompt_kernel_rj_92
L_sequential_preLN__grouped_kv_mqa__dense_activation_gelu__prompt_kernel_rq_90:
    ds_write_b128 v14, v[16:19] offset:2048
    ds_write_b128 v14, v[20:23] offset:3072
    ds_write_b128 v14, v[24:27] offset:8192
    ds_write_b128 v14, v[28:31] offset:9216
    ds_write_b128 v14, v[40:43] offset:22528
    ds_write_b128 v14, v[44:47] offset:23552
    v_pk_add_f32 v[112:113], v[112:113], v[32:33]
    v_pk_add_f32 v[114:115], v[114:115], v[34:35]
    v_pk_add_f32 v[116:117], v[116:117], v[36:37]
    v_pk_add_f32 v[118:119], v[118:119], v[38:39]
    s_branch L_sequential_preLN__grouped_kv_mqa__dense_activation_gelu__prompt_kernel_rj_92
L_sequential_preLN__grouped_kv_mqa__dense_activation_gelu__prompt_kernel_rq_91:
    ds_write_b128 v14, v[16:19] offset:4096
    ds_write_b128 v14, v[20:23] offset:5120
    ds_write_b128 v14, v[24:27] offset:10240
    ds_write_b128 v14, v[28:31] offset:11264
    ds_write_b128 v14, v[32:35] offset:16384
    ds_write_b128 v14, v[36:39] offset:17408
    v_pk_add_f32 v[112:113], v[112:113], v[40:41]
    v_pk_add_f32 v[114:115], v[114:115], v[42:43]
    v_pk_add_f32 v[116:117], v[116:117], v[44:45]
    v_pk_add_f32 v[118:119], v[118:119], v[46:47]
L_sequential_preLN__grouped_kv_mqa__dense_activation_gelu__prompt_kernel_rj_92:
    s_waitcnt lgkmcnt(0)
    s_barrier
    ds_read_b128 v[48:51], v15 offset:0
    ds_read_b128 v[52:55], v15 offset:1024
    ds_read_b128 v[56:59], v15 offset:2048
    ds_read_b128 v[60:63], v15 offset:3072
    ds_read_b128 v[64:67], v15 offset:4096
    ds_read_b128 v[68:71], v15 offset:5120
    s_waitcnt lgkmcnt(4)
    v_pk_add_f32 v[112:113], v[112:113], v[48:49]
    v_pk_add_f32 v[114:115], v[114:115], v[50:51]
    v_pk_add_f32 v[116:117], v[116:117], v[52:53]
    v_pk_add_f32 v[118:119], v[118:119], v[54:55]
    s_waitcnt lgkmcnt(2)
    v_pk_add_f32 v[112:113], v[112:113], v[56:57]
    v_pk_add_f32 v[114:115], v[114:115], v[58:59]
    v_pk_add_f32 v[116:117], v[116:117], v[60:61]
    v_pk_add_f32 v[118:119], v[118:119], v[62:63]
    s_waitcnt lgkmcnt(0)
    v_pk_add_f32 v[112:113], v[112:113], v[64:65]
    v_pk_add_f32 v[114:115], v[114:115], v[66:67]
    v_pk_add_f32 v[116:117], v[116:117], v[68:69]
    v_pk_add_f32 v[118:119], v[118:119], v[70:71]
    v_cvt_pk_bf16_f32 v24, v112, v113
    v_cvt_pk_bf16_f32 v25, v114, v115
    v_cvt_pk_bf16_f32 v26, v116, v117
    v_cvt_pk_bf16_f32 v27, v118, v119
    s_nop 1
    v_permlane32_swap_b32 v24, v26
    v_permlane32_swap_b32 v25, v27
    buffer_store_dwordx4 v[24:27], v7, s[40:43], s60 offen
L_end:
    s_endpgm
L_sequential_preLN__grouped_kv_mqa__dense_activation_gelu__prompt_kernel_slow_37:
    buffer_store_dwordx4 v[16:19], v4, s[36:39], s59 offen sc1
    s_branch L_sequential_preLN__grouped_kv_mqa__dense_activation_gelu__prompt_kernel_pj_38
L_sequential_preLN__grouped_kv_mqa__dense_activation_gelu__prompt_kernel_slow_39:
    s_waitcnt vmcnt(0)
    buffer_store_dword v3, v2, s[36:39], s61 offen offset:0 sc1
    s_branch L_sequential_preLN__grouped_kv_mqa__dense_activation_gelu__prompt_kernel_pj_40
L_sequential_preLN__grouped_kv_mqa__dense_activation_gelu__prompt_kernel_slow_52:
    buffer_store_dwordx4 v[8:11], v4, s[36:39], s68 offen sc1
    s_branch L_sequential_preLN__grouped_kv_mqa__dense_activation_gelu__prompt_kernel_pj_53
L_sequential_preLN__grouped_kv_mqa__dense_activation_gelu__prompt_kernel_slow_54:
    buffer_store_dword v24, v12, s[36:39], s69 offen sc1
    s_branch L_sequential_preLN__grouped_kv_mqa__dense_activation_gelu__prompt_kernel_pj_55
L_sequential_preLN__grouped_kv_mqa__dense_activation_gelu__prompt_kernel_slow_56:
    s_waitcnt vmcnt(0)
    buffer_store_dword v3, v2, s[36:39], s61 offen offset:256 sc1
    s_branch L_sequential_preLN__grouped_kv_mqa__dense_activation_gelu__prompt_kernel_pj_57
L_sequential_preLN__grouped_kv_mqa__dense_activation_gelu__prompt_kernel_slow_65:
    s_waitcnt vmcnt(0)
    buffer_store_dword v3, v2, s[36:39], s61 offen offset:512 sc1
    s_branch L_sequential_preLN__grouped_kv_mqa__dense_activation_gelu__prompt_kernel_pj_66
L_sequential_preLN__grouped_kv_mqa__dense_activation_gelu__prompt_kernel_slow_67:
    buffer_store_dwordx4 v[32:35], v4, s[36:39], s69 offen sc1
    buffer_store_dwordx4 v[36:39], v4, s[36:39], s69 offen offset:1024 sc1
    s_branch L_sequential_preLN__grouped_kv_mqa__dense_activation_gelu__prompt_kernel_pj_68
L_sequential_preLN__grouped_kv_mqa__dense_activation_gelu__prompt_kernel_slow_69:
    s_waitcnt vmcnt(0)
    buffer_store_dword v3, v2, s[36:39], s61 offen offset:768 sc1
    s_branch L_sequential_preLN__grouped_kv_mqa__dense_activation_gelu__prompt_kernel_pj_70
L_sequential_preLN__grouped_kv_mqa__dense_activation_gelu__prompt_kernel_slow_75:
    buffer_store_dwordx4 v[16:19], v4, s[36:39], s69 offen sc1
    buffer_store_dwordx4 v[20:23], v4, s[36:39], s69 offen offset:1024 sc1
    s_branch L_sequential_preLN__grouped_kv_mqa__dense_activation_gelu__prompt_kernel_pj_76
L_sequential_preLN__grouped_kv_mqa__dense_activation_gelu__prompt_kernel_slow_77:
    s_waitcnt vmcnt(8)
    buffer_store_dword v3, v2, s[36:39], s61 offen offset:512 sc1
    s_branch L_sequential_preLN__grouped_kv_mqa__dense_activation_gelu__prompt_kernel_pj_78
L_fb_code:
L_sequential_preLN__grouped_kv_mqa__dense_activation_gelu__prompt_kernel_fallback_26:
    s_mov_b32 s64, 0x0
    v_mov_b32 v117, 0xff800000
    v_mov_b32 v118, 0xff800000
L_sequential_preLN__grouped_kv_mqa__dense_activation_gelu__prompt_kernel_fbl_93:
    buffer_load_dwordx4 v[12:15], v4, s[32:35], s64 offen sc1
    s_waitcnt vmcnt(0)
    v_mfma_f32_32x32x16_bf16 v[16:31], v[12:15], v[80:83], 0
    v_mfma_f32_32x32x16_bf16 v[32:47], v[12:15], v[84:87], 0
    s_nop 15
    v_max3_f32 v117, v117, v16, v17
    v_max3_f32 v117, v117, v18, v19
    v_max3_f32 v117, v117, v20, v21
    v_max3_f32 v117, v117, v22, v23
    v_max3_f32 v117, v117, v24, v25
    v_max3_f32 v117, v117, v26, v27
    v_max3_f32 v117, v117, v28, v29
    v_max3_f32 v117, v117, v30, v31
    v_max3_f32 v118, v118, v32, v33
    v_max3_f32 v118, v118, v34, v35
    v_max3_f32 v118, v118, v36, v37
    v_max3_f32 v118, v118, v38, v39
    v_max3_f32 v118, v118, v40, v41
    v_max3_f32 v118, v118, v42, v43
    v_max3_f32 v118, v118, v44, v45
    v_max3_f32 v118, v118, v46, v47
    s_add_u32 s64, s64, 1024
    s_cmp_lt_u32 s64, 0x10000
    s_cbranch_scc1 L_sequential_preLN__grouped_kv_mqa__dense_activation_gelu__prompt_kernel_fbl_93
    s_waitcnt lgkmcnt(0)
    ds_read_b128 v[88:91], v113
    ds_read_b128 v[92:95], v113 offset:2048
    s_mov_b64 exec, s[72:73]
    ds_read_b128 v[96:99], v114
    ds_read_b128 v[100:103], v114 offset:512
    s_mov_b64 exec, -1
    s_waitcnt lgkmcnt(3)
    v_mfma_f32_32x32x16_bf16 v[16:31], v[88:91], v[80:83], 0
    v_mov_b32 v48, 0
    v_mov_b32 v49, 0
    v_mov_b32 v50, 0
    v_mov_b32 v51, 0
    v_mov_b32 v52, 0
    v_mov_b32 v53, 0
    v_mov_b32 v54, 0
    v_mov_b32 v55, 0
    v_mov_b32 v56, 0
    v_mov_b32 v57, 0
    v_mov_b32 v58, 0
    v_mov_b32 v59, 0
    v_mov_b32 v60, 0
    v_mov_b32 v61, 0
    v_mov_b32 v62, 0
    v_mov_b32 v63, 0
    v_mov_b32 v64, 0
    v_mov_b32 v65, 0
    v_mov_b32 v66, 0
    v_mov_b32 v67, 0
    v_mov_b32 v68, 0
    v_mov_b32 v69, 0
    v_mov_b32 v70, 0
    v_mov_b32 v71, 0
    v_mov_b32 v72, 0
    v_mov_b32 v73, 0
    v_mov_b32 v74, 0
    v_mov_b32 v75, 0
    v_mov_b32 v76, 0
    v_mov_b32 v77, 0
    v_mov_b32 v78, 0
    v_mov_b32 v79, 0
    v_mov_b32 v2, v117
    v_mov_b32 v3, v118
    s_nop 1
    v_permlane32_swap_b32 v117, v2
    v_permlane32_swap_b32 v118, v3
    s_nop 1
    v_max_f32 v117, v117, v2
    v_max_f32 v118, v118, v3
    s_nop 7
    s_setprio 3
    s_waitcnt lgkmcnt(0)
    v_sub_f32 v16, v16, v117
    v_exp_f32 v16, v16
    v_sub_f32 v17, v17, v117
    v_exp_f32 v17, v17
    v_sub_f32 v18, v18, v117
    v_exp_f32 v18, v18
    v_sub_f32 v19, v19, v117
    v_exp_f32 v19, v19
    v_sub_f32 v20, v20, v117
    v_exp_f32 v20, v20
    v_mfma_f32_32x32x16_bf16 v[32:47], v[88:91], v[84:87], 0
    v_sub_f32 v21, v21, v117
    v_exp_f32 v21, v21
    v_sub_f32 v22, v22, v117
    v_exp_f32 v22, v22
    v_sub_f32 v23, v23, v117
    v_exp_f32 v23, v23
    v_sub_f32 v24, v24, v117
    v_exp_f32 v24, v24
    v_sub_f32 v25, v25, v117
    v_exp_f32 v25, v25
    v_smfmac_f32_32x32x32_bf16 v[48:63], v[96:99], v[16:23], v112
    ds_read_b128 v[88:91], v113 offset:4096
    s_mov_b64 exec, s[72:73]
    ds_read_b128 v[104:107], v114 offset:2048
    ds_read_b128 v[108:111], v114 offset:2560
    s_mov_b64 exec, -1
    v_sub_f32 v26, v26, v117
    v_exp_f32 v26, v26
    v_sub_f32 v27, v27, v117
    v_exp_f32 v27, v27
    v_sub_f32 v28, v28, v117
    v_exp_f32 v28, v28
    v_sub_f32 v29, v29, v117
    v_exp_f32 v29, v29
    v_sub_f32 v30, v30, v117
    v_exp_f32 v30, v30
    v_sub_f32 v31, v31, v117
    v_exp_f32 v31, v31
    v_sub_f32 v32, v32, v118
    v_exp_f32 v32, v32
    v_sub_f32 v33, v33, v118
    v_exp_f32 v33, v33
    v_smfmac_f32_32x32x32_bf16 v[48:63], v[100:103], v[24:31], v112
    v_sub_f32 v34, v34, v118
    v_exp_f32 v34, v34
    v_sub_f32 v35, v35, v118
    v_exp_f32 v35, v35
    v_sub_f32 v36, v36, v118
    v_exp_f32 v36, v36
    v_mfma_f32_32x32x16_bf16 v[16:31], v[92:95], v[80:83], 0
    v_sub_f32 v37, v37, v118
    v_exp_f32 v37, v37
    v_sub_f32 v38, v38, v118
    v_exp_f32 v38, v38
    v_sub_f32 v39, v39, v118
    v_exp_f32 v39, v39
    v_sub_f32 v40, v40, v118
    v_exp_f32 v40, v40
    v_sub_f32 v41, v41, v118
    v_exp_f32 v41, v41
    v_smfmac_f32_32x32x32_bf16 v[64:79], v[96:99], v[32:39], v112
    v_sub_f32 v42, v42, v118
    v_exp_f32 v42, v42
    v_sub_f32 v43, v43, v118
    v_exp_f32 v43, v43
    v_sub_f32 v44, v44, v118
    v_exp_f32 v44, v44
    v_sub_f32 v45, v45, v118
    v_exp_f32 v45, v45
    v_sub_f32 v46, v46, v118
    v_exp_f32 v46, v46
    v_sub_f32 v47, v47, v118
    v_exp_f32 v47, v47
    s_waitcnt lgkmcnt(0)
    v_sub_f32 v16, v16, v117
    v_exp_f32 v16, v16
    v_sub_f32 v17, v17, v117
    v_exp_f32 v17, v17
    v_smfmac_f32_32x32x32_bf16 v[64:79], v[100:103], v[40:47], v112
    v_sub_f32 v18, v18, v117
    v_exp_f32 v18, v18
    v_sub_f32 v19, v19, v117
    v_exp_f32 v19, v19
    v_sub_f32 v20, v20, v117
    v_exp_f32 v20, v20
    v_mfma_f32_32x32x16_bf16 v[32:47], v[92:95], v[84:87], 0
    v_sub_f32 v21, v21, v117
    v_exp_f32 v21, v21
    v_sub_f32 v22, v22, v117
    v_exp_f32 v22, v22
    v_sub_f32 v23, v23, v117
    v_exp_f32 v23, v23
    v_sub_f32 v24, v24, v117
    v_exp_f32 v24, v24
    v_sub_f32 v25, v25, v117
    v_exp_f32 v25, v25
    v_smfmac_f32_32x32x32_bf16 v[48:63], v[104:107], v[16:23], v112
    ds_read_b128 v[92:95], v113 offset:6144
    s_mov_b64 exec, s[72:73]
    ds_read_b128 v[96:99], v114 offset:4096
    ds_read_b128 v[100:103], v114 offset:4608
    s_mov_b64 exec, -1
    v_sub_f32 v26, v26, v117
    v_exp_f32 v26, v26
    v_sub_f32 v27, v27, v117
    v_exp_f32 v27, v27
    v_sub_f32 v28, v28, v117
    v_exp_f32 v28, v28
    v_sub_f32 v29, v29, v117
    v_exp_f32 v29, v29
    v_sub_f32 v30, v30, v117
    v_exp_f32 v30, v30
    v_sub_f32 v31, v31, v117
    v_exp_f32 v31, v31
    v_sub_f32 v32, v32, v118
    v_exp_f32 v32, v32
    v_sub_f32 v33, v33, v118
    v_exp_f32 v33, v33
    v_smfmac_f32_32x32x32_bf16 v[48:63], v[108:111], v[24:31], v112
    v_sub_f32 v34, v34, v118
    v_exp_f32 v34, v34
    v_sub_f32 v35, v35, v118
    v_exp_f32 v35, v35
    v_sub_f32 v36, v36, v118
    v_exp_f32 v36, v36
    v_mfma_f32_32x32x16_bf16 v[16:31], v[88:91], v[80:83], 0
    v_sub_f32 v37, v37, v118
    v_exp_f32 v37, v37
    v_sub_f32 v38, v38, v118
    v_exp_f32 v38, v38
    v_sub_f32 v39, v39, v118
    v_exp_f32 v39, v39
    v_sub_f32 v40, v40, v118
    v_exp_f32 v40, v40
    v_sub_f32 v41, v41, v118
    v_exp_f32 v41, v41
    v_smfmac_f32_32x32x32_bf16 v[64:79], v[104:107], v[32:39], v112
    v_sub_f32 v42, v42, v118
    v_exp_f32 v42, v42
    v_sub_f32 v43, v43, v118
    v_exp_f32 v43, v43
    v_sub_f32 v44, v44, v118
    v_exp_f32 v44, v44
    v_sub_f32 v45, v45, v118
    v_exp_f32 v45, v45
    v_sub_f32 v46, v46, v118
    v_exp_f32 v46, v46
    v_sub_f32 v47, v47, v118
    v_exp_f32 v47, v47
    s_waitcnt vmcnt(10)
    s_barrier
    s_waitcnt lgkmcnt(0)
    v_sub_f32 v16, v16, v117
    v_exp_f32 v16, v16
    v_sub_f32 v17, v17, v117
    v_exp_f32 v17, v17
    v_smfmac_f32_32x32x32_bf16 v[64:79], v[108:111], v[40:47], v112
    v_sub_f32 v18, v18, v117
    v_exp_f32 v18, v18
    v_sub_f32 v19, v19, v117
    v_exp_f32 v19, v19
    v_sub_f32 v20, v20, v117
    v_exp_f32 v20, v20
    v_mfma_f32_32x32x16_bf16 v[32:47], v[88:91], v[84:87], 0
    v_sub_f32 v21, v21, v117
    v_exp_f32 v21, v21
    v_sub_f32 v22, v22, v117
    v_exp_f32 v22, v22
    v_sub_f32 v23, v23, v117
    v_exp_f32 v23, v23
    v_sub_f32 v24, v24, v117
    v_exp_f32 v24, v24
    v_sub_f32 v25, v25, v117
    v_exp_f32 v25, v25
    v_smfmac_f32_32x32x32_bf16 v[48:63], v[96:99], v[16:23], v112
    ds_read_b128 v[88:91], v113 offset:8192
    s_mov_b64 exec, s[72:73]
    ds_read_b128 v[104:107], v114 offset:6144
    ds_read_b128 v[108:111], v114 offset:6656
    s_mov_b64 exec, -1
    s_lshr_b32 s64, s2, 3
    s_lshl_b32 s65, s50, 5
    s_add_u32 s64, s64, s65
    s_lshl_b32 s64, s64, 13
    buffer_load_dword v2, v119, s[44:47], s64 offen
    s_lshl_b32 s64, s52, 3
    s_add_u32 s64, s64, s50
    s_mul_i32 s64, s64, 3072
    s_mov_b64 exec, 0xffffff
    buffer_load_dword v3, v119, s[36:39], s64 offen sc1
    s_mov_b64 exec, -1
    v_sub_f32 v26, v26, v117
    v_exp_f32 v26, v26
    v_sub_f32 v27, v27, v117
    v_exp_f32 v27, v27
    v_sub_f32 v28, v28, v117
    v_exp_f32 v28, v28
    v_sub_f32 v29, v29, v117
    v_exp_f32 v29, v29
    v_sub_f32 v30, v30, v117
    v_exp_f32 v30, v30
    v_sub_f32 v31, v31, v117
    v_exp_f32 v31, v31
    v_sub_f32 v32, v32, v118
    v_exp_f32 v32, v32
    v_sub_f32 v33, v33, v118
    v_exp_f32 v33, v33
    v_smfmac_f32_32x32x32_bf16 v[48:63], v[100:103], v[24:31], v112
    v_sub_f32 v34, v34, v118
    v_exp_f32 v34, v34
    v_sub_f32 v35, v35, v118
    v_exp_f32 v35, v35
    v_sub_f32 v36, v36, v118
    v_exp_f32 v36, v36
    v_mfma_f32_32x32x16_bf16 v[16:31], v[92:95], v[80:83], 0
    v_sub_f32 v37, v37, v118
    v_exp_f32 v37, v37
    v_sub_f32 v38, v38, v118
    v_exp_f32 v38, v38
    v_sub_f32 v39, v39, v118
    v_exp_f32 v39, v39
    v_sub_f32 v40, v40, v118
    v_exp_f32 v40, v40
    v_sub_f32 v41, v41, v118
    v_exp_f32 v41, v41
    v_smfmac_f32_32x32x32_bf16 v[64:79], v[96:99], v[32:39], v112
    v_sub_f32 v42, v42, v118
    v_exp_f32 v42, v42
    v_sub_f32 v43, v43, v118
    v_exp_f32 v43, v43
    v_sub_f32 v44, v44, v118
    v_exp_f32 v44, v44
    v_sub_f32 v45, v45, v118
    v_exp_f32 v45, v45
    v_sub_f32 v46, v46, v118
    v_exp_f32 v46, v46
    v_sub_f32 v47, v47, v118
    v_exp_f32 v47, v47
    s_waitcnt lgkmcnt(0)
    v_sub_f32 v16, v16, v117
    v_exp_f32 v16, v16
    v_sub_f32 v17, v17, v117
    v_exp_f32 v17, v17
    v_smfmac_f32_32x32x32_bf16 v[64:79], v[100:103], v[40:47], v112
    v_sub_f32 v18, v18, v117
    v_exp_f32 v18, v18
    v_sub_f32 v19, v19, v117
    v_exp_f32 v19, v19
    v_sub_f32 v20, v20, v117
    v_exp_f32 v20, v20
    v_mfma_f32_32x32x16_bf16 v[32:47], v[92:95], v[84:87], 0
    v_sub_f32 v21, v21, v117
    v_exp_f32 v21, v21
    v_sub_f32 v22, v22, v117
    v_exp_f32 v22, v22
    v_sub_f32 v23, v23, v117
    v_exp_f32 v23, v23
    v_sub_f32 v24, v24, v117
    v_exp_f32 v24, v24
    v_sub_f32 v25, v25, v117
    v_exp_f32 v25, v25
    v_smfmac_f32_32x32x32_bf16 v[48:63], v[104:107], v[16:23], v112
    ds_read_b128 v[92:95], v113 offset:10240
    s_mov_b64 exec, s[72:73]
    ds_read_b128 v[96:99], v114 offset:8192
    ds_read_b128 v[100:103], v114 offset:8704
    s_mov_b64 exec, -1
    s_lshl_b32 s64, s50, 2
    v_mov_b32 v12, s64
    v_mov_b32 v13, 0
    ds_write_b32 v12, v13
    v_sub_f32 v26, v26, v117
    v_exp_f32 v26, v26
    v_sub_f32 v27, v27, v117
    v_exp_f32 v27, v27
    v_sub_f32 v28, v28, v117
    v_exp_f32 v28, v28
    v_sub_f32 v29, v29, v117
    v_exp_f32 v29, v29
    v_sub_f32 v30, v30, v117
    v_exp_f32 v30, v30
    v_sub_f32 v31, v31, v117
    v_exp_f32 v31, v31
    v_sub_f32 v32, v32, v118
    v_exp_f32 v32, v32
    v_sub_f32 v33, v33, v118
    v_exp_f32 v33, v33
    v_smfmac_f32_32x32x32_bf16 v[48:63], v[108:111], v[24:31], v112
    v_sub_f32 v34, v34, v118
    v_exp_f32 v34, v34
    v_sub_f32 v35, v35, v118
    v_exp_f32 v35, v35
    v_sub_f32 v36, v36, v118
    v_exp_f32 v36, v36
    v_mfma_f32_32x32x16_bf16 v[16:31], v[88:91], v[80:83], 0
    v_sub_f32 v37, v37, v118
    v_exp_f32 v37, v37
    v_sub_f32 v38, v38, v118
    v_exp_f32 v38, v38
    v_sub_f32 v39, v39, v118
    v_exp_f32 v39, v39
    v_sub_f32 v40, v40, v118
    v_exp_f32 v40, v40
    v_sub_f32 v41, v41, v118
    v_exp_f32 v41, v41
    v_smfmac_f32_32x32x32_bf16 v[64:79], v[104:107], v[32:39], v112
    v_sub_f32 v42, v42, v118
    v_exp_f32 v42, v42
    v_sub_f32 v43, v43, v118
    v_exp_f32 v43, v43
    v_sub_f32 v44, v44, v118
    v_exp_f32 v44, v44
    v_sub_f32 v45, v45, v118
    v_exp_f32 v45, v45
    v_sub_f32 v46, v46, v118
    v_exp_f32 v46, v46
    v_sub_f32 v47, v47, v118
    v_exp_f32 v47, v47
    s_waitcnt lgkmcnt(0)
    v_sub_f32 v16, v16, v117
    v_exp_f32 v16, v16
    v_sub_f32 v17, v17, v117
    v_exp_f32 v17, v17
    v_smfmac_f32_32x32x32_bf16 v[64:79], v[108:111], v[40:47], v112
    v_sub_f32 v18, v18, v117
    v_exp_f32 v18, v18
    v_sub_f32 v19, v19, v117
    v_exp_f32 v19, v19
    v_sub_f32 v20, v20, v117
    v_exp_f32 v20, v20
    v_mfma_f32_32x32x16_bf16 v[32:47], v[88:91], v[84:87], 0
    v_sub_f32 v21, v21, v117
    v_exp_f32 v21, v21
    v_sub_f32 v22, v22, v117
    v_exp_f32 v22, v22
    v_sub_f32 v23, v23, v117
    v_exp_f32 v23, v23
    v_sub_f32 v24, v24, v117
    v_exp_f32 v24, v24
    v_sub_f32 v25, v25, v117
    v_exp_f32 v25, v25
    v_smfmac_f32_32x32x32_bf16 v[48:63], v[96:99], v[16:23], v112
    ds_read_b128 v[88:91], v113 offset:12288
    s_mov_b64 exec, s[72:73]
    ds_read_b128 v[104:107], v114 offset:10240
    ds_read_b128 v[108:111], v114 offset:10752
    s_mov_b64 exec, -1
    s_cmp_ge_u32 s52, 3
    s_cselect_b32 s64, s53, 0
    s_and_b32 s64, s64, s54
    s_cselect_b32 s46, 0, s46
    v_sub_f32 v26, v26, v117
    v_exp_f32 v26, v26
    v_sub_f32 v27, v27, v117
    v_exp_f32 v27, v27
    v_sub_f32 v28, v28, v117
    v_exp_f32 v28, v28
    v_sub_f32 v29, v29, v117
    v_exp_f32 v29, v29
    v_sub_f32 v30, v30, v117
    v_exp_f32 v30, v30
    v_sub_f32 v31, v31, v117
    v_exp_f32 v31, v31
    v_sub_f32 v32, v32, v118
    v_exp_f32 v32, v32
    v_sub_f32 v33, v33, v118
    v_exp_f32 v33, v33
    v_smfmac_f32_32x32x32_bf16 v[48:63], v[100:103], v[24:31], v112
    v_sub_f32 v34, v34, v118
    v_exp_f32 v34, v34
    v_sub_f32 v35, v35, v118
    v_exp_f32 v35, v35
    v_sub_f32 v36, v36, v118
    v_exp_f32 v36, v36
    v_mfma_f32_32x32x16_bf16 v[16:31], v[92:95], v[80:83], 0
    v_sub_f32 v37, v37, v118
    v_exp_f32 v37, v37
    v_sub_f32 v38, v38, v118
    v_exp_f32 v38, v38
    v_sub_f32 v39, v39, v118
    v_exp_f32 v39, v39
    v_sub_f32 v40, v40, v118
    v_exp_f32 v40, v40
    v_sub_f32 v41, v41, v118
    v_exp_f32 v41, v41
    v_smfmac_f32_32x32x32_bf16 v[64:79], v[96:99], v[32:39], v112
    v_sub_f32 v42, v42, v118
    v_exp_f32 v42, v42
    v_sub_f32 v43, v43, v118
    v_exp_f32 v43, v43
    v_sub_f32 v44, v44, v118
    v_exp_f32 v44, v44
    v_sub_f32 v45, v45, v118
    v_exp_f32 v45, v45
    v_sub_f32 v46, v46, v118
    v_exp_f32 v46, v46
    v_sub_f32 v47, v47, v118
    v_exp_f32 v47, v47
    s_waitcnt lgkmcnt(0)
    v_sub_f32 v16, v16, v117
    v_exp_f32 v16, v16
    v_sub_f32 v17, v17, v117
    v_exp_f32 v17, v17
    v_smfmac_f32_32x32x32_bf16 v[64:79], v[100:103], v[40:47], v112
    v_sub_f32 v18, v18, v117
    v_exp_f32 v18, v18
    v_sub_f32 v19, v19, v117
    v_exp_f32 v19, v19
    v_sub_f32 v20, v20, v117
    v_exp_f32 v20, v20
    v_mfma_f32_32x32x16_bf16 v[32:47], v[92:95], v[84:87], 0
    v_sub_f32 v21, v21, v117
    v_exp_f32 v21, v21
    v_sub_f32 v22, v22, v117
    v_exp_f32 v22, v22
    v_sub_f32 v23, v23, v117
    v_exp_f32 v23, v23
    v_sub_f32 v24, v24, v117
    v_exp_f32 v24, v24
    v_sub_f32 v25, v25, v117
    v_exp_f32 v25, v25
    v_smfmac_f32_32x32x32_bf16 v[48:63], v[104:107], v[16:23], v112
    ds_read_b128 v[92:95], v113 offset:14336
    s_mov_b64 exec, s[72:73]
    ds_read_b128 v[96:99], v114 offset:12288
    ds_read_b128 v[100:103], v114 offset:12800
    s_mov_b64 exec, -1
    v_sub_f32 v26, v26, v117
    v_exp_f32 v26, v26
    v_sub_f32 v27, v27, v117
    v_exp_f32 v27, v27
    v_sub_f32 v28, v28, v117
    v_exp_f32 v28, v28
    v_sub_f32 v29, v29, v117
    v_exp_f32 v29, v29
    v_sub_f32 v30, v30, v117
    v_exp_f32 v30, v30
    v_sub_f32 v31, v31, v117
    v_exp_f32 v31, v31
    v_sub_f32 v32, v32, v118
    v_exp_f32 v32, v32
    v_sub_f32 v33, v33, v118
    v_exp_f32 v33, v33
    v_smfmac_f32_32x32x32_bf16 v[48:63], v[108:111], v[24:31], v112
    v_sub_f32 v34, v34, v118
    v_exp_f32 v34, v34
    v_sub_f32 v35, v35, v118
    v_exp_f32 v35, v35
    v_sub_f32 v36, v36, v118
    v_exp_f32 v36, v36
    v_mfma_f32_32x32x16_bf16 v[16:31], v[88:91], v[80:83], 0
    v_sub_f32 v37, v37, v118
    v_exp_f32 v37, v37
    v_sub_f32 v38, v38, v118
    v_exp_f32 v38, v38
    v_sub_f32 v39, v39, v118
    v_exp_f32 v39, v39
    v_sub_f32 v40, v40, v118
    v_exp_f32 v40, v40
    v_sub_f32 v41, v41, v118
    v_exp_f32 v41, v41
    v_smfmac_f32_32x32x32_bf16 v[64:79], v[104:107], v[32:39], v112
    v_sub_f32 v42, v42, v118
    v_exp_f32 v42, v42
    v_sub_f32 v43, v43, v118
    v_exp_f32 v43, v43
    v_sub_f32 v44, v44, v118
    v_exp_f32 v44, v44
    v_sub_f32 v45, v45, v118
    v_exp_f32 v45, v45
    v_sub_f32 v46, v46, v118
    v_exp_f32 v46, v46
    v_sub_f32 v47, v47, v118
    v_exp_f32 v47, v47
    s_waitcnt vmcnt(2) lgkmcnt(0)
    s_barrier
    s_waitcnt lgkmcnt(0)
    v_sub_f32 v16, v16, v117
    v_exp_f32 v16, v16
    v_sub_f32 v17, v17, v117
    v_exp_f32 v17, v17
    v_smfmac_f32_32x32x32_bf16 v[64:79], v[108:111], v[40:47], v112
    v_sub_f32 v18, v18, v117
    v_exp_f32 v18, v18
    v_sub_f32 v19, v19, v117
    v_exp_f32 v19, v19
    v_sub_f32 v20, v20, v117
    v_exp_f32 v20, v20
    v_mfma_f32_32x32x16_bf16 v[32:47], v[88:91], v[84:87], 0
    v_sub_f32 v21, v21, v117
    v_exp_f32 v21, v21
    v_sub_f32 v22, v22, v117
    v_exp_f32 v22, v22
    v_sub_f32 v23, v23, v117
    v_exp_f32 v23, v23
    v_sub_f32 v24, v24, v117
    v_exp_f32 v24, v24
    v_sub_f32 v25, v25, v117
    v_exp_f32 v25, v25
    v_smfmac_f32_32x32x32_bf16 v[48:63], v[96:99], v[16:23], v112
    ds_read_b128 v[88:91], v113 offset:16384
    s_mov_b64 exec, s[72:73]
    ds_read_b128 v[104:107], v114 offset:14336
    ds_read_b128 v[108:111], v114 offset:14848
    s_mov_b64 exec, -1
    v_sub_f32 v26, v26, v117
    v_exp_f32 v26, v26
    v_sub_f32 v27, v27, v117
    v_exp_f32 v27, v27
    v_sub_f32 v28, v28, v117
    v_exp_f32 v28, v28
    v_sub_f32 v29, v29, v117
    v_exp_f32 v29, v29
    v_sub_f32 v30, v30, v117
    v_exp_f32 v30, v30
    v_sub_f32 v31, v31, v117
    v_exp_f32 v31, v31
    v_sub_f32 v32, v32, v118
    v_exp_f32 v32, v32
    v_sub_f32 v33, v33, v118
    v_exp_f32 v33, v33
    v_smfmac_f32_32x32x32_bf16 v[48:63], v[100:103], v[24:31], v112
    v_sub_f32 v34, v34, v118
    v_exp_f32 v34, v34
    v_sub_f32 v35, v35, v118
    v_exp_f32 v35, v35
    v_sub_f32 v36, v36, v118
    v_exp_f32 v36, v36
    v_mfma_f32_32x32x16_bf16 v[16:31], v[92:95], v[80:83], 0
    v_sub_f32 v37, v37, v118
    v_exp_f32 v37, v37
    v_sub_f32 v38, v38, v118
    v_exp_f32 v38, v38
    v_sub_f32 v39, v39, v118
    v_exp_f32 v39, v39
    v_sub_f32 v40, v40, v118
    v_exp_f32 v40, v40
    v_sub_f32 v41, v41, v118
    v_exp_f32 v41, v41
    v_smfmac_f32_32x32x32_bf16 v[64:79], v[96:99], v[32:39], v112
    buffer_load_dwordx4 v[8:11], v7, s[40:43], s60 offen
    v_min_u32 v12, 2688, v119
    v_min_u32 v13, 896, v119
    global_load_dword v2, v12, s[18:19]
    global_load_dword v2, v13, s[22:23]
    s_cmp_lg_u32 s50, 7
    s_cbranch_scc1 L_sequential_preLN__grouped_kv_mqa__dense_activation_gelu__prompt_kernel_noz_94
    v_lshrrev_b32 v14, 3, v1
    v_and_b32 v15, 7, v1
    v_lshlrev_b32 v15, 2, v15
    v_lshl_add_u32 v14, v14, 8, v15
    v_mov_b32 v15, 0
    s_sub_u32 s64, s61, 28
    s_mov_b32 exec_hi, 0
    buffer_store_dword v15, v14, s[36:39], s64 offen sc1
    s_mov_b64 exec, -1
L_sequential_preLN__grouped_kv_mqa__dense_activation_gelu__prompt_kernel_noz_94:
    v_sub_f32 v42, v42, v118
    v_exp_f32 v42, v42
    v_sub_f32 v43, v43, v118
    v_exp_f32 v43, v43
    v_sub_f32 v44, v44, v118
    v_exp_f32 v44, v44
    v_sub_f32 v45, v45, v118
    v_exp_f32 v45, v45
    v_sub_f32 v46, v46, v118
    v_exp_f32 v46, v46
    v_sub_f32 v47, v47, v118
    v_exp_f32 v47, v47
    s_waitcnt lgkmcnt(0)
    v_sub_f32 v16, v16, v117
    v_exp_f32 v16, v16
    v_sub_f32 v17, v17, v117
    v_exp_f32 v17, v17
    v_smfmac_f32_32x32x32_bf16 v[64:79], v[100:103], v[40:47], v112
    v_sub_f32 v18, v18, v117
    v_exp_f32 v18, v18
    v_sub_f32 v19, v19, v117
    v_exp_f32 v19, v19
    v_sub_f32 v20, v20, v117
    v_exp_f32 v20, v20
    v_mfma_f32_32x32x16_bf16 v[32:47], v[92:95], v[84:87], 0
    v_sub_f32 v21, v21, v117
    v_exp_f32 v21, v21
    v_sub_f32 v22, v22, v117
    v_exp_f32 v22, v22
    v_sub_f32 v23, v23, v117
    v_exp_f32 v23, v23
    v_sub_f32 v24, v24, v117
    v_exp_f32 v24, v24
    v_sub_f32 v25, v25, v117
    v_exp_f32 v25, v25
    v_smfmac_f32_32x32x32_bf16 v[48:63], v[104:107], v[16:23], v112
    ds_read_b128 v[92:95], v113 offset:18432
    s_mov_b64 exec, s[72:73]
    ds_read_b128 v[96:99], v114 offset:16384
    ds_read_b128 v[100:103], v114 offset:16896
    s_mov_b64 exec, -1
    v_sub_f32 v26, v26, v117
    v_exp_f32 v26, v26
    v_sub_f32 v27, v27, v117
    v_exp_f32 v27, v27
    v_sub_f32 v28, v28, v117
    v_exp_f32 v28, v28
    v_sub_f32 v29, v29, v117
    v_exp_f32 v29, v29
    v_sub_f32 v30, v30, v117
    v_exp_f32 v30, v30
    v_sub_f32 v31, v31, v117
    v_exp_f32 v31, v31
    v_sub_f32 v32, v32, v118
    v_exp_f32 v32, v32
    v_sub_f32 v33, v33, v118
    v_exp_f32 v33, v33
    v_smfmac_f32_32x32x32_bf16 v[48:63], v[108:111], v[24:31], v112
    v_sub_f32 v34, v34, v118
    v_exp_f32 v34, v34
    v_sub_f32 v35, v35, v118
    v_exp_f32 v35, v35
    v_sub_f32 v36, v36, v118
    v_exp_f32 v36, v36
    v_mfma_f32_32x32x16_bf16 v[16:31], v[88:91], v[80:83], 0
    v_sub_f32 v37, v37, v118
    v_exp_f32 v37, v37
    v_sub_f32 v38, v38, v118
    v_exp_f32 v38, v38
    v_sub_f32 v39, v39, v118
    v_exp_f32 v39, v39
    v_sub_f32 v40, v40, v118
    v_exp_f32 v40, v40
    v_sub_f32 v41, v41, v118
    v_exp_f32 v41, v41
    v_smfmac_f32_32x32x32_bf16 v[64:79], v[104:107], v[32:39], v112
    v_sub_f32 v42, v42, v118
    v_exp_f32 v42, v42
    v_sub_f32 v43, v43, v118
    v_exp_f32 v43, v43
    v_sub_f32 v44, v44, v118
    v_exp_f32 v44, v44
    v_sub_f32 v45, v45, v118
    v_exp_f32 v45, v45
    v_sub_f32 v46, v46, v118
    v_exp_f32 v46, v46
    v_sub_f32 v47, v47, v118
    v_exp_f32 v47, v47
    s_waitcnt lgkmcnt(0)
    v_sub_f32 v16, v16, v117
    v_exp_f32 v16, v16
    v_sub_f32 v17, v17, v117
    v_exp_f32 v17, v17
    v_smfmac_f32_32x32x32_bf16 v[64:79], v[108:111], v[40:47], v112
    v_sub_f32 v18, v18, v117
    v_exp_f32 v18, v18
    v_sub_f32 v19, v19, v117
    v_exp_f32 v19, v19
    v_sub_f32 v20, v20, v117
    v_exp_f32 v20, v20
    v_mfma_f32_32x32x16_bf16 v[32:47], v[88:91], v[84:87], 0
    v_sub_f32 v21, v21, v117
    v_exp_f32 v21, v21
    v_sub_f32 v22, v22, v117
    v_exp_f32 v22, v22
    v_sub_f32 v23, v23, v117
    v_exp_f32 v23, v23
    v_sub_f32 v24, v24, v117
    v_exp_f32 v24, v24
    v_sub_f32 v25, v25, v117
    v_exp_f32 v25, v25
    v_smfmac_f32_32x32x32_bf16 v[48:63], v[96:99], v[16:23], v112
    ds_read_b128 v[88:91], v113 offset:20480
    s_mov_b64 exec, s[72:73]
    ds_read_b128 v[104:107], v114 offset:18432
    ds_read_b128 v[108:111], v114 offset:18944
    s_mov_b64 exec, -1
    v_sub_f32 v26, v26, v117
    v_exp_f32 v26, v26
    v_sub_f32 v27, v27, v117
    v_exp_f32 v27, v27
    v_sub_f32 v28, v28, v117
    v_exp_f32 v28, v28
    v_sub_f32 v29, v29, v117
    v_exp_f32 v29, v29
    v_sub_f32 v30, v30, v117
    v_exp_f32 v30, v30
    v_sub_f32 v31, v31, v117
    v_exp_f32 v31, v31
    v_sub_f32 v32, v32, v118
    v_exp_f32 v32, v32
    v_sub_f32 v33, v33, v118
    v_exp_f32 v33, v33
    v_smfmac_f32_32x32x32_bf16 v[48:63], v[100:103], v[24:31], v112
    v_sub_f32 v34, v34, v118
    v_exp_f32 v34, v34
    v_sub_f32 v35, v35, v118
    v_exp_f32 v35, v35
    v_sub_f32 v36, v36, v118
    v_exp_f32 v36, v36
    v_mfma_f32_32x32x16_bf16 v[16:31], v[92:95], v[80:83], 0
    v_sub_f32 v37, v37, v118
    v_exp_f32 v37, v37
    v_sub_f32 v38, v38, v118
    v_exp_f32 v38, v38
    v_sub_f32 v39, v39, v118
    v_exp_f32 v39, v39
    v_sub_f32 v40, v40, v118
    v_exp_f32 v40, v40
    v_sub_f32 v41, v41, v118
    v_exp_f32 v41, v41
    v_smfmac_f32_32x32x32_bf16 v[64:79], v[96:99], v[32:39], v112
    v_sub_f32 v42, v42, v118
    v_exp_f32 v42, v42
    v_sub_f32 v43, v43, v118
    v_exp_f32 v43, v43
    v_sub_f32 v44, v44, v118
    v_exp_f32 v44, v44
    v_sub_f32 v45, v45, v118
    v_exp_f32 v45, v45
    v_sub_f32 v46, v46, v118
    v_exp_f32 v46, v46
    v_sub_f32 v47, v47, v118
    v_exp_f32 v47, v47
    s_waitcnt lgkmcnt(0)
    v_sub_f32 v16, v16, v117
    v_exp_f32 v16, v16
    v_sub_f32 v17, v17, v117
    v_exp_f32 v17, v17
    v_smfmac_f32_32x32x32_bf16 v[64:79], v[100:103], v[40:47], v112
    v_sub_f32 v18, v18, v117
    v_exp_f32 v18, v18
    v_sub_f32 v19, v19, v117
    v_exp_f32 v19, v19
    v_sub_f32 v20, v20, v117
    v_exp_f32 v20, v20
    v_mfma_f32_32x32x16_bf16 v[32:47], v[92:95], v[84:87], 0
    v_sub_f32 v21, v21, v117
    v_exp_f32 v21, v21
    v_sub_f32 v22, v22, v117
    v_exp_f32 v22, v22
    v_sub_f32 v23, v23, v117
    v_exp_f32 v23, v23
    v_sub_f32 v24, v24, v117
    v_exp_f32 v24, v24
    v_sub_f32 v25, v25, v117
    v_exp_f32 v25, v25
    v_smfmac_f32_32x32x32_bf16 v[48:63], v[104:107], v[16:23], v112
    ds_read_b128 v[92:95], v113 offset:22528
    s_mov_b64 exec, s[72:73]
    ds_read_b128 v[96:99], v114 offset:20480
    ds_read_b128 v[100:103], v114 offset:20992
    s_mov_b64 exec, -1
    v_sub_f32 v26, v26, v117
    v_exp_f32 v26, v26
    v_sub_f32 v27, v27, v117
    v_exp_f32 v27, v27
    v_sub_f32 v28, v28, v117
    v_exp_f32 v28, v28
    v_sub_f32 v29, v29, v117
    v_exp_f32 v29, v29
    v_sub_f32 v30, v30, v117
    v_exp_f32 v30, v30
    v_sub_f32 v31, v31, v117
    v_exp_f32 v31, v31
    v_sub_f32 v32, v32, v118
    v_exp_f32 v32, v32
    v_sub_f32 v33, v33, v118
    v_exp_f32 v33, v33
    v_smfmac_f32_32x32x32_bf16 v[48:63], v[108:111], v[24:31], v112
    v_sub_f32 v34, v34, v118
    v_exp_f32 v34, v34
    v_sub_f32 v35, v35, v118
    v_exp_f32 v35, v35
    v_sub_f32 v36, v36, v118
    v_exp_f32 v36, v36
    v_mfma_f32_32x32x16_bf16 v[16:31], v[88:91], v[80:83], 0
    v_sub_f32 v37, v37, v118
    v_exp_f32 v37, v37
    v_sub_f32 v38, v38, v118
    v_exp_f32 v38, v38
    v_sub_f32 v39, v39, v118
    v_exp_f32 v39, v39
    v_sub_f32 v40, v40, v118
    v_exp_f32 v40, v40
    v_sub_f32 v41, v41, v118
    v_exp_f32 v41, v41
    v_smfmac_f32_32x32x32_bf16 v[64:79], v[104:107], v[32:39], v112
    v_sub_f32 v42, v42, v118
    v_exp_f32 v42, v42
    v_sub_f32 v43, v43, v118
    v_exp_f32 v43, v43
    v_sub_f32 v44, v44, v118
    v_exp_f32 v44, v44
    v_sub_f32 v45, v45, v118
    v_exp_f32 v45, v45
    v_sub_f32 v46, v46, v118
    v_exp_f32 v46, v46
    v_sub_f32 v47, v47, v118
    v_exp_f32 v47, v47
    s_waitcnt lgkmcnt(0)
    v_sub_f32 v16, v16, v117
    v_exp_f32 v16, v16
    v_sub_f32 v17, v17, v117
    v_exp_f32 v17, v17
    v_smfmac_f32_32x32x32_bf16 v[64:79], v[108:111], v[40:47], v112
    v_sub_f32 v18, v18, v117
    v_exp_f32 v18, v18
    v_sub_f32 v19, v19, v117
    v_exp_f32 v19, v19
    v_sub_f32 v20, v20, v117
    v_exp_f32 v20, v20
    v_mfma_f32_32x32x16_bf16 v[32:47], v[88:91], v[84:87], 0
    v_sub_f32 v21, v21, v117
    v_exp_f32 v21, v21
    v_sub_f32 v22, v22, v117
    v_exp_f32 v22, v22
    v_sub_f32 v23, v23, v117
    v_exp_f32 v23, v23
    v_sub_f32 v24, v24, v117
    v_exp_f32 v24, v24
    v_sub_f32 v25, v25, v117
    v_exp_f32 v25, v25
    v_smfmac_f32_32x32x32_bf16 v[48:63], v[96:99], v[16:23], v112
    ds_read_b128 v[88:91], v113 offset:24576
    s_mov_b64 exec, s[72:73]
    ds_read_b128 v[104:107], v114 offset:22528
    ds_read_b128 v[108:111], v114 offset:23040
    s_mov_b64 exec, -1
    v_sub_f32 v26, v26, v117
    v_exp_f32 v26, v26
    v_sub_f32 v27, v27, v117
    v_exp_f32 v27, v27
    v_sub_f32 v28, v28, v117
    v_exp_f32 v28, v28
    v_sub_f32 v29, v29, v117
    v_exp_f32 v29, v29
    v_sub_f32 v30, v30, v117
    v_exp_f32 v30, v30
    v_sub_f32 v31, v31, v117
    v_exp_f32 v31, v31
    v_sub_f32 v32, v32, v118
    v_exp_f32 v32, v32
    v_sub_f32 v33, v33, v118
    v_exp_f32 v33, v33
    v_smfmac_f32_32x32x32_bf16 v[48:63], v[100:103], v[24:31], v112
    v_sub_f32 v34, v34, v118
    v_exp_f32 v34, v34
    v_sub_f32 v35, v35, v118
    v_exp_f32 v35, v35
    v_sub_f32 v36, v36, v118
    v_exp_f32 v36, v36
    v_mfma_f32_32x32x16_bf16 v[16:31], v[92:95], v[80:83], 0
    v_sub_f32 v37, v37, v118
    v_exp_f32 v37, v37
    v_sub_f32 v38, v38, v118
    v_exp_f32 v38, v38
    v_sub_f32 v39, v39, v118
    v_exp_f32 v39, v39
    v_sub_f32 v40, v40, v118
    v_exp_f32 v40, v40
    v_sub_f32 v41, v41, v118
    v_exp_f32 v41, v41
    v_smfmac_f32_32x32x32_bf16 v[64:79], v[96:99], v[32:39], v112
    v_sub_f32 v42, v42, v118
    v_exp_f32 v42, v42
    v_sub_f32 v43, v43, v118
    v_exp_f32 v43, v43
    v_sub_f32 v44, v44, v118
    v_exp_f32 v44, v44
    v_sub_f32 v45, v45, v118
    v_exp_f32 v45, v45
    v_sub_f32 v46, v46, v118
    v_exp_f32 v46, v46
    v_sub_f32 v47, v47, v118
    v_exp_f32 v47, v47
    s_waitcnt lgkmcnt(0)
    v_sub_f32 v16, v16, v117
    v_exp_f32 v16, v16
    v_sub_f32 v17, v17, v117
    v_exp_f32 v17, v17
    v_smfmac_f32_32x32x32_bf16 v[64:79], v[100:103], v[40:47], v112
    v_sub_f32 v18, v18, v117
    v_exp_f32 v18, v18
    v_sub_f32 v19, v19, v117
    v_exp_f32 v19, v19
    v_sub_f32 v20, v20, v117
    v_exp_f32 v20, v20
    v_mfma_f32_32x32x16_bf16 v[32:47], v[92:95], v[84:87], 0
    v_sub_f32 v21, v21, v117
    v_exp_f32 v21, v21
    v_sub_f32 v22, v22, v117
    v_exp_f32 v22, v22
    v_sub_f32 v23, v23, v117
    v_exp_f32 v23, v23
    v_sub_f32 v24, v24, v117
    v_exp_f32 v24, v24
    v_sub_f32 v25, v25, v117
    v_exp_f32 v25, v25
    v_smfmac_f32_32x32x32_bf16 v[48:63], v[104:107], v[16:23], v112
    ds_read_b128 v[92:95], v113 offset:26624
    s_mov_b64 exec, s[72:73]
    ds_read_b128 v[96:99], v114 offset:24576
    ds_read_b128 v[100:103], v114 offset:25088
    s_mov_b64 exec, -1
    s_add_u32 m0, s75, 0
    s_add_u32 s71, s74, 0
    buffer_load_dwordx4 v115, s[44:47], s71 offen  lds
    s_add_u32 m0, s75, 1024
    s_add_u32 s71, s74, 44032
    buffer_load_dwordx4 v115, s[44:47], s71 offen  lds
    v_sub_f32 v26, v26, v117
    v_exp_f32 v26, v26
    v_sub_f32 v27, v27, v117
    v_exp_f32 v27, v27
    v_sub_f32 v28, v28, v117
    v_exp_f32 v28, v28
    v_sub_f32 v29, v29, v117
    v_exp_f32 v29, v29
    v_sub_f32 v30, v30, v117
    v_exp_f32 v30, v30
    v_sub_f32 v31, v31, v117
    v_exp_f32 v31, v31
    v_sub_f32 v32, v32, v118
    v_exp_f32 v32, v32
    v_sub_f32 v33, v33, v118
    v_exp_f32 v33, v33
    v_smfmac_f32_32x32x32_bf16 v[48:63], v[108:111], v[24:31], v112
    v_sub_f32 v34, v34, v118
    v_exp_f32 v34, v34
    v_sub_f32 v35, v35, v118
    v_exp_f32 v35, v35
    v_sub_f32 v36, v36, v118
    v_exp_f32 v36, v36
    v_mfma_f32_32x32x16_bf16 v[16:31], v[88:91], v[80:83], 0
    v_sub_f32 v37, v37, v118
    v_exp_f32 v37, v37
    v_sub_f32 v38, v38, v118
    v_exp_f32 v38, v38
    v_sub_f32 v39, v39, v118
    v_exp_f32 v39, v39
    v_sub_f32 v40, v40, v118
    v_exp_f32 v40, v40
    v_sub_f32 v41, v41, v118
    v_exp_f32 v41, v41
    v_smfmac_f32_32x32x32_bf16 v[64:79], v[104:107], v[32:39], v112
    v_sub_f32 v42, v42, v118
    v_exp_f32 v42, v42
    v_sub_f32 v43, v43, v118
    v_exp_f32 v43, v43
    v_sub_f32 v44, v44, v118
    v_exp_f32 v44, v44
    v_sub_f32 v45, v45, v118
    v_exp_f32 v45, v45
    v_sub_f32 v46, v46, v118
    v_exp_f32 v46, v46
    v_sub_f32 v47, v47, v118
    v_exp_f32 v47, v47
    s_waitcnt lgkmcnt(0)
    v_sub_f32 v16, v16, v117
    v_exp_f32 v16, v16
    v_sub_f32 v17, v17, v117
    v_exp_f32 v17, v17
    v_smfmac_f32_32x32x32_bf16 v[64:79], v[108:111], v[40:47], v112
    v_sub_f32 v18, v18, v117
    v_exp_f32 v18, v18
    v_sub_f32 v19, v19, v117
    v_exp_f32 v19, v19
    v_sub_f32 v20, v20, v117
    v_exp_f32 v20, v20
    v_mfma_f32_32x32x16_bf16 v[32:47], v[88:91], v[84:87], 0
    v_sub_f32 v21, v21, v117
    v_exp_f32 v21, v21
    v_sub_f32 v22, v22, v117
    v_exp_f32 v22, v22
    v_sub_f32 v23, v23, v117
    v_exp_f32 v23, v23
    v_sub_f32 v24, v24, v117
    v_exp_f32 v24, v24
    v_sub_f32 v25, v25, v117
    v_exp_f32 v25, v25
    v_smfmac_f32_32x32x32_bf16 v[48:63], v[96:99], v[16:23], v112
    ds_read_b128 v[88:91], v113 offset:28672
    s_mov_b64 exec, s[72:73]
    ds_read_b128 v[104:107], v114 offset:26624
    ds_read_b128 v[108:111], v114 offset:27136
    s_mov_b64 exec, -1
    s_add_u32 m0, s75, 2048
    s_add_u32 s71, s74, 88064
    buffer_load_dwordx4 v115, s[44:47], s71 offen  lds
    s_add_u32 m0, s75, 3072
    s_add_u32 s71, s74, 132096
    buffer_load_dwordx4 v115, s[44:47], s71 offen  lds
    v_sub_f32 v26, v26, v117
    v_exp_f32 v26, v26
    v_sub_f32 v27, v27, v117
    v_exp_f32 v27, v27
    v_sub_f32 v28, v28, v117
    v_exp_f32 v28, v28
    v_sub_f32 v29, v29, v117
    v_exp_f32 v29, v29
    v_sub_f32 v30, v30, v117
    v_exp_f32 v30, v30
    v_sub_f32 v31, v31, v117
    v_exp_f32 v31, v31
    v_sub_f32 v32, v32, v118
    v_exp_f32 v32, v32
    v_sub_f32 v33, v33, v118
    v_exp_f32 v33, v33
    v_smfmac_f32_32x32x32_bf16 v[48:63], v[100:103], v[24:31], v112
    v_sub_f32 v34, v34, v118
    v_exp_f32 v34, v34
    v_sub_f32 v35, v35, v118
    v_exp_f32 v35, v35
    v_sub_f32 v36, v36, v118
    v_exp_f32 v36, v36
    v_mfma_f32_32x32x16_bf16 v[16:31], v[92:95], v[80:83], 0
    v_sub_f32 v37, v37, v118
    v_exp_f32 v37, v37
    v_sub_f32 v38, v38, v118
    v_exp_f32 v38, v38
    v_sub_f32 v39, v39, v118
    v_exp_f32 v39, v39
    v_sub_f32 v40, v40, v118
    v_exp_f32 v40, v40
    v_sub_f32 v41, v41, v118
    v_exp_f32 v41, v41
    v_smfmac_f32_32x32x32_bf16 v[64:79], v[96:99], v[32:39], v112
    v_sub_f32 v42, v42, v118
    v_exp_f32 v42, v42
    v_sub_f32 v43, v43, v118
    v_exp_f32 v43, v43
    v_sub_f32 v44, v44, v118
    v_exp_f32 v44, v44
    v_sub_f32 v45, v45, v118
    v_exp_f32 v45, v45
    v_sub_f32 v46, v46, v118
    v_exp_f32 v46, v46
    v_sub_f32 v47, v47, v118
    v_exp_f32 v47, v47
    s_waitcnt lgkmcnt(0)
    v_sub_f32 v16, v16, v117
    v_exp_f32 v16, v16
    v_sub_f32 v17, v17, v117
    v_exp_f32 v17, v17
    v_smfmac_f32_32x32x32_bf16 v[64:79], v[100:103], v[40:47], v112
    v_sub_f32 v18, v18, v117
    v_exp_f32 v18, v18
    v_sub_f32 v19, v19, v117
    v_exp_f32 v19, v19
    v_sub_f32 v20, v20, v117
    v_exp_f32 v20, v20
    v_mfma_f32_32x32x16_bf16 v[32:47], v[92:95], v[84:87], 0
    v_sub_f32 v21, v21, v117
    v_exp_f32 v21, v21
    v_sub_f32 v22, v22, v117
    v_exp_f32 v22, v22
    v_sub_f32 v23, v23, v117
    v_exp_f32 v23, v23
    v_sub_f32 v24, v24, v117
    v_exp_f32 v24, v24
    v_sub_f32 v25, v25, v117
    v_exp_f32 v25, v25
    v_smfmac_f32_32x32x32_bf16 v[48:63], v[104:107], v[16:23], v112
    ds_read_b128 v[92:95], v113 offset:30720
    s_mov_b64 exec, s[72:73]
    ds_read_b128 v[96:99], v114 offset:28672
    ds_read_b128 v[100:103], v114 offset:29184
    s_mov_b64 exec, -1
    s_lshr_b32 s64, s2, 3
    s_lshl_b32 s65, s50, 5
    s_add_u32 s64, s64, s65
    s_lshl_b32 s64, s64, 13
    buffer_load_dword v2, v119, s[84:87], s64 offen
    v_sub_f32 v26, v26, v117
    v_exp_f32 v26, v26
    v_sub_f32 v27, v27, v117
    v_exp_f32 v27, v27
    v_sub_f32 v28, v28, v117
    v_exp_f32 v28, v28
    v_sub_f32 v29, v29, v117
    v_exp_f32 v29, v29
    v_sub_f32 v30, v30, v117
    v_exp_f32 v30, v30
    v_sub_f32 v31, v31, v117
    v_exp_f32 v31, v31
    v_sub_f32 v32, v32, v118
    v_exp_f32 v32, v32
    v_sub_f32 v33, v33, v118
    v_exp_f32 v33, v33
    v_smfmac_f32_32x32x32_bf16 v[48:63], v[108:111], v[24:31], v112
    v_sub_f32 v34, v34, v118
    v_exp_f32 v34, v34
    v_sub_f32 v35, v35, v118
    v_exp_f32 v35, v35
    v_sub_f32 v36, v36, v118
    v_exp_f32 v36, v36
    v_mfma_f32_32x32x16_bf16 v[16:31], v[88:91], v[80:83], 0
    v_sub_f32 v37, v37, v118
    v_exp_f32 v37, v37
    v_sub_f32 v38, v38, v118
    v_exp_f32 v38, v38
    v_sub_f32 v39, v39, v118
    v_exp_f32 v39, v39
    v_sub_f32 v40, v40, v118
    v_exp_f32 v40, v40
    v_sub_f32 v41, v41, v118
    v_exp_f32 v41, v41
    v_smfmac_f32_32x32x32_bf16 v[64:79], v[104:107], v[32:39], v112
    s_waitcnt vmcnt(3)
    ds_read_b64_tr_b16 a[0:1], v116 offset:0
    ds_read_b64_tr_b16 a[2:3], v116 offset:512
    ds_read_b64_tr_b16 a[4:5], v116 offset:1024
    ds_read_b64_tr_b16 a[6:7], v116 offset:1536
    s_cmp_lg_u32 s50, 7
    s_cbranch_scc1 L_sequential_preLN__grouped_kv_mqa__dense_activation_gelu__prompt_kernel_noat_95
    s_getreg_b32 s64, hwreg(HW_REG_XCC_ID, 0, 4)
    s_lshl_b32 s64, 1, s64
    s_add_u32 s65, s52, 16
    s_lshl_b32 s65, 1, s65
    s_or_b32 s64, s64, s65
    s_lshl_b32 s65, s51, 2
    v_mov_b32 v14, s65
    v_mov_b32 v15, s64
    s_mov_b64 exec, 1
    global_atomic_or v14, v15, s[26:27] offset:4 sc1
    s_mov_b64 exec, -1
L_sequential_preLN__grouped_kv_mqa__dense_activation_gelu__prompt_kernel_noat_95:
    v_sub_f32 v42, v42, v118
    v_exp_f32 v42, v42
    v_sub_f32 v43, v43, v118
    v_exp_f32 v43, v43
    v_sub_f32 v44, v44, v118
    v_exp_f32 v44, v44
    v_sub_f32 v45, v45, v118
    v_exp_f32 v45, v45
    v_sub_f32 v46, v46, v118
    v_exp_f32 v46, v46
    v_sub_f32 v47, v47, v118
    v_exp_f32 v47, v47
    s_waitcnt lgkmcnt(0)
    s_add_u32 m0, s75, 0
    s_add_u32 s71, s74, 176128
    buffer_load_dwordx4 v115, s[44:47], s71 offen  lds
    s_add_u32 m0, s75, 1024
    s_add_u32 s71, s74, 220160
    buffer_load_dwordx4 v115, s[44:47], s71 offen  lds
    v_sub_f32 v16, v16, v117
    v_exp_f32 v16, v16
    v_sub_f32 v17, v17, v117
    v_exp_f32 v17, v17
    v_smfmac_f32_32x32x32_bf16 v[64:79], v[108:111], v[40:47], v112
    v_sub_f32 v18, v18, v117
    v_exp_f32 v18, v18
    v_sub_f32 v19, v19, v117
    v_exp_f32 v19, v19
    v_sub_f32 v20, v20, v117
    v_exp_f32 v20, v20
    v_mfma_f32_32x32x16_bf16 v[32:47], v[88:91], v[84:87], 0
    v_sub_f32 v21, v21, v117
    v_exp_f32 v21, v21
    v_sub_f32 v22, v22, v117
    v_exp_f32 v22, v22
    v_sub_f32 v23, v23, v117
    v_exp_f32 v23, v23
    v_sub_f32 v24, v24, v117
    v_exp_f32 v24, v24
    v_sub_f32 v25, v25, v117
    v_exp_f32 v25, v25
    v_smfmac_f32_32x32x32_bf16 v[48:63], v[96:99], v[16:23], v112
    ds_read_b128 v[88:91], v113 offset:32768
    s_mov_b64 exec, s[72:73]
    ds_read_b128 v[104:107], v114 offset:30720
    ds_read_b128 v[108:111], v114 offset:31232
    s_mov_b64 exec, -1
    v_sub_f32 v26, v26, v117
    v_exp_f32 v26, v26
    v_sub_f32 v27, v27, v117
    v_exp_f32 v27, v27
    v_sub_f32 v28, v28, v117
    v_exp_f32 v28, v28
    v_sub_f32 v29, v29, v117
    v_exp_f32 v29, v29
    v_sub_f32 v30, v30, v117
    v_exp_f32 v30, v30
    v_sub_f32 v31, v31, v117
    v_exp_f32 v31, v31
    v_sub_f32 v32, v32, v118
    v_exp_f32 v32, v32
    v_sub_f32 v33, v33, v118
    v_exp_f32 v33, v33
    v_smfmac_f32_32x32x32_bf16 v[48:63], v[100:103], v[24:31], v112
    v_sub_f32 v34, v34, v118
    v_exp_f32 v34, v34
    v_sub_f32 v35, v35, v118
    v_exp_f32 v35, v35
    v_sub_f32 v36, v36, v118
    v_exp_f32 v36, v36
    v_mfma_f32_32x32x16_bf16 v[16:31], v[92:95], v[80:83], 0
    v_sub_f32 v37, v37, v118
    v_exp_f32 v37, v37
    v_sub_f32 v38, v38, v118
    v_exp_f32 v38, v38
    v_sub_f32 v39, v39, v118
    v_exp_f32 v39, v39
    v_sub_f32 v40, v40, v118
    v_exp_f32 v40, v40
    v_sub_f32 v41, v41, v118
    v_exp_f32 v41, v41
    v_smfmac_f32_32x32x32_bf16 v[64:79], v[96:99], v[32:39], v112
    s_waitcnt vmcnt(3)
    ds_read_b64_tr_b16 a[8:9], v116 offset:2048
    ds_read_b64_tr_b16 a[10:11], v116 offset:2560
    ds_read_b64_tr_b16 a[12:13], v116 offset:3072
    ds_read_b64_tr_b16 a[14:15], v116 offset:3584
    v_sub_f32 v42, v42, v118
    v_exp_f32 v42, v42
    v_sub_f32 v43, v43, v118
    v_exp_f32 v43, v43
    v_sub_f32 v44, v44, v118
    v_exp_f32 v44, v44
    v_sub_f32 v45, v45, v118
    v_exp_f32 v45, v45
    v_sub_f32 v46, v46, v118
    v_exp_f32 v46, v46
    v_sub_f32 v47, v47, v118
    v_exp_f32 v47, v47
    s_waitcnt lgkmcnt(0)
    s_add_u32 m0, s75, 2048
    s_add_u32 s71, s74, 264192
    buffer_load_dwordx4 v115, s[44:47], s71 offen  lds
    s_add_u32 m0, s75, 3072
    s_add_u32 s71, s74, 308224
    buffer_load_dwordx4 v115, s[44:47], s71 offen  lds
    v_sub_f32 v16, v16, v117
    v_exp_f32 v16, v16
    v_sub_f32 v17, v17, v117
    v_exp_f32 v17, v17
    v_smfmac_f32_32x32x32_bf16 v[64:79], v[100:103], v[40:47], v112
    v_sub_f32 v18, v18, v117
    v_exp_f32 v18, v18
    v_sub_f32 v19, v19, v117
    v_exp_f32 v19, v19
    v_sub_f32 v20, v20, v117
    v_exp_f32 v20, v20
    v_mfma_f32_32x32x16_bf16 v[32:47], v[92:95], v[84:87], 0
    v_sub_f32 v21, v21, v117
    v_exp_f32 v21, v21
    v_sub_f32 v22, v22, v117
    v_exp_f32 v22, v22
    v_sub_f32 v23, v23, v117
    v_exp_f32 v23, v23
    v_sub_f32 v24, v24, v117
    v_exp_f32 v24, v24
    v_sub_f32 v25, v25, v117
    v_exp_f32 v25, v25
    v_smfmac_f32_32x32x32_bf16 v[48:63], v[104:107], v[16:23], v112
    ds_read_b128 v[92:95], v113 offset:34816
    s_mov_b64 exec, s[72:73]
    ds_read_b128 v[96:99], v114 offset:32768
    ds_read_b128 v[100:103], v114 offset:33280
    s_mov_b64 exec, -1
    v_sub_f32 v26, v26, v117
    v_exp_f32 v26, v26
    v_sub_f32 v27, v27, v117
    v_exp_f32 v27, v27
    v_sub_f32 v28, v28, v117
    v_exp_f32 v28, v28
    v_sub_f32 v29, v29, v117
    v_exp_f32 v29, v29
    v_sub_f32 v30, v30, v117
    v_exp_f32 v30, v30
    v_sub_f32 v31, v31, v117
    v_exp_f32 v31, v31
    v_sub_f32 v32, v32, v118
    v_exp_f32 v32, v32
    v_sub_f32 v33, v33, v118
    v_exp_f32 v33, v33
    v_smfmac_f32_32x32x32_bf16 v[48:63], v[108:111], v[24:31], v112
    v_sub_f32 v34, v34, v118
    v_exp_f32 v34, v34
    v_sub_f32 v35, v35, v118
    v_exp_f32 v35, v35
    v_sub_f32 v36, v36, v118
    v_exp_f32 v36, v36
    v_mfma_f32_32x32x16_bf16 v[16:31], v[88:91], v[80:83], 0
    v_sub_f32 v37, v37, v118
    v_exp_f32 v37, v37
    v_sub_f32 v38, v38, v118
    v_exp_f32 v38, v38
    v_sub_f32 v39, v39, v118
    v_exp_f32 v39, v39
    v_sub_f32 v40, v40, v118
    v_exp_f32 v40, v40
    v_sub_f32 v41, v41, v118
    v_exp_f32 v41, v41
    v_smfmac_f32_32x32x32_bf16 v[64:79], v[104:107], v[32:39], v112
    s_waitcnt vmcnt(2)
    ds_read_b64_tr_b16 a[16:17], v116 offset:0
    ds_read_b64_tr_b16 a[18:19], v116 offset:512
    ds_read_b64_tr_b16 a[20:21], v116 offset:1024
    ds_read_b64_tr_b16 a[22:23], v116 offset:1536
    v_sub_f32 v42, v42, v118
    v_exp_f32 v42, v42
    v_sub_f32 v43, v43, v118
    v_exp_f32 v43, v43
    v_sub_f32 v44, v44, v118
    v_exp_f32 v44, v44
    v_sub_f32 v45, v45, v118
    v_exp_f32 v45, v45
    v_sub_f32 v46, v46, v118
    v_exp_f32 v46, v46
    v_sub_f32 v47, v47, v118
    v_exp_f32 v47, v47
    s_waitcnt lgkmcnt(0)
    s_add_u32 m0, s75, 0
    s_add_u32 s71, s74, 352256
    buffer_load_dwordx4 v115, s[44:47], s71 offen  lds
    s_add_u32 m0, s75, 1024
    s_add_u32 s71, s74, 396288
    buffer_load_dwordx4 v115, s[44:47], s71 offen  lds
    v_sub_f32 v16, v16, v117
    v_exp_f32 v16, v16
    v_sub_f32 v17, v17, v117
    v_exp_f32 v17, v17
    v_smfmac_f32_32x32x32_bf16 v[64:79], v[108:111], v[40:47], v112
    v_sub_f32 v18, v18, v117
    v_exp_f32 v18, v18
    v_sub_f32 v19, v19, v117
    v_exp_f32 v19, v19
    v_sub_f32 v20, v20, v117
    v_exp_f32 v20, v20
    v_mfma_f32_32x32x16_bf16 v[32:47], v[88:91], v[84:87], 0
    v_sub_f32 v21, v21, v117
    v_exp_f32 v21, v21
    v_sub_f32 v22, v22, v117
    v_exp_f32 v22, v22
    v_sub_f32 v23, v23, v117
    v_exp_f32 v23, v23
    v_sub_f32 v24, v24, v117
    v_exp_f32 v24, v24
    v_sub_f32 v25, v25, v117
    v_exp_f32 v25, v25
    v_smfmac_f32_32x32x32_bf16 v[48:63], v[96:99], v[16:23], v112
    ds_read_b128 v[88:91], v113 offset:36864
    s_mov_b64 exec, s[72:73]
    ds_read_b128 v[104:107], v114 offset:34816
    ds_read_b128 v[108:111], v114 offset:35328
    s_mov_b64 exec, -1
    v_sub_f32 v26, v26, v117
    v_exp_f32 v26, v26
    v_sub_f32 v27, v27, v117
    v_exp_f32 v27, v27
    v_sub_f32 v28, v28, v117
    v_exp_f32 v28, v28
    v_sub_f32 v29, v29, v117
    v_exp_f32 v29, v29
    v_sub_f32 v30, v30, v117
    v_exp_f32 v30, v30
    v_sub_f32 v31, v31, v117
    v_exp_f32 v31, v31
    v_sub_f32 v32, v32, v118
    v_exp_f32 v32, v32
    v_sub_f32 v33, v33, v118
    v_exp_f32 v33, v33
    v_smfmac_f32_32x32x32_bf16 v[48:63], v[100:103], v[24:31], v112
    v_sub_f32 v34, v34, v118
    v_exp_f32 v34, v34
    v_sub_f32 v35, v35, v118
    v_exp_f32 v35, v35
    v_sub_f32 v36, v36, v118
    v_exp_f32 v36, v36
    v_mfma_f32_32x32x16_bf16 v[16:31], v[92:95], v[80:83], 0
    v_sub_f32 v37, v37, v118
    v_exp_f32 v37, v37
    v_sub_f32 v38, v38, v118
    v_exp_f32 v38, v38
    v_sub_f32 v39, v39, v118
    v_exp_f32 v39, v39
    v_sub_f32 v40, v40, v118
    v_exp_f32 v40, v40
    v_sub_f32 v41, v41, v118
    v_exp_f32 v41, v41
    v_smfmac_f32_32x32x32_bf16 v[64:79], v[96:99], v[32:39], v112
    s_waitcnt vmcnt(2)
    ds_read_b64_tr_b16 a[24:25], v116 offset:2048
    ds_read_b64_tr_b16 a[26:27], v116 offset:2560
    ds_read_b64_tr_b16 a[28:29], v116 offset:3072
    ds_read_b64_tr_b16 a[30:31], v116 offset:3584
    v_sub_f32 v42, v42, v118
    v_exp_f32 v42, v42
    v_sub_f32 v43, v43, v118
    v_exp_f32 v43, v43
    v_sub_f32 v44, v44, v118
    v_exp_f32 v44, v44
    v_sub_f32 v45, v45, v118
    v_exp_f32 v45, v45
    v_sub_f32 v46, v46, v118
    v_exp_f32 v46, v46
    v_sub_f32 v47, v47, v118
    v_exp_f32 v47, v47
    s_waitcnt lgkmcnt(0)
    s_add_u32 m0, s75, 2048
    s_add_u32 s71, s74, 440320
    buffer_load_dwordx4 v115, s[44:47], s71 offen  lds
    s_add_u32 m0, s75, 3072
    s_add_u32 s71, s74, 484352
    buffer_load_dwordx4 v115, s[44:47], s71 offen  lds
    v_sub_f32 v16, v16, v117
    v_exp_f32 v16, v16
    v_sub_f32 v17, v17, v117
    v_exp_f32 v17, v17
    v_smfmac_f32_32x32x32_bf16 v[64:79], v[100:103], v[40:47], v112
    v_sub_f32 v18, v18, v117
    v_exp_f32 v18, v18
    v_sub_f32 v19, v19, v117
    v_exp_f32 v19, v19
    v_sub_f32 v20, v20, v117
    v_exp_f32 v20, v20
    v_mfma_f32_32x32x16_bf16 v[32:47], v[92:95], v[84:87], 0
    v_sub_f32 v21, v21, v117
    v_exp_f32 v21, v21
    v_sub_f32 v22, v22, v117
    v_exp_f32 v22, v22
    v_sub_f32 v23, v23, v117
    v_exp_f32 v23, v23
    v_sub_f32 v24, v24, v117
    v_exp_f32 v24, v24
    v_sub_f32 v25, v25, v117
    v_exp_f32 v25, v25
    v_smfmac_f32_32x32x32_bf16 v[48:63], v[104:107], v[16:23], v112
    ds_read_b128 v[92:95], v113 offset:38912
    s_mov_b64 exec, s[72:73]
    ds_read_b128 v[96:99], v114 offset:36864
    ds_read_b128 v[100:103], v114 offset:37376
    s_mov_b64 exec, -1
    v_sub_f32 v26, v26, v117
    v_exp_f32 v26, v26
    v_sub_f32 v27, v27, v117
    v_exp_f32 v27, v27
    v_sub_f32 v28, v28, v117
    v_exp_f32 v28, v28
    v_sub_f32 v29, v29, v117
    v_exp_f32 v29, v29
    v_sub_f32 v30, v30, v117
    v_exp_f32 v30, v30
    v_sub_f32 v31, v31, v117
    v_exp_f32 v31, v31
    v_sub_f32 v32, v32, v118
    v_exp_f32 v32, v32
    v_sub_f32 v33, v33, v118
    v_exp_f32 v33, v33
    v_smfmac_f32_32x32x32_bf16 v[48:63], v[108:111], v[24:31], v112
    v_sub_f32 v34, v34, v118
    v_exp_f32 v34, v34
    v_sub_f32 v35, v35, v118
    v_exp_f32 v35, v35
    v_sub_f32 v36, v36, v118
    v_exp_f32 v36, v36
    v_mfma_f32_32x32x16_bf16 v[16:31], v[88:91], v[80:83], 0
    v_sub_f32 v37, v37, v118
    v_exp_f32 v37, v37
    v_sub_f32 v38, v38, v118
    v_exp_f32 v38, v38
    v_sub_f32 v39, v39, v118
    v_exp_f32 v39, v39
    v_sub_f32 v40, v40, v118
    v_exp_f32 v40, v40
    v_sub_f32 v41, v41, v118
    v_exp_f32 v41, v41
    v_smfmac_f32_32x32x32_bf16 v[64:79], v[104:107], v[32:39], v112
    s_waitcnt vmcnt(2)
    ds_read_b64_tr_b16 a[32:33], v116 offset:0
    ds_read_b64_tr_b16 a[34:35], v116 offset:512
    ds_read_b64_tr_b16 a[36:37], v116 offset:1024
    ds_read_b64_tr_b16 a[38:39], v116 offset:1536
    v_sub_f32 v42, v42, v118
    v_exp_f32 v42, v42
    v_sub_f32 v43, v43, v118
    v_exp_f32 v43, v43
    v_sub_f32 v44, v44, v118
    v_exp_f32 v44, v44
    v_sub_f32 v45, v45, v118
    v_exp_f32 v45, v45
    v_sub_f32 v46, v46, v118
    v_exp_f32 v46, v46
    v_sub_f32 v47, v47, v118
    v_exp_f32 v47, v47
    s_waitcnt lgkmcnt(0)
    s_add_u32 m0, s75, 0
    s_add_u32 s71, s74, 528384
    buffer_load_dwordx4 v115, s[44:47], s71 offen  lds
    s_add_u32 m0, s75, 1024
    s_add_u32 s71, s74, 572416
    buffer_load_dwordx4 v115, s[44:47], s71 offen  lds
    v_sub_f32 v16, v16, v117
    v_exp_f32 v16, v16
    v_sub_f32 v17, v17, v117
    v_exp_f32 v17, v17
    v_smfmac_f32_32x32x32_bf16 v[64:79], v[108:111], v[40:47], v112
    v_sub_f32 v18, v18, v117
    v_exp_f32 v18, v18
    v_sub_f32 v19, v19, v117
    v_exp_f32 v19, v19
    v_sub_f32 v20, v20, v117
    v_exp_f32 v20, v20
    v_mfma_f32_32x32x16_bf16 v[32:47], v[88:91], v[84:87], 0
    v_sub_f32 v21, v21, v117
    v_exp_f32 v21, v21
    v_sub_f32 v22, v22, v117
    v_exp_f32 v22, v22
    v_sub_f32 v23, v23, v117
    v_exp_f32 v23, v23
    v_sub_f32 v24, v24, v117
    v_exp_f32 v24, v24
    v_sub_f32 v25, v25, v117
    v_exp_f32 v25, v25
    v_smfmac_f32_32x32x32_bf16 v[48:63], v[96:99], v[16:23], v112
    ds_read_b128 v[88:91], v113 offset:40960
    s_mov_b64 exec, s[72:73]
    ds_read_b128 v[104:107], v114 offset:38912
    ds_read_b128 v[108:111], v114 offset:39424
    s_mov_b64 exec, -1
    s_lshl_b32 s64, s50, 2
    v_mov_b32 v12, s64
    v_mov_b32 v13, 1
    ds_write_b32 v12, v13
    v_sub_f32 v26, v26, v117
    v_exp_f32 v26, v26
    v_sub_f32 v27, v27, v117
    v_exp_f32 v27, v27
    v_sub_f32 v28, v28, v117
    v_exp_f32 v28, v28
    v_sub_f32 v29, v29, v117
    v_exp_f32 v29, v29
    v_sub_f32 v30, v30, v117
    v_exp_f32 v30, v30
    v_sub_f32 v31, v31, v117
    v_exp_f32 v31, v31
    v_sub_f32 v32, v32, v118
    v_exp_f32 v32, v32
    v_sub_f32 v33, v33, v118
    v_exp_f32 v33, v33
    v_smfmac_f32_32x32x32_bf16 v[48:63], v[100:103], v[24:31], v112
    v_sub_f32 v34, v34, v118
    v_exp_f32 v34, v34
    v_sub_f32 v35, v35, v118
    v_exp_f32 v35, v35
    v_sub_f32 v36, v36, v118
    v_exp_f32 v36, v36
    v_mfma_f32_32x32x16_bf16 v[16:31], v[92:95], v[80:83], 0
    v_sub_f32 v37, v37, v118
    v_exp_f32 v37, v37
    v_sub_f32 v38, v38, v118
    v_exp_f32 v38, v38
    v_sub_f32 v39, v39, v118
    v_exp_f32 v39, v39
    v_sub_f32 v40, v40, v118
    v_exp_f32 v40, v40
    v_sub_f32 v41, v41, v118
    v_exp_f32 v41, v41
    v_smfmac_f32_32x32x32_bf16 v[64:79], v[96:99], v[32:39], v112
    s_waitcnt vmcnt(2)
    ds_read_b64_tr_b16 a[40:41], v116 offset:2048
    ds_read_b64_tr_b16 a[42:43], v116 offset:2560
    ds_read_b64_tr_b16 a[44:45], v116 offset:3072
    ds_read_b64_tr_b16 a[46:47], v116 offset:3584
    v_sub_f32 v42, v42, v118
    v_exp_f32 v42, v42
    v_sub_f32 v43, v43, v118
    v_exp_f32 v43, v43
    v_sub_f32 v44, v44, v118
    v_exp_f32 v44, v44
    v_sub_f32 v45, v45, v118
    v_exp_f32 v45, v45
    v_sub_f32 v46, v46, v118
    v_exp_f32 v46, v46
    v_sub_f32 v47, v47, v118
    v_exp_f32 v47, v47
    s_waitcnt lgkmcnt(0)
    s_add_u32 m0, s75, 2048
    s_add_u32 s71, s74, 616448
    buffer_load_dwordx4 v115, s[44:47], s71 offen  lds
    s_add_u32 m0, s75, 3072
    s_add_u32 s71, s74, 660480
    buffer_load_dwordx4 v115, s[44:47], s71 offen  lds
    v_sub_f32 v16, v16, v117
    v_exp_f32 v16, v16
    v_sub_f32 v17, v17, v117
    v_exp_f32 v17, v17
    v_smfmac_f32_32x32x32_bf16 v[64:79], v[100:103], v[40:47], v112
    v_sub_f32 v18, v18, v117
    v_exp_f32 v18, v18
    v_sub_f32 v19, v19, v117
    v_exp_f32 v19, v19
    v_sub_f32 v20, v20, v117
    v_exp_f32 v20, v20
    v_mfma_f32_32x32x16_bf16 v[32:47], v[92:95], v[84:87], 0
    v_sub_f32 v21, v21, v117
    v_exp_f32 v21, v21
    v_sub_f32 v22, v22, v117
    v_exp_f32 v22, v22
    v_sub_f32 v23, v23, v117
    v_exp_f32 v23, v23
    v_sub_f32 v24, v24, v117
    v_exp_f32 v24, v24
    v_sub_f32 v25, v25, v117
    v_exp_f32 v25, v25
    v_smfmac_f32_32x32x32_bf16 v[48:63], v[104:107], v[16:23], v112
    ds_read_b128 v[92:95], v113 offset:43008
    s_mov_b64 exec, s[72:73]
    ds_read_b128 v[96:99], v114 offset:40960
    ds_read_b128 v[100:103], v114 offset:41472
    s_mov_b64 exec, -1
    s_lshr_b32 s64, s2, 3
    s_lshl_b32 s65, s50, 5
    s_xor_b32 s65, s65, 0xe0
    s_add_u32 s64, s64, s65
    s_lshl_b32 s64, s64, 13
    buffer_load_dword v2, v119, s[80:83], s64 offen
    v_sub_f32 v26, v26, v117
    v_exp_f32 v26, v26
    v_sub_f32 v27, v27, v117
    v_exp_f32 v27, v27
    v_sub_f32 v28, v28, v117
    v_exp_f32 v28, v28
    v_sub_f32 v29, v29, v117
    v_exp_f32 v29, v29
    v_sub_f32 v30, v30, v117
    v_exp_f32 v30, v30
    v_sub_f32 v31, v31, v117
    v_exp_f32 v31, v31
    v_sub_f32 v32, v32, v118
    v_exp_f32 v32, v32
    v_sub_f32 v33, v33, v118
    v_exp_f32 v33, v33
    v_smfmac_f32_32x32x32_bf16 v[48:63], v[108:111], v[24:31], v112
    v_sub_f32 v34, v34, v118
    v_exp_f32 v34, v34
    v_sub_f32 v35, v35, v118
    v_exp_f32 v35, v35
    v_sub_f32 v36, v36, v118
    v_exp_f32 v36, v36
    v_mfma_f32_32x32x16_bf16 v[16:31], v[88:91], v[80:83], 0
    v_sub_f32 v37, v37, v118
    v_exp_f32 v37, v37
    v_sub_f32 v38, v38, v118
    v_exp_f32 v38, v38
    v_sub_f32 v39, v39, v118
    v_exp_f32 v39, v39
    v_sub_f32 v40, v40, v118
    v_exp_f32 v40, v40
    v_sub_f32 v41, v41, v118
    v_exp_f32 v41, v41
    v_smfmac_f32_32x32x32_bf16 v[64:79], v[104:107], v[32:39], v112
    s_waitcnt vmcnt(3)
    ds_read_b64_tr_b16 a[48:49], v116 offset:0
    ds_read_b64_tr_b16 a[50:51], v116 offset:512
    ds_read_b64_tr_b16 a[52:53], v116 offset:1024
    ds_read_b64_tr_b16 a[54:55], v116 offset:1536
    v_sub_f32 v42, v42, v118
    v_exp_f32 v42, v42
    v_sub_f32 v43, v43, v118
    v_exp_f32 v43, v43
    v_sub_f32 v44, v44, v118
    v_exp_f32 v44, v44
    v_sub_f32 v45, v45, v118
    v_exp_f32 v45, v45
    v_sub_f32 v46, v46, v118
    v_exp_f32 v46, v46
    v_sub_f32 v47, v47, v118
    v_exp_f32 v47, v47
    s_waitcnt lgkmcnt(0)
    s_add_u32 m0, s75, 0
    s_add_u32 s71, s74, 704512
    buffer_load_dwordx4 v115, s[44:47], s71 offen  lds
    s_add_u32 m0, s75, 1024
    s_add_u32 s71, s74, 748544
    buffer_load_dwordx4 v115, s[44:47], s71 offen  lds
    v_sub_f32 v16, v16, v117
    v_exp_f32 v16, v16
    v_sub_f32 v17, v17, v117
    v_exp_f32 v17, v17
    v_smfmac_f32_32x32x32_bf16 v[64:79], v[108:111], v[40:47], v112
    v_sub_f32 v18, v18, v117
    v_exp_f32 v18, v18
    v_sub_f32 v19, v19, v117
    v_exp_f32 v19, v19
    v_sub_f32 v20, v20, v117
    v_exp_f32 v20, v20
    v_mfma_f32_32x32x16_bf16 v[32:47], v[88:91], v[84:87], 0
    v_sub_f32 v21, v21, v117
    v_exp_f32 v21, v21
    v_sub_f32 v22, v22, v117
    v_exp_f32 v22, v22
    v_sub_f32 v23, v23, v117
    v_exp_f32 v23, v23
    v_sub_f32 v24, v24, v117
    v_exp_f32 v24, v24
    v_sub_f32 v25, v25, v117
    v_exp_f32 v25, v25
    v_smfmac_f32_32x32x32_bf16 v[48:63], v[96:99], v[16:23], v112
    ds_read_b128 v[88:91], v113 offset:45056
    s_mov_b64 exec, s[72:73]
    ds_read_b128 v[104:107], v114 offset:43008
    ds_read_b128 v[108:111], v114 offset:43520
    s_mov_b64 exec, -1
    v_sub_f32 v26, v26, v117
    v_exp_f32 v26, v26
    v_sub_f32 v27, v27, v117
    v_exp_f32 v27, v27
    v_sub_f32 v28, v28, v117
    v_exp_f32 v28, v28
    v_sub_f32 v29, v29, v117
    v_exp_f32 v29, v29
    v_sub_f32 v30, v30, v117
    v_exp_f32 v30, v30
    v_sub_f32 v31, v31, v117
    v_exp_f32 v31, v31
    v_sub_f32 v32, v32, v118
    v_exp_f32 v32, v32
    v_sub_f32 v33, v33, v118
    v_exp_f32 v33, v33
    v_smfmac_f32_32x32x32_bf16 v[48:63], v[100:103], v[24:31], v112
    v_sub_f32 v34, v34, v118
    v_exp_f32 v34, v34
    v_sub_f32 v35, v35, v118
    v_exp_f32 v35, v35
    v_sub_f32 v36, v36, v118
    v_exp_f32 v36, v36
    v_mfma_f32_32x32x16_bf16 v[16:31], v[92:95], v[80:83], 0
    v_sub_f32 v37, v37, v118
    v_exp_f32 v37, v37
    v_sub_f32 v38, v38, v118
    v_exp_f32 v38, v38
    v_sub_f32 v39, v39, v118
    v_exp_f32 v39, v39
    v_sub_f32 v40, v40, v118
    v_exp_f32 v40, v40
    v_sub_f32 v41, v41, v118
    v_exp_f32 v41, v41
    v_smfmac_f32_32x32x32_bf16 v[64:79], v[96:99], v[32:39], v112
    s_waitcnt vmcnt(3)
    ds_read_b64_tr_b16 a[56:57], v116 offset:2048
    ds_read_b64_tr_b16 a[58:59], v116 offset:2560
    ds_read_b64_tr_b16 a[60:61], v116 offset:3072
    ds_read_b64_tr_b16 a[62:63], v116 offset:3584
    v_sub_f32 v42, v42, v118
    v_exp_f32 v42, v42
    v_sub_f32 v43, v43, v118
    v_exp_f32 v43, v43
    v_sub_f32 v44, v44, v118
    v_exp_f32 v44, v44
    v_sub_f32 v45, v45, v118
    v_exp_f32 v45, v45
    v_sub_f32 v46, v46, v118
    v_exp_f32 v46, v46
    v_sub_f32 v47, v47, v118
    v_exp_f32 v47, v47
    s_waitcnt lgkmcnt(0)
    s_add_u32 m0, s75, 2048
    s_add_u32 s71, s74, 792576
    buffer_load_dwordx4 v115, s[44:47], s71 offen  lds
    s_add_u32 m0, s75, 3072
    s_add_u32 s71, s74, 836608
    buffer_load_dwordx4 v115, s[44:47], s71 offen  lds
    v_sub_f32 v16, v16, v117
    v_exp_f32 v16, v16
    v_sub_f32 v17, v17, v117
    v_exp_f32 v17, v17
    v_smfmac_f32_32x32x32_bf16 v[64:79], v[100:103], v[40:47], v112
    v_sub_f32 v18, v18, v117
    v_exp_f32 v18, v18
    v_sub_f32 v19, v19, v117
    v_exp_f32 v19, v19
    v_sub_f32 v20, v20, v117
    v_exp_f32 v20, v20
    v_mfma_f32_32x32x16_bf16 v[32:47], v[92:95], v[84:87], 0
    v_sub_f32 v21, v21, v117
    v_exp_f32 v21, v21
    v_sub_f32 v22, v22, v117
    v_exp_f32 v22, v22
    v_sub_f32 v23, v23, v117
    v_exp_f32 v23, v23
    v_sub_f32 v24, v24, v117
    v_exp_f32 v24, v24
    v_sub_f32 v25, v25, v117
    v_exp_f32 v25, v25
    v_smfmac_f32_32x32x32_bf16 v[48:63], v[104:107], v[16:23], v112
    ds_read_b128 v[92:95], v113 offset:47104
    s_mov_b64 exec, s[72:73]
    ds_read_b128 v[96:99], v114 offset:45056
    ds_read_b128 v[100:103], v114 offset:45568
    s_mov_b64 exec, -1
    v_sub_f32 v26, v26, v117
    v_exp_f32 v26, v26
    v_sub_f32 v27, v27, v117
    v_exp_f32 v27, v27
    v_sub_f32 v28, v28, v117
    v_exp_f32 v28, v28
    v_sub_f32 v29, v29, v117
    v_exp_f32 v29, v29
    v_sub_f32 v30, v30, v117
    v_exp_f32 v30, v30
    v_sub_f32 v31, v31, v117
    v_exp_f32 v31, v31
    v_sub_f32 v32, v32, v118
    v_exp_f32 v32, v32
    v_sub_f32 v33, v33, v118
    v_exp_f32 v33, v33
    v_smfmac_f32_32x32x32_bf16 v[48:63], v[108:111], v[24:31], v112
    v_sub_f32 v34, v34, v118
    v_exp_f32 v34, v34
    v_sub_f32 v35, v35, v118
    v_exp_f32 v35, v35
    v_sub_f32 v36, v36, v118
    v_exp_f32 v36, v36
    v_mfma_f32_32x32x16_bf16 v[16:31], v[88:91], v[80:83], 0
    v_sub_f32 v37, v37, v118
    v_exp_f32 v37, v37
    v_sub_f32 v38, v38, v118
    v_exp_f32 v38, v38
    v_sub_f32 v39, v39, v118
    v_exp_f32 v39, v39
    v_sub_f32 v40, v40, v118
    v_exp_f32 v40, v40
    v_sub_f32 v41, v41, v118
    v_exp_f32 v41, v41
    v_smfmac_f32_32x32x32_bf16 v[64:79], v[104:107], v[32:39], v112
    s_waitcnt vmcnt(2)
    ds_read_b64_tr_b16 a[64:65], v116 offset:0
    ds_read_b64_tr_b16 a[66:67], v116 offset:512
    ds_read_b64_tr_b16 a[68:69], v116 offset:1024
    ds_read_b64_tr_b16 a[70:71], v116 offset:1536
    v_sub_f32 v42, v42, v118
    v_exp_f32 v42, v42
    v_sub_f32 v43, v43, v118
    v_exp_f32 v43, v43
    v_sub_f32 v44, v44, v118
    v_exp_f32 v44, v44
    v_sub_f32 v45, v45, v118
    v_exp_f32 v45, v45
    v_sub_f32 v46, v46, v118
    v_exp_f32 v46, v46
    v_sub_f32 v47, v47, v118
    v_exp_f32 v47, v47
    s_setprio 2
    s_waitcnt lgkmcnt(0)
    s_add_u32 m0, s75, 0
    s_add_u32 s71, s74, 880640
    buffer_load_dwordx4 v115, s[44:47], s71 offen  lds
    s_add_u32 m0, s75, 1024
    s_add_u32 s71, s74, 924672
    buffer_load_dwordx4 v115, s[44:47], s71 offen  lds
    v_sub_f32 v16, v16, v117
    v_exp_f32 v16, v16
    v_sub_f32 v17, v17, v117
    v_exp_f32 v17, v17
    v_smfmac_f32_32x32x32_bf16 v[64:79], v[108:111], v[40:47], v112
    v_sub_f32 v18, v18, v117
    v_exp_f32 v18, v18
    v_sub_f32 v19, v19, v117
    v_exp_f32 v19, v19
    v_sub_f32 v20, v20, v117
    v_exp_f32 v20, v20
    v_mfma_f32_32x32x16_bf16 v[32:47], v[88:91], v[84:87], 0
    v_sub_f32 v21, v21, v117
    v_exp_f32 v21, v21
    v_sub_f32 v22, v22, v117
    v_exp_f32 v22, v22
    v_sub_f32 v23, v23, v117
    v_exp_f32 v23, v23
    v_sub_f32 v24, v24, v117
    v_exp_f32 v24, v24
    v_sub_f32 v25, v25, v117
    v_exp_f32 v25, v25
    v_smfmac_f32_32x32x32_bf16 v[48:63], v[96:99], v[16:23], v112
    ds_read_b128 v[88:91], v113 offset:49152
    s_mov_b64 exec, s[72:73]
    ds_read_b128 v[104:107], v114 offset:47104
    ds_read_b128 v[108:111], v114 offset:47616
    s_mov_b64 exec, -1
    v_sub_f32 v26, v26, v117
    v_exp_f32 v26, v26
    v_sub_f32 v27, v27, v117
    v_exp_f32 v27, v27
    v_sub_f32 v28, v28, v117
    v_exp_f32 v28, v28
    v_sub_f32 v29, v29, v117
    v_exp_f32 v29, v29
    v_sub_f32 v30, v30, v117
    v_exp_f32 v30, v30
    v_sub_f32 v31, v31, v117
    v_exp_f32 v31, v31
    v_sub_f32 v32, v32, v118
    v_exp_f32 v32, v32
    v_sub_f32 v33, v33, v118
    v_exp_f32 v33, v33
    v_smfmac_f32_32x32x32_bf16 v[48:63], v[100:103], v[24:31], v112
    v_sub_f32 v34, v34, v118
    v_exp_f32 v34, v34
    v_sub_f32 v35, v35, v118
    v_exp_f32 v35, v35
    v_sub_f32 v36, v36, v118
    v_exp_f32 v36, v36
    v_mfma_f32_32x32x16_bf16 v[16:31], v[92:95], v[80:83], 0
    v_sub_f32 v37, v37, v118
    v_exp_f32 v37, v37
    v_sub_f32 v38, v38, v118
    v_exp_f32 v38, v38
    v_sub_f32 v39, v39, v118
    v_exp_f32 v39, v39
    v_sub_f32 v40, v40, v118
    v_exp_f32 v40, v40
    v_sub_f32 v41, v41, v118
    v_exp_f32 v41, v41
    v_smfmac_f32_32x32x32_bf16 v[64:79], v[96:99], v[32:39], v112
    s_waitcnt vmcnt(2)
    ds_read_b64_tr_b16 a[72:73], v116 offset:2048
    ds_read_b64_tr_b16 a[74:75], v116 offset:2560
    ds_read_b64_tr_b16 a[76:77], v116 offset:3072
    ds_read_b64_tr_b16 a[78:79], v116 offset:3584
    v_sub_f32 v42, v42, v118
    v_exp_f32 v42, v42
    v_sub_f32 v43, v43, v118
    v_exp_f32 v43, v43
    v_sub_f32 v44, v44, v118
    v_exp_f32 v44, v44
    v_sub_f32 v45, v45, v118
    v_exp_f32 v45, v45
    v_sub_f32 v46, v46, v118
    v_exp_f32 v46, v46
    v_sub_f32 v47, v47, v118
    v_exp_f32 v47, v47
    s_waitcnt lgkmcnt(0)
    s_add_u32 m0, s75, 2048
    s_add_u32 s71, s74, 968704
    buffer_load_dwordx4 v115, s[44:47], s71 offen  lds
    s_add_u32 m0, s75, 3072
    s_add_u32 s71, s74, 1012736
    buffer_load_dwordx4 v115, s[44:47], s71 offen  lds
    v_sub_f32 v16, v16, v117
    v_exp_f32 v16, v16
    v_sub_f32 v17, v17, v117
    v_exp_f32 v17, v17
    v_smfmac_f32_32x32x32_bf16 v[64:79], v[100:103], v[40:47], v112
    v_sub_f32 v18, v18, v117
    v_exp_f32 v18, v18
    v_sub_f32 v19, v19, v117
    v_exp_f32 v19, v19
    v_sub_f32 v20, v20, v117
    v_exp_f32 v20, v20
    v_mfma_f32_32x32x16_bf16 v[32:47], v[92:95], v[84:87], 0
    v_sub_f32 v21, v21, v117
    v_exp_f32 v21, v21
    v_sub_f32 v22, v22, v117
    v_exp_f32 v22, v22
    v_sub_f32 v23, v23, v117
    v_exp_f32 v23, v23
    v_sub_f32 v24, v24, v117
    v_exp_f32 v24, v24
    v_sub_f32 v25, v25, v117
    v_exp_f32 v25, v25
    v_smfmac_f32_32x32x32_bf16 v[48:63], v[104:107], v[16:23], v112
    ds_read_b128 v[92:95], v113 offset:51200
    s_mov_b64 exec, s[72:73]
    ds_read_b128 v[96:99], v114 offset:49152
    ds_read_b128 v[100:103], v114 offset:49664
    s_mov_b64 exec, -1
    v_sub_f32 v26, v26, v117
    v_exp_f32 v26, v26
    v_sub_f32 v27, v27, v117
    v_exp_f32 v27, v27
    v_sub_f32 v28, v28, v117
    v_exp_f32 v28, v28
    v_sub_f32 v29, v29, v117
    v_exp_f32 v29, v29
    v_sub_f32 v30, v30, v117
    v_exp_f32 v30, v30
    v_sub_f32 v31, v31, v117
    v_exp_f32 v31, v31
    v_sub_f32 v32, v32, v118
    v_exp_f32 v32, v32
    v_sub_f32 v33, v33, v118
    v_exp_f32 v33, v33
    v_smfmac_f32_32x32x32_bf16 v[48:63], v[108:111], v[24:31], v112
    v_sub_f32 v34, v34, v118
    v_exp_f32 v34, v34
    v_sub_f32 v35, v35, v118
    v_exp_f32 v35, v35
    v_sub_f32 v36, v36, v118
    v_exp_f32 v36, v36
    v_mfma_f32_32x32x16_bf16 v[16:31], v[88:91], v[80:83], 0
    v_sub_f32 v37, v37, v118
    v_exp_f32 v37, v37
    v_sub_f32 v38, v38, v118
    v_exp_f32 v38, v38
    v_sub_f32 v39, v39, v118
    v_exp_f32 v39, v39
    v_sub_f32 v40, v40, v118
    v_exp_f32 v40, v40
    v_sub_f32 v41, v41, v118
    v_exp_f32 v41, v41
    v_smfmac_f32_32x32x32_bf16 v[64:79], v[104:107], v[32:39], v112
    s_waitcnt vmcnt(2)
    ds_read_b64_tr_b16 a[80:81], v116 offset:0
    ds_read_b64_tr_b16 a[82:83], v116 offset:512
    ds_read_b64_tr_b16 a[84:85], v116 offset:1024
    ds_read_b64_tr_b16 a[86:87], v116 offset:1536
    v_sub_f32 v42, v42, v118
    v_exp_f32 v42, v42
    v_sub_f32 v43, v43, v118
    v_exp_f32 v43, v43
    v_sub_f32 v44, v44, v118
    v_exp_f32 v44, v44
    v_sub_f32 v45, v45, v118
    v_exp_f32 v45, v45
    v_sub_f32 v46, v46, v118
    v_exp_f32 v46, v46
    v_sub_f32 v47, v47, v118
    v_exp_f32 v47, v47
    s_waitcnt lgkmcnt(0)
    s_add_u32 m0, s75, 0
    s_add_u32 s71, s74, 1056768
    buffer_load_dwordx4 v115, s[44:47], s71 offen  lds
    s_add_u32 m0, s75, 1024
    s_add_u32 s71, s74, 1100800
    buffer_load_dwordx4 v115, s[44:47], s71 offen  lds
    v_sub_f32 v16, v16, v117
    v_exp_f32 v16, v16
    v_sub_f32 v17, v17, v117
    v_exp_f32 v17, v17
    v_smfmac_f32_32x32x32_bf16 v[64:79], v[108:111], v[40:47], v112
    v_sub_f32 v18, v18, v117
    v_exp_f32 v18, v18
    v_sub_f32 v19, v19, v117
    v_exp_f32 v19, v19
    v_sub_f32 v20, v20, v117
    v_exp_f32 v20, v20
    v_mfma_f32_32x32x16_bf16 v[32:47], v[88:91], v[84:87], 0
    v_sub_f32 v21, v21, v117
    v_exp_f32 v21, v21
    v_sub_f32 v22, v22, v117
    v_exp_f32 v22, v22
    v_sub_f32 v23, v23, v117
    v_exp_f32 v23, v23
    v_sub_f32 v24, v24, v117
    v_exp_f32 v24, v24
    v_sub_f32 v25, v25, v117
    v_exp_f32 v25, v25
    v_smfmac_f32_32x32x32_bf16 v[48:63], v[96:99], v[16:23], v112
    ds_read_b128 v[88:91], v113 offset:53248
    s_mov_b64 exec, s[72:73]
    ds_read_b128 v[104:107], v114 offset:51200
    ds_read_b128 v[108:111], v114 offset:51712
    s_mov_b64 exec, -1
    v_sub_f32 v26, v26, v117
    v_exp_f32 v26, v26
    v_sub_f32 v27, v27, v117
    v_exp_f32 v27, v27
    v_sub_f32 v28, v28, v117
    v_exp_f32 v28, v28
    v_sub_f32 v29, v29, v117
    v_exp_f32 v29, v29
    v_sub_f32 v30, v30, v117
    v_exp_f32 v30, v30
    v_sub_f32 v31, v31, v117
    v_exp_f32 v31, v31
    v_sub_f32 v32, v32, v118
    v_exp_f32 v32, v32
    v_sub_f32 v33, v33, v118
    v_exp_f32 v33, v33
    v_smfmac_f32_32x32x32_bf16 v[48:63], v[100:103], v[24:31], v112
    v_sub_f32 v34, v34, v118
    v_exp_f32 v34, v34
    v_sub_f32 v35, v35, v118
    v_exp_f32 v35, v35
    v_sub_f32 v36, v36, v118
    v_exp_f32 v36, v36
    v_mfma_f32_32x32x16_bf16 v[16:31], v[92:95], v[80:83], 0
    v_sub_f32 v37, v37, v118
    v_exp_f32 v37, v37
    v_sub_f32 v38, v38, v118
    v_exp_f32 v38, v38
    v_sub_f32 v39, v39, v118
    v_exp_f32 v39, v39
    v_sub_f32 v40, v40, v118
    v_exp_f32 v40, v40
    v_sub_f32 v41, v41, v118
    v_exp_f32 v41, v41
    v_smfmac_f32_32x32x32_bf16 v[64:79], v[96:99], v[32:39], v112
    s_waitcnt vmcnt(2)
    ds_read_b64_tr_b16 a[88:89], v116 offset:2048
    ds_read_b64_tr_b16 a[90:91], v116 offset:2560
    ds_read_b64_tr_b16 a[92:93], v116 offset:3072
    ds_read_b64_tr_b16 a[94:95], v116 offset:3584
    v_sub_f32 v42, v42, v118
    v_exp_f32 v42, v42
    v_sub_f32 v43, v43, v118
    v_exp_f32 v43, v43
    v_sub_f32 v44, v44, v118
    v_exp_f32 v44, v44
    v_sub_f32 v45, v45, v118
    v_exp_f32 v45, v45
    v_sub_f32 v46, v46, v118
    v_exp_f32 v46, v46
    v_sub_f32 v47, v47, v118
    v_exp_f32 v47, v47
    s_waitcnt lgkmcnt(0)
    s_add_u32 m0, s75, 2048
    s_add_u32 s71, s74, 1144832
    buffer_load_dwordx4 v115, s[44:47], s71 offen  lds
    s_add_u32 m0, s75, 3072
    s_add_u32 s71, s74, 1188864
    buffer_load_dwordx4 v115, s[44:47], s71 offen  lds
    v_sub_f32 v16, v16, v117
    v_exp_f32 v16, v16
    v_sub_f32 v17, v17, v117
    v_exp_f32 v17, v17
    v_smfmac_f32_32x32x32_bf16 v[64:79], v[100:103], v[40:47], v112
    v_sub_f32 v18, v18, v117
    v_exp_f32 v18, v18
    v_sub_f32 v19, v19, v117
    v_exp_f32 v19, v19
    v_sub_f32 v20, v20, v117
    v_exp_f32 v20, v20
    v_mfma_f32_32x32x16_bf16 v[32:47], v[92:95], v[84:87], 0
    v_sub_f32 v21, v21, v117
    v_exp_f32 v21, v21
    v_sub_f32 v22, v22, v117
    v_exp_f32 v22, v22
    v_sub_f32 v23, v23, v117
    v_exp_f32 v23, v23
    v_sub_f32 v24, v24, v117
    v_exp_f32 v24, v24
    v_sub_f32 v25, v25, v117
    v_exp_f32 v25, v25
    v_smfmac_f32_32x32x32_bf16 v[48:63], v[104:107], v[16:23], v112
    ds_read_b128 v[92:95], v113 offset:55296
    s_mov_b64 exec, s[72:73]
    ds_read_b128 v[96:99], v114 offset:53248
    ds_read_b128 v[100:103], v114 offset:53760
    s_mov_b64 exec, -1
    v_sub_f32 v26, v26, v117
    v_exp_f32 v26, v26
    v_sub_f32 v27, v27, v117
    v_exp_f32 v27, v27
    v_sub_f32 v28, v28, v117
    v_exp_f32 v28, v28
    v_sub_f32 v29, v29, v117
    v_exp_f32 v29, v29
    v_sub_f32 v30, v30, v117
    v_exp_f32 v30, v30
    v_sub_f32 v31, v31, v117
    v_exp_f32 v31, v31
    v_sub_f32 v32, v32, v118
    v_exp_f32 v32, v32
    v_sub_f32 v33, v33, v118
    v_exp_f32 v33, v33
    v_smfmac_f32_32x32x32_bf16 v[48:63], v[108:111], v[24:31], v112
    v_sub_f32 v34, v34, v118
    v_exp_f32 v34, v34
    v_sub_f32 v35, v35, v118
    v_exp_f32 v35, v35
    v_sub_f32 v36, v36, v118
    v_exp_f32 v36, v36
    v_mfma_f32_32x32x16_bf16 v[16:31], v[88:91], v[80:83], 0
    v_sub_f32 v37, v37, v118
    v_exp_f32 v37, v37
    v_sub_f32 v38, v38, v118
    v_exp_f32 v38, v38
    v_sub_f32 v39, v39, v118
    v_exp_f32 v39, v39
    v_sub_f32 v40, v40, v118
    v_exp_f32 v40, v40
    v_sub_f32 v41, v41, v118
    v_exp_f32 v41, v41
    v_smfmac_f32_32x32x32_bf16 v[64:79], v[104:107], v[32:39], v112
    s_waitcnt vmcnt(2)
    ds_read_b64_tr_b16 a[96:97], v116 offset:0
    ds_read_b64_tr_b16 a[98:99], v116 offset:512
    ds_read_b64_tr_b16 a[100:101], v116 offset:1024
    ds_read_b64_tr_b16 a[102:103], v116 offset:1536
    v_sub_f32 v42, v42, v118
    v_exp_f32 v42, v42
    v_sub_f32 v43, v43, v118
    v_exp_f32 v43, v43
    v_sub_f32 v44, v44, v118
    v_exp_f32 v44, v44
    v_sub_f32 v45, v45, v118
    v_exp_f32 v45, v45
    v_sub_f32 v46, v46, v118
    v_exp_f32 v46, v46
    v_sub_f32 v47, v47, v118
    v_exp_f32 v47, v47
    s_waitcnt lgkmcnt(0)
    s_add_u32 m0, s75, 0
    s_add_u32 s71, s74, 1232896
    buffer_load_dwordx4 v115, s[44:47], s71 offen  lds
    s_add_u32 m0, s75, 1024
    s_add_u32 s71, s74, 1276928
    buffer_load_dwordx4 v115, s[44:47], s71 offen  lds
    v_sub_f32 v16, v16, v117
    v_exp_f32 v16, v16
    v_sub_f32 v17, v17, v117
    v_exp_f32 v17, v17
    v_smfmac_f32_32x32x32_bf16 v[64:79], v[108:111], v[40:47], v112
    v_sub_f32 v18, v18, v117
    v_exp_f32 v18, v18
    v_sub_f32 v19, v19, v117
    v_exp_f32 v19, v19
    v_sub_f32 v20, v20, v117
    v_exp_f32 v20, v20
    v_mfma_f32_32x32x16_bf16 v[32:47], v[88:91], v[84:87], 0
    v_sub_f32 v21, v21, v117
    v_exp_f32 v21, v21
    v_sub_f32 v22, v22, v117
    v_exp_f32 v22, v22
    v_sub_f32 v23, v23, v117
    v_exp_f32 v23, v23
    v_sub_f32 v24, v24, v117
    v_exp_f32 v24, v24
    v_sub_f32 v25, v25, v117
    v_exp_f32 v25, v25
    v_smfmac_f32_32x32x32_bf16 v[48:63], v[96:99], v[16:23], v112
    ds_read_b128 v[88:91], v113 offset:57344
    s_mov_b64 exec, s[72:73]
    ds_read_b128 v[104:107], v114 offset:55296
    ds_read_b128 v[108:111], v114 offset:55808
    s_mov_b64 exec, -1
    v_sub_f32 v26, v26, v117
    v_exp_f32 v26, v26
    v_sub_f32 v27, v27, v117
    v_exp_f32 v27, v27
    v_sub_f32 v28, v28, v117
    v_exp_f32 v28, v28
    v_sub_f32 v29, v29, v117
    v_exp_f32 v29, v29
    v_sub_f32 v30, v30, v117
    v_exp_f32 v30, v30
    v_sub_f32 v31, v31, v117
    v_exp_f32 v31, v31
    v_sub_f32 v32, v32, v118
    v_exp_f32 v32, v32
    v_sub_f32 v33, v33, v118
    v_exp_f32 v33, v33
    v_smfmac_f32_32x32x32_bf16 v[48:63], v[100:103], v[24:31], v112
    v_sub_f32 v34, v34, v118
    v_exp_f32 v34, v34
    v_sub_f32 v35, v35, v118
    v_exp_f32 v35, v35
    v_sub_f32 v36, v36, v118
    v_exp_f32 v36, v36
    v_mfma_f32_32x32x16_bf16 v[16:31], v[92:95], v[80:83], 0
    v_sub_f32 v37, v37, v118
    v_exp_f32 v37, v37
    v_sub_f32 v38, v38, v118
    v_exp_f32 v38, v38
    v_sub_f32 v39, v39, v118
    v_exp_f32 v39, v39
    v_sub_f32 v40, v40, v118
    v_exp_f32 v40, v40
    v_sub_f32 v41, v41, v118
    v_exp_f32 v41, v41
    v_smfmac_f32_32x32x32_bf16 v[64:79], v[96:99], v[32:39], v112
    s_waitcnt vmcnt(2)
    ds_read_b64_tr_b16 a[104:105], v116 offset:2048
    ds_read_b64_tr_b16 a[106:107], v116 offset:2560
    ds_read_b64_tr_b16 a[108:109], v116 offset:3072
    ds_read_b64_tr_b16 a[110:111], v116 offset:3584
    v_sub_f32 v42, v42, v118
    v_exp_f32 v42, v42
    v_sub_f32 v43, v43, v118
    v_exp_f32 v43, v43
    v_sub_f32 v44, v44, v118
    v_exp_f32 v44, v44
    v_sub_f32 v45, v45, v118
    v_exp_f32 v45, v45
    v_sub_f32 v46, v46, v118
    v_exp_f32 v46, v46
    v_sub_f32 v47, v47, v118
    v_exp_f32 v47, v47
    s_waitcnt lgkmcnt(0)
    s_add_u32 m0, s75, 2048
    s_add_u32 s71, s74, 1320960
    buffer_load_dwordx4 v115, s[44:47], s71 offen  lds
    s_add_u32 m0, s75, 3072
    s_add_u32 s71, s74, 1364992
    buffer_load_dwordx4 v115, s[44:47], s71 offen  lds
    v_sub_f32 v16, v16, v117
    v_exp_f32 v16, v16
    v_sub_f32 v17, v17, v117
    v_exp_f32 v17, v17
    v_smfmac_f32_32x32x32_bf16 v[64:79], v[100:103], v[40:47], v112
    v_sub_f32 v18, v18, v117
    v_exp_f32 v18, v18
    v_sub_f32 v19, v19, v117
    v_exp_f32 v19, v19
    v_sub_f32 v20, v20, v117
    v_exp_f32 v20, v20
    v_mfma_f32_32x32x16_bf16 v[32:47], v[92:95], v[84:87], 0
    v_sub_f32 v21, v21, v117
    v_exp_f32 v21, v21
    v_sub_f32 v22, v22, v117
    v_exp_f32 v22, v22
    v_sub_f32 v23, v23, v117
    v_exp_f32 v23, v23
    v_sub_f32 v24, v24, v117
    v_exp_f32 v24, v24
    v_sub_f32 v25, v25, v117
    v_exp_f32 v25, v25
    v_smfmac_f32_32x32x32_bf16 v[48:63], v[104:107], v[16:23], v112
    ds_read_b128 v[92:95], v113 offset:59392
    s_mov_b64 exec, s[72:73]
    ds_read_b128 v[96:99], v114 offset:57344
    ds_read_b128 v[100:103], v114 offset:57856
    s_mov_b64 exec, -1
    s_lshl_b32 s64, s52, 3
    s_add_u32 s64, s64, s50
    s_mul_i32 s64, s64, 3072
    s_mov_b64 exec, 0xffffff
    buffer_load_dword v3, v119, s[36:39], s64 offen sc1
    s_mov_b64 exec, -1
    v_sub_f32 v26, v26, v117
    v_exp_f32 v26, v26
    v_sub_f32 v27, v27, v117
    v_exp_f32 v27, v27
    v_sub_f32 v28, v28, v117
    v_exp_f32 v28, v28
    v_sub_f32 v29, v29, v117
    v_exp_f32 v29, v29
    v_sub_f32 v30, v30, v117
    v_exp_f32 v30, v30
    v_sub_f32 v31, v31, v117
    v_exp_f32 v31, v31
    v_sub_f32 v32, v32, v118
    v_exp_f32 v32, v32
    v_sub_f32 v33, v33, v118
    v_exp_f32 v33, v33
    v_smfmac_f32_32x32x32_bf16 v[48:63], v[108:111], v[24:31], v112
    v_sub_f32 v34, v34, v118
    v_exp_f32 v34, v34
    v_sub_f32 v35, v35, v118
    v_exp_f32 v35, v35
    v_sub_f32 v36, v36, v118
    v_exp_f32 v36, v36
    v_mfma_f32_32x32x16_bf16 v[16:31], v[88:91], v[80:83], 0
    v_sub_f32 v37, v37, v118
    v_exp_f32 v37, v37
    v_sub_f32 v38, v38, v118
    v_exp_f32 v38, v38
    v_sub_f32 v39, v39, v118
    v_exp_f32 v39, v39
    v_sub_f32 v40, v40, v118
    v_exp_f32 v40, v40
    v_sub_f32 v41, v41, v118
    v_exp_f32 v41, v41
    v_smfmac_f32_32x32x32_bf16 v[64:79], v[104:107], v[32:39], v112
    s_waitcnt vmcnt(3)
    ds_read_b64_tr_b16 a[112:113], v116 offset:0
    ds_read_b64_tr_b16 a[114:115], v116 offset:512
    ds_read_b64_tr_b16 a[116:117], v116 offset:1024
    ds_read_b64_tr_b16 a[118:119], v116 offset:1536
    v_sub_f32 v42, v42, v118
    v_exp_f32 v42, v42
    v_sub_f32 v43, v43, v118
    v_exp_f32 v43, v43
    v_sub_f32 v44, v44, v118
    v_exp_f32 v44, v44
    v_sub_f32 v45, v45, v118
    v_exp_f32 v45, v45
    v_sub_f32 v46, v46, v118
    v_exp_f32 v46, v46
    v_sub_f32 v47, v47, v118
    v_exp_f32 v47, v47
    s_setprio 1
    s_waitcnt lgkmcnt(0)
    v_sub_f32 v16, v16, v117
    v_exp_f32 v16, v16
    v_sub_f32 v17, v17, v117
    v_exp_f32 v17, v17
    v_smfmac_f32_32x32x32_bf16 v[64:79], v[108:111], v[40:47], v112
    v_sub_f32 v18, v18, v117
    v_exp_f32 v18, v18
    v_sub_f32 v19, v19, v117
    v_exp_f32 v19, v19
    v_sub_f32 v20, v20, v117
    v_exp_f32 v20, v20
    v_mfma_f32_32x32x16_bf16 v[32:47], v[88:91], v[84:87], 0
    v_sub_f32 v21, v21, v117
    v_exp_f32 v21, v21
    v_sub_f32 v22, v22, v117
    v_exp_f32 v22, v22
    v_sub_f32 v23, v23, v117
    v_exp_f32 v23, v23
    v_sub_f32 v24, v24, v117
    v_exp_f32 v24, v24
    v_sub_f32 v25, v25, v117
    v_exp_f32 v25, v25
    v_smfmac_f32_32x32x32_bf16 v[48:63], v[96:99], v[16:23], v112
    ds_read_b128 v[88:91], v113 offset:61440
    s_mov_b64 exec, s[72:73]
    ds_read_b128 v[104:107], v114 offset:59392
    ds_read_b128 v[108:111], v114 offset:59904
    s_mov_b64 exec, -1
    v_sub_f32 v26, v26, v117
    v_exp_f32 v26, v26
    v_sub_f32 v27, v27, v117
    v_exp_f32 v27, v27
    v_sub_f32 v28, v28, v117
    v_exp_f32 v28, v28
    v_sub_f32 v29, v29, v117
    v_exp_f32 v29, v29
    v_sub_f32 v30, v30, v117
    v_exp_f32 v30, v30
    v_sub_f32 v31, v31, v117
    v_exp_f32 v31, v31
    v_sub_f32 v32, v32, v118
    v_exp_f32 v32, v32
    v_sub_f32 v33, v33, v118
    v_exp_f32 v33, v33
    v_smfmac_f32_32x32x32_bf16 v[48:63], v[100:103], v[24:31], v112
    v_sub_f32 v34, v34, v118
    v_exp_f32 v34, v34
    v_sub_f32 v35, v35, v118
    v_exp_f32 v35, v35
    v_sub_f32 v36, v36, v118
    v_exp_f32 v36, v36
    v_mfma_f32_32x32x16_bf16 v[16:31], v[92:95], v[80:83], 0
    v_sub_f32 v37, v37, v118
    v_exp_f32 v37, v37
    v_sub_f32 v38, v38, v118
    v_exp_f32 v38, v38
    v_sub_f32 v39, v39, v118
    v_exp_f32 v39, v39
    v_sub_f32 v40, v40, v118
    v_exp_f32 v40, v40
    v_sub_f32 v41, v41, v118
    v_exp_f32 v41, v41
    v_smfmac_f32_32x32x32_bf16 v[64:79], v[96:99], v[32:39], v112
    s_waitcnt vmcnt(1)
    ds_read_b64_tr_b16 a[120:121], v116 offset:2048
    ds_read_b64_tr_b16 a[122:123], v116 offset:2560
    ds_read_b64_tr_b16 a[124:125], v116 offset:3072
    ds_read_b64_tr_b16 a[126:127], v116 offset:3584
    v_sub_f32 v42, v42, v118
    v_exp_f32 v42, v42
    v_sub_f32 v43, v43, v118
    v_exp_f32 v43, v43
    v_sub_f32 v44, v44, v118
    v_exp_f32 v44, v44
    v_sub_f32 v45, v45, v118
    v_exp_f32 v45, v45
    v_sub_f32 v46, v46, v118
    v_exp_f32 v46, v46
    v_sub_f32 v47, v47, v118
    v_exp_f32 v47, v47
    s_waitcnt lgkmcnt(0)
    v_sub_f32 v16, v16, v117
    v_exp_f32 v16, v16
    v_sub_f32 v17, v17, v117
    v_exp_f32 v17, v17
    v_smfmac_f32_32x32x32_bf16 v[64:79], v[100:103], v[40:47], v112
    v_sub_f32 v18, v18, v117
    v_exp_f32 v18, v18
    v_sub_f32 v19, v19, v117
    v_exp_f32 v19, v19
    v_sub_f32 v20, v20, v117
    v_exp_f32 v20, v20
    v_mfma_f32_32x32x16_bf16 v[32:47], v[92:95], v[84:87], 0
    v_sub_f32 v21, v21, v117
    v_exp_f32 v21, v21
    v_sub_f32 v22, v22, v117
    v_exp_f32 v22, v22
    v_sub_f32 v23, v23, v117
    v_exp_f32 v23, v23
    v_sub_f32 v24, v24, v117
    v_exp_f32 v24, v24
    v_sub_f32 v25, v25, v117
    v_exp_f32 v25, v25
    v_smfmac_f32_32x32x32_bf16 v[48:63], v[104:107], v[16:23], v112
    ds_read_b128 v[92:95], v113 offset:63488
    s_mov_b64 exec, s[72:73]
    ds_read_b128 v[96:99], v114 offset:61440
    ds_read_b128 v[100:103], v114 offset:61952
    s_mov_b64 exec, -1
    v_and_b32 v12, 7, v1
    v_lshlrev_b32 v12, 2, v12
    ds_read_b32 v13, v12
    v_sub_f32 v26, v26, v117
    v_exp_f32 v26, v26
    v_sub_f32 v27, v27, v117
    v_exp_f32 v27, v27
    v_sub_f32 v28, v28, v117
    v_exp_f32 v28, v28
    v_sub_f32 v29, v29, v117
    v_exp_f32 v29, v29
    v_sub_f32 v30, v30, v117
    v_exp_f32 v30, v30
    v_sub_f32 v31, v31, v117
    v_exp_f32 v31, v31
    v_sub_f32 v32, v32, v118
    v_exp_f32 v32, v32
    v_sub_f32 v33, v33, v118
    v_exp_f32 v33, v33
    v_smfmac_f32_32x32x32_bf16 v[48:63], v[108:111], v[24:31], v112
    v_sub_f32 v34, v34, v118
    v_exp_f32 v34, v34
    v_sub_f32 v35, v35, v118
    v_exp_f32 v35, v35
    v_sub_f32 v36, v36, v118
    v_exp_f32 v36, v36
    v_mfma_f32_32x32x16_bf16 v[16:31], v[88:91], v[80:83], 0
    v_sub_f32 v37, v37, v118
    v_exp_f32 v37, v37
    v_sub_f32 v38, v38, v118
    v_exp_f32 v38, v38
    v_sub_f32 v39, v39, v118
    v_exp_f32 v39, v39
    v_sub_f32 v40, v40, v118
    v_exp_f32 v40, v40
    v_sub_f32 v41, v41, v118
    v_exp_f32 v41, v41
    v_smfmac_f32_32x32x32_bf16 v[64:79], v[104:107], v[32:39], v112
L_sequential_preLN__grouped_kv_mqa__dense_activation_gelu__prompt_kernel_sp_96:
    s_waitcnt lgkmcnt(0)
    v_cmp_ne_u32 vcc, 1, v13
    s_nop 1
    s_cmp_eq_u64 vcc, 0
    s_cbranch_scc1 L_sequential_preLN__grouped_kv_mqa__dense_activation_gelu__prompt_kernel_ok_97
    s_sleep 2
    ds_read_b32 v13, v12
    s_branch L_sequential_preLN__grouped_kv_mqa__dense_activation_gelu__prompt_kernel_sp_96
L_sequential_preLN__grouped_kv_mqa__dense_activation_gelu__prompt_kernel_ok_97:
    s_add_u32 m0, s78, 2048
    s_add_u32 s71, s77, 0
    buffer_load_dwordx4 v6, s[84:87], s71 offen  lds
    s_add_u32 m0, s78, 3072
    s_add_u32 s71, s77, 8192
    buffer_load_dwordx4 v6, s[84:87], s71 offen  lds
    s_add_u32 m0, s78, 18432
    s_add_u32 s71, s77, 131072
    buffer_load_dwordx4 v6, s[84:87], s71 offen  lds
    s_add_u32 m0, s78, 19456
    s_add_u32 s71, s77, 139264
    buffer_load_dwordx4 v6, s[84:87], s71 offen  lds
    s_add_u32 m0, s78, 67584
    s_add_u32 s71, s77, 262144
    buffer_load_dwordx4 v6, s[84:87], s71 offen  lds
    s_add_u32 m0, s78, 68608
    s_add_u32 s71, s77, 270336
    buffer_load_dwordx4 v6, s[84:87], s71 offen  lds
    s_add_u32 m0, s78, 83968
    s_add_u32 s71, s77, 393216
    buffer_load_dwordx4 v6, s[84:87], s71 offen  lds
    s_add_u32 m0, s78, 84992
    s_add_u32 s71, s77, 401408
    buffer_load_dwordx4 v6, s[84:87], s71 offen  lds
    s_lshl_b32 s65, s51, 2
    v_mov_b32 v14, s65
    global_load_dword v15, v14, s[26:27] offset:4 sc1
    v_sub_f32 v42, v42, v118
    v_exp_f32 v42, v42
    v_sub_f32 v43, v43, v118
    v_exp_f32 v43, v43
    v_sub_f32 v44, v44, v118
    v_exp_f32 v44, v44
    v_sub_f32 v45, v45, v118
    v_exp_f32 v45, v45
    v_sub_f32 v46, v46, v118
    v_exp_f32 v46, v46
    v_sub_f32 v47, v47, v118
    v_exp_f32 v47, v47
    s_waitcnt lgkmcnt(0)
    v_sub_f32 v16, v16, v117
    v_exp_f32 v16, v16
    v_sub_f32 v17, v17, v117
    v_exp_f32 v17, v17
    v_smfmac_f32_32x32x32_bf16 v[64:79], v[108:111], v[40:47], v112
    v_sub_f32 v18, v18, v117
    v_exp_f32 v18, v18
    v_sub_f32 v19, v19, v117
    v_exp_f32 v19, v19
    v_sub_f32 v20, v20, v117
    v_exp_f32 v20, v20
    v_mfma_f32_32x32x16_bf16 v[32:47], v[88:91], v[84:87], 0
    v_sub_f32 v21, v21, v117
    v_exp_f32 v21, v21
    v_sub_f32 v22, v22, v117
    v_exp_f32 v22, v22
    v_sub_f32 v23, v23, v117
    v_exp_f32 v23, v23
    v_sub_f32 v24, v24, v117
    v_exp_f32 v24, v24
    v_sub_f32 v25, v25, v117
    v_exp_f32 v25, v25
    v_smfmac_f32_32x32x32_bf16 v[48:63], v[96:99], v[16:23], v112
    s_mov_b64 exec, s[72:73]
    ds_read_b128 v[104:107], v114 offset:63488
    ds_read_b128 v[108:111], v114 offset:64000
    s_mov_b64 exec, -1
    v_sub_f32 v26, v26, v117
    v_exp_f32 v26, v26
    v_sub_f32 v27, v27, v117
    v_exp_f32 v27, v27
    v_sub_f32 v28, v28, v117
    v_exp_f32 v28, v28
    v_sub_f32 v29, v29, v117
    v_exp_f32 v29, v29
    v_sub_f32 v30, v30, v117
    v_exp_f32 v30, v30
    v_sub_f32 v31, v31, v117
    v_exp_f32 v31, v31
    v_sub_f32 v32, v32, v118
    v_exp_f32 v32, v32
    v_sub_f32 v33, v33, v118
    v_exp_f32 v33, v33
    v_smfmac_f32_32x32x32_bf16 v[48:63], v[100:103], v[24:31], v112
    v_sub_f32 v34, v34, v118
    v_exp_f32 v34, v34
    v_sub_f32 v35, v35, v118
    v_exp_f32 v35, v35
    v_sub_f32 v36, v36, v118
    v_exp_f32 v36, v36
    v_mfma_f32_32x32x16_bf16 v[16:31], v[92:95], v[80:83], 0
    v_sub_f32 v37, v37, v118
    v_exp_f32 v37, v37
    v_sub_f32 v38, v38, v118
    v_exp_f32 v38, v38
    v_sub_f32 v39, v39, v118
    v_exp_f32 v39, v39
    v_sub_f32 v40, v40, v118
    v_exp_f32 v40, v40
    v_sub_f32 v41, v41, v118
    v_exp_f32 v41, v41
    v_smfmac_f32_32x32x32_bf16 v[64:79], v[96:99], v[32:39], v112
    v_sub_f32 v42, v42, v118
    v_exp_f32 v42, v42
    v_sub_f32 v43, v43, v118
    v_exp_f32 v43, v43
    v_sub_f32 v44, v44, v118
    v_exp_f32 v44, v44
    v_sub_f32 v45, v45, v118
    v_exp_f32 v45, v45
    v_sub_f32 v46, v46, v118
    v_exp_f32 v46, v46
    v_sub_f32 v47, v47, v118
    v_exp_f32 v47, v47
    s_setprio 0
    s_waitcnt lgkmcnt(0)
    v_sub_f32 v16, v16, v117
    v_exp_f32 v16, v16
    v_sub_f32 v17, v17, v117
    v_exp_f32 v17, v17
    v_smfmac_f32_32x32x32_bf16 v[64:79], v[100:103], v[40:47], v112
    v_sub_f32 v18, v18, v117
    v_exp_f32 v18, v18
    v_sub_f32 v19, v19, v117
    v_exp_f32 v19, v19
    v_sub_f32 v20, v20, v117
    v_exp_f32 v20, v20
    v_mfma_f32_32x32x16_bf16 v[32:47], v[92:95], v[84:87], 0
    v_sub_f32 v21, v21, v117
    v_exp_f32 v21, v21
    v_sub_f32 v22, v22, v117
    v_exp_f32 v22, v22
    v_sub_f32 v23, v23, v117
    v_exp_f32 v23, v23
    v_sub_f32 v24, v24, v117
    v_exp_f32 v24, v24
    v_sub_f32 v25, v25, v117
    v_exp_f32 v25, v25
    v_smfmac_f32_32x32x32_bf16 v[48:63], v[104:107], v[16:23], v112
L_sequential_preLN__grouped_kv_mqa__dense_activation_gelu__prompt_kernel_cw_98:
    s_waitcnt vmcnt(0)
    v_readfirstlane_b32 s64, v15
    s_nop 3
    s_lshr_b32 s65, s64, 16
    s_cmp_eq_u32 s65, 0xff
    s_cbranch_scc1 L_sequential_preLN__grouped_kv_mqa__dense_activation_gelu__prompt_kernel_cw2_99
    s_sub_u32 s62, s62, 1
    s_cbranch_scc1 L_sequential_preLN__grouped_kv_mqa__dense_activation_gelu__prompt_kernel_to_100
    s_sleep 4
    global_load_dword v15, v14, s[26:27] offset:4 sc1
    s_branch L_sequential_preLN__grouped_kv_mqa__dense_activation_gelu__prompt_kernel_cw_98
L_sequential_preLN__grouped_kv_mqa__dense_activation_gelu__prompt_kernel_cw2_99:
    s_and_b32 s64, s64, 0xffff
    s_bcnt1_i32_b32 s64, s64
    s_cmp_eq_u32 s64, 1
    s_cselect_b32 s56, 1, 0
    v_sub_f32 v26, v26, v117
    v_exp_f32 v26, v26
    v_sub_f32 v27, v27, v117
    v_exp_f32 v27, v27
    v_sub_f32 v28, v28, v117
    v_exp_f32 v28, v28
    v_sub_f32 v29, v29, v117
    v_exp_f32 v29, v29
    v_sub_f32 v30, v30, v117
    v_exp_f32 v30, v30
    v_sub_f32 v31, v31, v117
    v_exp_f32 v31, v31
    v_sub_f32 v32, v32, v118
    v_exp_f32 v32, v32
    v_sub_f32 v33, v33, v118
    v_exp_f32 v33, v33
    v_smfmac_f32_32x32x32_bf16 v[48:63], v[108:111], v[24:31], v112
    v_sub_f32 v34, v34, v118
    v_exp_f32 v34, v34
    v_sub_f32 v35, v35, v118
    v_exp_f32 v35, v35
    v_sub_f32 v36, v36, v118
    v_exp_f32 v36, v36
    v_sub_f32 v37, v37, v118
    v_exp_f32 v37, v37
    v_sub_f32 v38, v38, v118
    v_exp_f32 v38, v38
    v_sub_f32 v39, v39, v118
    v_exp_f32 v39, v39
    v_sub_f32 v40, v40, v118
    v_exp_f32 v40, v40
    v_sub_f32 v41, v41, v118
    v_exp_f32 v41, v41
    v_smfmac_f32_32x32x32_bf16 v[64:79], v[104:107], v[32:39], v112
    v_sub_f32 v42, v42, v118
    v_exp_f32 v42, v42
    v_sub_f32 v43, v43, v118
    v_exp_f32 v43, v43
    v_sub_f32 v44, v44, v118
    v_exp_f32 v44, v44
    v_sub_f32 v45, v45, v118
    v_exp_f32 v45, v45
    v_sub_f32 v46, v46, v118
    v_exp_f32 v46, v46
    v_sub_f32 v47, v47, v118
    v_exp_f32 v47, v47
    v_add_u32 v12, s75, v4
    v_xor_b32 v13, 0x2000, v12
    v_smfmac_f32_32x32x32_bf16 v[64:79], v[108:111], v[40:47], v112
    s_branch L_sequential_preLN__grouped_kv_mqa__dense_activation_gelu__prompt_kernel_attepi_27
L_sequential_preLN__grouped_kv_mqa__dense_activation_gelu__prompt_kernel_to_25:
    s_mov_b32 s62, 0
    s_branch L_sequential_preLN__grouped_kv_mqa__dense_activation_gelu__prompt_kernel_kvpd_23
L_sequential_preLN__grouped_kv_mqa__dense_activation_gelu__prompt_kernel_to_34:
    s_mov_b32 s62, 0
    s_branch L_sequential_preLN__grouped_kv_mqa__dense_activation_gelu__prompt_kernel_cw2_33
L_sequential_preLN__grouped_kv_mqa__dense_activation_gelu__prompt_kernel_to_46:
    s_mov_b32 s62, 0
    s_branch L_sequential_preLN__grouped_kv_mqa__dense_activation_gelu__prompt_kernel_polld_43
L_sequential_preLN__grouped_kv_mqa__dense_activation_gelu__prompt_kernel_to_62:
    s_mov_b32 s62, 0
    s_branch L_sequential_preLN__grouped_kv_mqa__dense_activation_gelu__prompt_kernel_polld_59
L_sequential_preLN__grouped_kv_mqa__dense_activation_gelu__prompt_kernel_to_84:
    s_mov_b32 s62, 0
    s_branch L_sequential_preLN__grouped_kv_mqa__dense_activation_gelu__prompt_kernel_poll_83_d
L_sequential_preLN__grouped_kv_mqa__dense_activation_gelu__prompt_kernel_to_86:
    s_mov_b32 s62, 0
    s_branch L_sequential_preLN__grouped_kv_mqa__dense_activation_gelu__prompt_kernel_poll_85_d
L_sequential_preLN__grouped_kv_mqa__dense_activation_gelu__prompt_kernel_to_100:
    s_mov_b32 s62, 0
    s_branch L_sequential_preLN__grouped_kv_mqa__dense_activation_gelu__prompt_kernel_cw2_99
.section .rodata,"a"
.p2align 6
.amdhsa_kernel sequential_preLN__grouped_kv_mqa__dense_activation_gelu__prompt_kernel
  .amdhsa_next_free_vgpr 256
  .amdhsa_next_free_sgpr 96
  .amdhsa_accum_offset 128
  .amdhsa_group_segment_fixed_size 0
  .amdhsa_kernarg_size 104
  .amdhsa_user_sgpr_count 2
  .amdhsa_user_sgpr_kernarg_segment_ptr 1
  .amdhsa_system_sgpr_workgroup_id_x 1
  .amdhsa_float_denorm_mode_32 3
.end_amdhsa_kernel
```
